```python
import torch

def _softmax(x, axis=-1):
    return torch.softmax(x, dim=axis)
def _gelu(x):
    return torch.nn.functional.gelu(x, approximate="tanh")
def _silu(x):
    return torch.nn.functional.silu(x)
def _sigmoid(x):
    return torch.sigmoid(x)
def _layernorm(x, axis=-1, eps=1e-5):
    m = x.mean(dim=axis, keepdim=True)
    v = x.var(dim=axis, keepdim=True, unbiased=False)
    return (x - m) / torch.sqrt(v + eps)
def _scatter_add(tgt, idx, src, axis=0):
    return tgt.clone().index_add_(axis, idx, src)
def _segment_sum(src, seg, n):
    out = torch.zeros((n,) + src.shape[1:], dtype=src.dtype)
    return out.index_add_(0, seg, src)
def _pad(x, pw):
    flat = tuple(v for pair in reversed(pw) for v in pair)
    return torch.nn.functional.pad(x, flat)

kernel_name = 'parallel_sum__sliding_block__glu_gated_glu__prompt'

def setup_inputs():

    _w = (lambda a: (lambda t: t.to(torch.bfloat16) if t.is_floating_point() else t)(torch.as_tensor(a)))
    def _A_setup():
        B, S, D = 1, 2048, 512
        return {
            "x": _w((lambda *s: torch.randn(*s, dtype=torch.bfloat16) * 0.05)(B, S, D)),
            "wqkv": _w((lambda *s: torch.randn(*s, dtype=torch.bfloat16) * 0.05)(D, 3 * D)),
            "wo": _w((lambda *s: torch.randn(*s, dtype=torch.bfloat16) * 0.05)(D, D)),
        }
    _A_in = _A_setup()

    def _B_setup():
        B, S, D, F = 1, 2048, 512, 1792
        return {
            "x": _w((lambda *s: torch.randn(*s, dtype=torch.bfloat16) * 0.05)(B, S, D)),
            "w_gate": _w((lambda *s: torch.randn(*s, dtype=torch.bfloat16) * 0.05)(D, F)),
            "w_up": _w((lambda *s: torch.randn(*s, dtype=torch.bfloat16) * 0.05)(D, F)),
            "w_down": _w((lambda *s: torch.randn(*s, dtype=torch.bfloat16) * 0.05)(F, D)),
        }
    _B_in = _B_setup()

    return {
        "A_x": _A_in["x"],
        "A_wqkv": _A_in["wqkv"],
        "A_wo": _A_in["wo"],
        "B_x": _B_in["x"],
        "B_w_gate": _B_in["w_gate"],
        "B_w_up": _B_in["w_up"],
        "B_w_down": _B_in["w_down"],
    }

def reference(A_x, A_wqkv, A_wo, B_x, B_w_gate, B_w_up, B_w_down):
    def _A_ref(x, wqkv, wo):
        B, S, D = x.shape
        H = 32; Dh = D // H; W = 256
        qkv = (lambda x, *d: x.permute(*d))((x @ wqkv).reshape(B, S, 3, H, Dh), 2, 0, 3, 1, 4)
        q, k, v = qkv[0], qkv[1], qkv[2]
        scores = torch.einsum("bhqd,bhkd->bhqk", q, k) * (Dh ** -0.5)
        idx = torch.arange(S)
        mask = (idx[:, None] - idx[None, :] >= 0) & (idx[:, None] - idx[None, :] < W)
        scores = torch.where(mask[None, None], scores, -1e9)
        p = _softmax(scores, axis=-1)
        o = torch.einsum("bhqk,bhkd->bhqd", p, v)
        return (lambda x, *d: x.permute(*d))(o, 0, 2, 1, 3).reshape(B, S, D) @ wo

    def _B_ref(x, w_gate, w_up, w_down):
        g = torch.einsum("bsd,df->bsf", x, w_gate)
        u = torch.einsum("bsd,df->bsf", x, w_up)
        h = _sigmoid(g) * u
        return torch.einsum("bsf,fd->bsd", h, w_down)

    x = A_x
    xn = _layernorm(x, axis=-1)
    return x + _A_ref(xn, A_wqkv, A_wo) + _B_ref(xn, B_w_gate, B_w_up, B_w_down)
```

```asm
; @launch grid=(256,1,1) block=(512,1,1) lds=163840
.amdgcn_target "amdgcn-amd-amdhsa--gfx950"
.text
.globl parallel_sum__sliding_block__glu_gated_glu__prompt_kernel
.p2align 8
.type parallel_sum__sliding_block__glu_gated_glu__prompt_kernel,@function
parallel_sum__sliding_block__glu_gated_glu__prompt_kernel:
  s_cmp_ge_u32 s2, 256
  s_cbranch_scc1 L_exit
  s_load_dwordx16 s[16:31], s[0:1], 0
  s_load_dwordx4 s[32:35], s[0:1], 64
  v_lshrrev_b32 v1, 6, v0
  v_and_b32 v0, 63, v0
  v_readfirstlane_b32 s3, v1
  s_and_b32 s4, s2, 7
  s_lshr_b32 s5, s2, 3
  s_and_b32 s10, s4, 1
  s_lshl_b32 s10, s10, 3
  s_and_b32 s11, s5, 7
  s_add_u32 s6, s10, s11
  s_lshr_b32 s8, s4, 1
  s_lshr_b32 s9, s5, 3
  s_lshl_b32 s10, s8, 2
  s_add_u32 s7, s10, s9
  s_mul_i32 s90, s8, 7
  s_lshl_b32 s14, s9, 1
  s_add_u32 s90, s90, s14
  s_cmp_eq_u32 s9, 3
  s_cselect_b32 s14, 0, 1
  s_add_u32 s91, s90, s14
  s_lshl_b32 s10, s8, 1
  s_add_u32 s10, s10, s9
  s_add_u32 s10, s10, 16
  s_lshl_b32 s11, s8, 2
  s_cmp_eq_u32 s9, 2
  s_cselect_b32 s10, s11, s10
  s_add_u32 s12, s11, 3
  s_cmp_eq_u32 s9, 3
  s_cselect_b32 s92, s12, s10
  s_and_b32 s95, s5, 0
  s_waitcnt lgkmcnt(0)
  s_mov_b32 s36, s16
  s_mov_b32 s37, s17
  s_mov_b32 s38, 2097152
  s_mov_b32 s39, 0x20000
  s_mov_b32 s40, s18
  s_mov_b32 s41, s19
  s_mov_b32 s42, 1572864
  s_mov_b32 s43, 0x20000
  s_mov_b32 s44, s20
  s_mov_b32 s45, s21
  s_mov_b32 s46, 524288
  s_mov_b32 s47, 0x20000
  s_mov_b32 s48, s24
  s_mov_b32 s49, s25
  s_mov_b32 s50, 1835008
  s_mov_b32 s51, 0x20000
  s_mov_b32 s52, s26
  s_mov_b32 s53, s27
  s_mov_b32 s54, 1835008
  s_mov_b32 s55, 0x20000
  s_mov_b32 s56, s28
  s_mov_b32 s57, s29
  s_mov_b32 s58, 1835008
  s_mov_b32 s59, 0x20000
  s_mov_b32 s60, s30
  s_mov_b32 s61, s31
  s_mov_b32 s62, 2097152
  s_mov_b32 s63, 0x20000
  s_mov_b32 s64, s32
  s_mov_b32 s65, s33
  s_mov_b32 s66, 256
  s_mov_b32 s67, 0x20000
  s_mov_b32 s68, s34
  s_mov_b32 s69, s35
  s_mov_b32 s70, 16793600
  s_mov_b32 s71, 0x20000
  s_add_u32 s12, s34, 16787456
  s_addc_u32 s13, s35, 0
  s_load_dword s32, s[12:13], 0
  s_cmp_ge_u32 s3, 4
  s_cbranch_scc1 L_tt_w
  v_lshrrev_b32 v2, 3, v0
  v_lshlrev_b32 v2, 10, v2
  v_and_b32 v3, 7, v0
  v_lshlrev_b32 v3, 7, v3
  v_add_u32 v2, v2, v3
  s_lshl_b32 s10, s6, 17
  s_lshl_b32 s11, s9, 15
  s_add_u32 s10, s10, s11
  s_lshl_b32 s11, s3, 13
  s_add_u32 s10, s10, s11
  buffer_load_dword v48, v2, s[36:39], s10 offen
  s_branch L_tt_done
L_tt_w:
  s_and_b32 s10, s5, 7
  s_lshl_b32 s11, s10, 6
  v_add_u32 v2, s11, v0
  s_movk_i32 s12, 3584
  v_mul_lo_u32 v3, v2, s12
  s_movk_i32 s12, 3072
  v_mul_lo_u32 v2, v2, s12
  s_cmp_ge_u32 s3, 6
  s_cbranch_scc1 L_tt_w3
  s_cmp_eq_u32 s9, 3
  s_cbranch_scc1 L_tt_B
  s_lshl_b32 s13, s90, 7
  s_cmp_eq_u32 s3, 4
  s_cbranch_scc0 L_tt_up
  buffer_load_dword v48, v3, s[48:51], s13 offen
  s_branch L_tt_done
L_tt_up:
  buffer_load_dword v48, v3, s[52:55], s13 offen
  s_branch L_tt_done
L_tt_B:
  s_lshl_b32 s13, s8, 2
  s_add_u32 s13, s13, s3
  s_sub_u32 s13, s13, 3
  s_lshl_b32 s13, s13, 7
  buffer_load_dword v48, v2, s[40:43], s13 offen
  s_branch L_tt_done
  s_branch L_tt_done
L_tt_w3:
  s_mul_i32 s10, s2, 72
  s_sub_u32 s11, s3, 6
  s_mul_i32 s11, s11, 36
  s_add_u32 s10, s10, s11
  s_lshl_b32 s10, s10, 7
  v_lshlrev_b32 v2, 7, v0
  v_add_u32 v2, s10, v2
  v_subrev_u32 v3, 1835008, v2
  s_mov_b32 exec_hi, 0xf
  buffer_load_dword v48, v2, s[56:59], 0 offen
  buffer_load_dword v48, v3, s[44:47], 0 offen
  s_mov_b64 exec, -1
L_tt_done:
  s_cmp_eq_u32 s3, 7
  s_cbranch_scc0 L_nocpf
  s_getpc_b64 s[12:13]
  s_and_b32 s12, s12, 0xffffff00
  s_lshl_b32 s10, s5, 11
  v_lshlrev_b32 v70, 7, v0
  v_add_u32 v70, s10, v70
  s_mov_b32 s11, L_exit-parallel_sum__sliding_block__glu_gated_glu__prompt_kernel-1024
  v_cmp_gt_u32 vcc, s11, v70
  s_nop 3
  s_and_b64 vcc, vcc, 0xffff
  s_and_saveexec_b64 s[14:15], vcc
  s_cbranch_execz L_cpf_r
  global_load_dword v72, v70, s[12:13]
L_cpf_r:
  s_mov_b64 exec, -1
L_nocpf:
  s_cmp_ge_u32 s3, 4
  s_cbranch_scc1 L_hwave
  s_lshl_b32 s12, s4, 2
  s_and_b32 s13, s5, 3
  s_add_u32 s86, s12, s13
  s_lshr_b32 s87, s5, 2
  s_cmp_eq_u32 s3, 0
  s_cbranch_scc0 L_prep_cs
  v_lshlrev_b32 v2, 4, v0
  s_lshl_b32 s10, s6, 17
  s_lshl_b32 s11, s7, 13
  s_add_u32 s10, s10, s11
  s_add_u32 s11, s10, 0
  buffer_load_dwordx4 v[128:131], v2, s[36:39], s11 offen
  s_add_u32 s11, s10, 1024
  buffer_load_dwordx4 v[132:135], v2, s[36:39], s11 offen
  s_add_u32 s11, s10, 2048
  buffer_load_dwordx4 v[136:139], v2, s[36:39], s11 offen
  s_add_u32 s11, s10, 3072
  buffer_load_dwordx4 v[140:143], v2, s[36:39], s11 offen
  s_add_u32 s11, s10, 4096
  buffer_load_dwordx4 v[144:147], v2, s[36:39], s11 offen
  s_add_u32 s11, s10, 5120
  buffer_load_dwordx4 v[148:151], v2, s[36:39], s11 offen
  s_add_u32 s11, s10, 6144
  buffer_load_dwordx4 v[152:155], v2, s[36:39], s11 offen
  s_add_u32 s11, s10, 7168
  buffer_load_dwordx4 v[156:159], v2, s[36:39], s11 offen
  v_mov_b32 v3, 0x3f803f80
  v_mov_b32 v16, 0
  v_mov_b32 v17, 0
  v_mov_b32 v18, 0
  v_mov_b32 v19, 0
  v_mov_b32 v20, 0
  v_mov_b32 v21, 0
  v_mov_b32 v22, 0
  v_mov_b32 v23, 0
  v_mov_b32 v24, 0
  v_mov_b32 v25, 0
  v_mov_b32 v26, 0
  v_mov_b32 v27, 0
  v_mov_b32 v28, 0
  v_mov_b32 v29, 0
  v_mov_b32 v30, 0
  v_mov_b32 v31, 0
  s_waitcnt vmcnt(7)
  v_dot2_f32_bf16 v16, v128, v3, v16
  v_dot2_f32_bf16 v24, v128, v128, v24
  v_dot2_f32_bf16 v16, v129, v3, v16
  v_dot2_f32_bf16 v24, v129, v129, v24
  v_dot2_f32_bf16 v16, v130, v3, v16
  v_dot2_f32_bf16 v24, v130, v130, v24
  v_dot2_f32_bf16 v16, v131, v3, v16
  v_dot2_f32_bf16 v24, v131, v131, v24
  s_waitcnt vmcnt(6)
  v_dot2_f32_bf16 v17, v132, v3, v17
  v_dot2_f32_bf16 v25, v132, v132, v25
  v_dot2_f32_bf16 v17, v133, v3, v17
  v_dot2_f32_bf16 v25, v133, v133, v25
  v_dot2_f32_bf16 v17, v134, v3, v17
  v_dot2_f32_bf16 v25, v134, v134, v25
  v_dot2_f32_bf16 v17, v135, v3, v17
  v_dot2_f32_bf16 v25, v135, v135, v25
  s_waitcnt vmcnt(5)
  v_dot2_f32_bf16 v18, v136, v3, v18
  v_dot2_f32_bf16 v26, v136, v136, v26
  v_dot2_f32_bf16 v18, v137, v3, v18
  v_dot2_f32_bf16 v26, v137, v137, v26
  v_dot2_f32_bf16 v18, v138, v3, v18
  v_dot2_f32_bf16 v26, v138, v138, v26
  v_dot2_f32_bf16 v18, v139, v3, v18
  v_dot2_f32_bf16 v26, v139, v139, v26
  s_waitcnt vmcnt(4)
  v_dot2_f32_bf16 v19, v140, v3, v19
  v_dot2_f32_bf16 v27, v140, v140, v27
  v_dot2_f32_bf16 v19, v141, v3, v19
  v_dot2_f32_bf16 v27, v141, v141, v27
  v_dot2_f32_bf16 v19, v142, v3, v19
  v_dot2_f32_bf16 v27, v142, v142, v27
  v_dot2_f32_bf16 v19, v143, v3, v19
  v_dot2_f32_bf16 v27, v143, v143, v27
  s_waitcnt vmcnt(3)
  v_dot2_f32_bf16 v20, v144, v3, v20
  v_dot2_f32_bf16 v28, v144, v144, v28
  v_dot2_f32_bf16 v20, v145, v3, v20
  v_dot2_f32_bf16 v28, v145, v145, v28
  v_dot2_f32_bf16 v20, v146, v3, v20
  v_dot2_f32_bf16 v28, v146, v146, v28
  v_dot2_f32_bf16 v20, v147, v3, v20
  v_dot2_f32_bf16 v28, v147, v147, v28
  s_waitcnt vmcnt(2)
  v_dot2_f32_bf16 v21, v148, v3, v21
  v_dot2_f32_bf16 v29, v148, v148, v29
  v_dot2_f32_bf16 v21, v149, v3, v21
  v_dot2_f32_bf16 v29, v149, v149, v29
  v_dot2_f32_bf16 v21, v150, v3, v21
  v_dot2_f32_bf16 v29, v150, v150, v29
  v_dot2_f32_bf16 v21, v151, v3, v21
  v_dot2_f32_bf16 v29, v151, v151, v29
  s_waitcnt vmcnt(1)
  v_dot2_f32_bf16 v22, v152, v3, v22
  v_dot2_f32_bf16 v30, v152, v152, v30
  v_dot2_f32_bf16 v22, v153, v3, v22
  v_dot2_f32_bf16 v30, v153, v153, v30
  v_dot2_f32_bf16 v22, v154, v3, v22
  v_dot2_f32_bf16 v30, v154, v154, v30
  v_dot2_f32_bf16 v22, v155, v3, v22
  v_dot2_f32_bf16 v30, v155, v155, v30
  s_waitcnt vmcnt(0)
  v_dot2_f32_bf16 v23, v156, v3, v23
  v_dot2_f32_bf16 v31, v156, v156, v31
  v_dot2_f32_bf16 v23, v157, v3, v23
  v_dot2_f32_bf16 v31, v157, v157, v31
  v_dot2_f32_bf16 v23, v158, v3, v23
  v_dot2_f32_bf16 v31, v158, v158, v31
  v_dot2_f32_bf16 v23, v159, v3, v23
  v_dot2_f32_bf16 v31, v159, v159, v31
  v_permlane32_swap_b32 v16, v20
  v_permlane32_swap_b32 v17, v21
  v_permlane32_swap_b32 v18, v22
  v_permlane32_swap_b32 v19, v23
  v_add_f32 v16, v16, v20
  v_add_f32 v17, v17, v21
  v_add_f32 v18, v18, v22
  v_add_f32 v19, v19, v23
  s_nop 0
  v_permlane16_swap_b32 v16, v18
  v_permlane16_swap_b32 v17, v19
  v_add_f32 v16, v16, v18
  v_add_f32 v17, v17, v19
  v_permlane32_swap_b32 v24, v28
  v_permlane32_swap_b32 v25, v29
  v_permlane32_swap_b32 v26, v30
  v_permlane32_swap_b32 v27, v31
  v_add_f32 v24, v24, v28
  v_add_f32 v25, v25, v29
  v_add_f32 v26, v26, v30
  v_add_f32 v27, v27, v31
  s_nop 0
  v_permlane16_swap_b32 v24, v26
  v_permlane16_swap_b32 v25, v27
  v_add_f32 v24, v24, v26
  v_add_f32 v25, v25, v27
  v_add_f32_dpp v16, v16, v16 row_ror:8 row_mask:0xf bank_mask:0xf
  v_add_f32_dpp v17, v17, v17 row_ror:8 row_mask:0xf bank_mask:0xf
  v_add_f32_dpp v24, v24, v24 row_ror:8 row_mask:0xf bank_mask:0xf
  v_add_f32_dpp v25, v25, v25 row_ror:8 row_mask:0xf bank_mask:0xf
  v_add_f32_dpp v16, v16, v16 row_ror:4 row_mask:0xf bank_mask:0xf
  v_add_f32_dpp v17, v17, v17 row_ror:4 row_mask:0xf bank_mask:0xf
  v_add_f32_dpp v24, v24, v24 row_ror:4 row_mask:0xf bank_mask:0xf
  v_add_f32_dpp v25, v25, v25 row_ror:4 row_mask:0xf bank_mask:0xf
  v_add_f32_dpp v16, v16, v16 row_ror:2 row_mask:0xf bank_mask:0xf
  v_add_f32_dpp v17, v17, v17 row_ror:2 row_mask:0xf bank_mask:0xf
  v_add_f32_dpp v24, v24, v24 row_ror:2 row_mask:0xf bank_mask:0xf
  v_add_f32_dpp v25, v25, v25 row_ror:2 row_mask:0xf bank_mask:0xf
  v_add_f32_dpp v16, v16, v16 row_ror:1 row_mask:0xf bank_mask:0xf
  v_add_f32_dpp v17, v17, v17 row_ror:1 row_mask:0xf bank_mask:0xf
  v_add_f32_dpp v24, v24, v24 row_ror:1 row_mask:0xf bank_mask:0xf
  v_add_f32_dpp v25, v25, v25 row_ror:1 row_mask:0xf bank_mask:0xf
  v_lshrrev_b32 v4, 4, v0
  v_and_b32 v5, 1, v4
  v_lshlrev_b32 v5, 1, v5
  v_lshrrev_b32 v4, 1, v4
  v_lshlrev_b32 v4, 2, v4
  v_add_u32 v4, v4, v5
  s_lshl_b32 s10, s6, 7
  s_lshl_b32 s11, s7, 3
  s_add_u32 s10, s10, s11
  v_add_u32 v4, s10, v4
  v_lshlrev_b32 v4, 4, v4
  v_and_b32 v5, 15, v0
  v_cmp_eq_u32 vcc, 0, v5
  s_nop 3
  s_mov_b64 s[12:13], vcc
  v_mul_f32 v16, 0x3b000000, v16
  v_mul_f32 v24, 0x3b000000, v24
  v_mul_f32 v32, v16, v16
  v_sub_f32 v24, v24, v32
  v_max_f32 v24, 0, v24
  v_cvt_pk_bf16_f32 v16, v16, v16
  v_cvt_pk_bf16_f32 v24, v24, v24
  v_lshlrev_b32 v24, 16, v24
  v_add_f32 v24, 0x3727c5ac, v24
  v_cvt_pk_bf16_f32 v24, v24, v24
  v_lshlrev_b32 v24, 16, v24
  v_sqrt_f32 v24, v24
  s_nop 0
  v_cvt_pk_bf16_f32 v24, v24, v24
  v_lshlrev_b32 v34, 16, v24
  v_rcp_f32 v33, v34
  v_xor_b32 v32, 0x80008000, v16
  v_mov_b32 v35, 0
  v_mul_f32 v17, 0x3b000000, v17
  v_mul_f32 v25, 0x3b000000, v25
  v_mul_f32 v36, v17, v17
  v_sub_f32 v25, v25, v36
  v_max_f32 v25, 0, v25
  v_cvt_pk_bf16_f32 v17, v17, v17
  v_cvt_pk_bf16_f32 v25, v25, v25
  v_lshlrev_b32 v25, 16, v25
  v_add_f32 v25, 0x3727c5ac, v25
  v_cvt_pk_bf16_f32 v25, v25, v25
  v_lshlrev_b32 v25, 16, v25
  v_sqrt_f32 v25, v25
  s_nop 0
  v_cvt_pk_bf16_f32 v25, v25, v25
  v_lshlrev_b32 v38, 16, v25
  v_rcp_f32 v37, v38
  v_xor_b32 v36, 0x80008000, v17
  v_mov_b32 v39, 0
  s_mov_b32 s10, 15728640
  s_mov_b64 exec, s[12:13]
  buffer_store_dwordx4 v[32:35], v4, s[68:71], s10 offen sc1
  buffer_store_dwordx4 v[36:39], v4, s[68:71], s10 offen offset:16 sc1
  s_mov_b64 exec, -1
  s_branch L_prep_done
L_prep_cs:
  s_lshr_b32 s11, s6, 3
  s_mul_i32 s11, s11, 3
  s_add_u32 s11, s11, s3
  s_sub_u32 s11, s11, 1
  s_cmp_ge_u32 s11, 5
  s_cbranch_scc1 L_prep_done
  s_and_b32 s12, s6, 7
  s_lshl_b32 s76, s8, 2
  s_add_u32 s76, s76, 1
  s_add_u32 s76, s76, s11
  s_lshl_b32 s77, s11, 1
  s_cmp_eq_u32 s9, 3
  s_cselect_b32 s78, 2, s11
  s_cselect_b32 s79, s76, s90
  s_cselect_b32 s80, s77, 0
  s_cmp_eq_u32 s11, 2
  s_cselect_b32 s78, 2, s78
  s_cselect_b32 s79, s92, s79
  s_cselect_b32 s80, 4, s80
  s_sub_u32 s76, s11, 3
  s_cmp_ge_u32 s11, 3
  s_cselect_b32 s78, s76, s78
  s_cselect_b32 s79, s91, s79
  s_cselect_b32 s80, 6, s80
  s_cmp_eq_u32 s78, 0
  s_cselect_b32 s72, s48, s52
  s_cselect_b32 s73, s49, s53
  s_mov_b32 s74, 1835008
  s_movk_i32 s81, 3584
  s_cmp_eq_u32 s78, 2
  s_cselect_b32 s72, s40, s72
  s_cselect_b32 s73, s41, s73
  s_cselect_b32 s74, 1572864, s74
  s_mov_b32 s75, 0x20000
  s_cselect_b32 s81, 3072, s81
  s_lshl_b32 s14, s79, 7
  s_lshl_b32 s13, s12, 6
  s_mul_i32 s13, s13, s81
  s_add_u32 s14, s14, s13
  v_lshrrev_b32 v2, 3, v0
  v_and_b32 v3, 7, v0
  v_mul_lo_u32 v6, v2, s81
  v_lshlrev_b32 v7, 4, v3
  v_add_u32 v6, v6, v7
  s_lshl_b32 s13, s81, 3
  buffer_load_dwordx4 v[128:131], v6, s[72:75], s14 offen
  s_add_u32 s14, s14, s13
  buffer_load_dwordx4 v[132:135], v6, s[72:75], s14 offen
  s_add_u32 s14, s14, s13
  buffer_load_dwordx4 v[136:139], v6, s[72:75], s14 offen
  s_add_u32 s14, s14, s13
  buffer_load_dwordx4 v[140:143], v6, s[72:75], s14 offen
  s_add_u32 s14, s14, s13
  buffer_load_dwordx4 v[144:147], v6, s[72:75], s14 offen
  s_add_u32 s14, s14, s13
  buffer_load_dwordx4 v[148:151], v6, s[72:75], s14 offen
  s_add_u32 s14, s14, s13
  buffer_load_dwordx4 v[152:155], v6, s[72:75], s14 offen
  s_add_u32 s14, s14, s13
  buffer_load_dwordx4 v[156:159], v6, s[72:75], s14 offen
  v_mov_b32 v4, 0x00003f80
  v_mov_b32 v5, 0x3f800000
  v_mov_b32 v16, 0
  v_mov_b32 v17, 0
  v_mov_b32 v18, 0
  v_mov_b32 v19, 0
  v_mov_b32 v20, 0
  v_mov_b32 v21, 0
  v_mov_b32 v22, 0
  v_mov_b32 v23, 0
  s_waitcnt vmcnt(7)
  v_dot2_f32_bf16 v16, v128, v4, v16
  v_dot2_f32_bf16 v17, v128, v5, v17
  v_dot2_f32_bf16 v18, v129, v4, v18
  v_dot2_f32_bf16 v19, v129, v5, v19
  v_dot2_f32_bf16 v20, v130, v4, v20
  v_dot2_f32_bf16 v21, v130, v5, v21
  v_dot2_f32_bf16 v22, v131, v4, v22
  v_dot2_f32_bf16 v23, v131, v5, v23
  s_waitcnt vmcnt(6)
  v_dot2_f32_bf16 v16, v132, v4, v16
  v_dot2_f32_bf16 v17, v132, v5, v17
  v_dot2_f32_bf16 v18, v133, v4, v18
  v_dot2_f32_bf16 v19, v133, v5, v19
  v_dot2_f32_bf16 v20, v134, v4, v20
  v_dot2_f32_bf16 v21, v134, v5, v21
  v_dot2_f32_bf16 v22, v135, v4, v22
  v_dot2_f32_bf16 v23, v135, v5, v23
  s_waitcnt vmcnt(5)
  v_dot2_f32_bf16 v16, v136, v4, v16
  v_dot2_f32_bf16 v17, v136, v5, v17
  v_dot2_f32_bf16 v18, v137, v4, v18
  v_dot2_f32_bf16 v19, v137, v5, v19
  v_dot2_f32_bf16 v20, v138, v4, v20
  v_dot2_f32_bf16 v21, v138, v5, v21
  v_dot2_f32_bf16 v22, v139, v4, v22
  v_dot2_f32_bf16 v23, v139, v5, v23
  s_waitcnt vmcnt(4)
  v_dot2_f32_bf16 v16, v140, v4, v16
  v_dot2_f32_bf16 v17, v140, v5, v17
  v_dot2_f32_bf16 v18, v141, v4, v18
  v_dot2_f32_bf16 v19, v141, v5, v19
  v_dot2_f32_bf16 v20, v142, v4, v20
  v_dot2_f32_bf16 v21, v142, v5, v21
  v_dot2_f32_bf16 v22, v143, v4, v22
  v_dot2_f32_bf16 v23, v143, v5, v23
  s_waitcnt vmcnt(3)
  v_dot2_f32_bf16 v16, v144, v4, v16
  v_dot2_f32_bf16 v17, v144, v5, v17
  v_dot2_f32_bf16 v18, v145, v4, v18
  v_dot2_f32_bf16 v19, v145, v5, v19
  v_dot2_f32_bf16 v20, v146, v4, v20
  v_dot2_f32_bf16 v21, v146, v5, v21
  v_dot2_f32_bf16 v22, v147, v4, v22
  v_dot2_f32_bf16 v23, v147, v5, v23
  s_waitcnt vmcnt(2)
  v_dot2_f32_bf16 v16, v148, v4, v16
  v_dot2_f32_bf16 v17, v148, v5, v17
  v_dot2_f32_bf16 v18, v149, v4, v18
  v_dot2_f32_bf16 v19, v149, v5, v19
  v_dot2_f32_bf16 v20, v150, v4, v20
  v_dot2_f32_bf16 v21, v150, v5, v21
  v_dot2_f32_bf16 v22, v151, v4, v22
  v_dot2_f32_bf16 v23, v151, v5, v23
  s_waitcnt vmcnt(1)
  v_dot2_f32_bf16 v16, v152, v4, v16
  v_dot2_f32_bf16 v17, v152, v5, v17
  v_dot2_f32_bf16 v18, v153, v4, v18
  v_dot2_f32_bf16 v19, v153, v5, v19
  v_dot2_f32_bf16 v20, v154, v4, v20
  v_dot2_f32_bf16 v21, v154, v5, v21
  v_dot2_f32_bf16 v22, v155, v4, v22
  v_dot2_f32_bf16 v23, v155, v5, v23
  s_waitcnt vmcnt(0)
  v_dot2_f32_bf16 v16, v156, v4, v16
  v_dot2_f32_bf16 v17, v156, v5, v17
  v_dot2_f32_bf16 v18, v157, v4, v18
  v_dot2_f32_bf16 v19, v157, v5, v19
  v_dot2_f32_bf16 v20, v158, v4, v20
  v_dot2_f32_bf16 v21, v158, v5, v21
  v_dot2_f32_bf16 v22, v159, v4, v22
  v_dot2_f32_bf16 v23, v159, v5, v23
  v_permlane32_swap_b32 v16, v20
  v_permlane32_swap_b32 v17, v21
  v_permlane32_swap_b32 v18, v22
  v_permlane32_swap_b32 v19, v23
  v_add_f32 v16, v16, v20
  v_add_f32 v17, v17, v21
  v_add_f32 v18, v18, v22
  v_add_f32 v19, v19, v23
  s_nop 0
  v_permlane16_swap_b32 v16, v18
  v_permlane16_swap_b32 v17, v19
  v_add_f32 v16, v16, v18
  v_add_f32 v17, v17, v19
  s_nop 0
  v_add_f32_dpp v16, v16, v16 row_ror:8 row_mask:0xf bank_mask:0xf
  v_add_f32_dpp v17, v17, v17 row_ror:8 row_mask:0xf bank_mask:0xf
  v_cvt_pk_bf16_f32 v18, v16, v16
  v_lshlrev_b32 v18, 16, v18
  v_sub_f32 v18, v16, v18
  v_cvt_pk_bf16_f32 v16, v16, v18
  v_cvt_pk_bf16_f32 v19, v17, v17
  v_lshlrev_b32 v19, 16, v19
  v_sub_f32 v19, v17, v19
  v_cvt_pk_bf16_f32 v17, v17, v19
  v_lshrrev_b32 v8, 4, v0
  v_and_b32 v9, 1, v8
  v_lshlrev_b32 v9, 1, v9
  v_lshrrev_b32 v8, 1, v8
  v_lshlrev_b32 v8, 2, v8
  v_add_u32 v8, v8, v9
  v_lshlrev_b32 v9, 3, v3
  v_add_u32 v8, v8, v9
  v_lshrrev_b32 v9, 4, v8
  v_lshlrev_b32 v9, 5, v9
  v_and_b32 v10, 15, v8
  v_add_u32 v9, v9, v10
  s_lshl_b32 s13, s78, 4
  v_add_u32 v9, s13, v9
  s_cmp_eq_u32 s78, 2
  s_cselect_b64 vcc, -1, 0
  v_cndmask_b32 v8, v9, v8, vcc
  v_lshrrev_b32 v9, 5, v8
  v_add_u32 v9, s80, v9
  v_lshlrev_b32 v9, 10, v9
  v_and_b32 v8, 31, v8
  v_lshlrev_b32 v8, 4, v8
  v_add_u32 v8, v8, v9
  s_lshr_b32 s13, s12, 2
  s_lshl_b32 s13, s13, 9
  s_and_b32 s14, s12, 3
  s_lshl_b32 s14, s14, 2
  s_add_u32 s13, s13, s14
  s_mul_i32 s14, s7, 10240
  s_add_u32 s14, s14, s13
  s_add_u32 s14, s14, 15794176
  v_and_b32 v9, 8, v0
  v_cmp_eq_u32 vcc, 0, v9
  s_nop 3
  s_mov_b64 s[12:13], vcc
  s_mov_b64 exec, s[12:13]
  buffer_store_dword v16, v8, s[68:71], s14 offen sc1
  buffer_store_dword v17, v8, s[68:71], s14 offen offset:16 sc1
  s_mov_b64 exec, -1
L_prep_done:
  s_nop 7
  s_waitcnt lgkmcnt(0)
  s_add_u32 s33, s32, 1
  s_lshl_b32 s33, s33, 3
  v_lshrrev_b32 v16, 4, v0
  v_and_b32 v17, 1, v16
  v_lshrrev_b32 v18, 1, v16
  v_and_b32 v19, 15, v0
  v_lshrrev_b32 v20, 2, v19
  v_and_b32 v21, 3, v19
  v_lshlrev_b32 v22, 3, v18
  v_add_u32 v22, v22, v20
  v_lshlrev_b32 v22, 7, v22
  v_and_b32 v23, 1, v21
  v_lshlrev_b32 v23, 3, v23
  v_add_u32 v22, v22, v23
  v_lshrrev_b32 v23, 1, v21
  v_lshlrev_b32 v23, 4, v23
  v_lshrrev_b32 v24, 1, v20
  v_lshlrev_b32 v24, 6, v24
  v_xor_b32 v23, v23, v24
  v_lshlrev_b32 v24, 5, v17
  v_xor_b32 v25, v23, v24
  v_add_u32 v5, v22, v25
  v_xor_b32 v6, 64, v5
  v_lshlrev_b32 v24, 13, v17
  v_add_u32 v1, v5, v24
  v_xor_b32 v2, 32, v1
  v_xor_b32 v3, 64, v1
  v_xor_b32 v4, 96, v1
  s_lshl_b32 s10, s3, 12
  v_and_b32 v16, 31, v0
  v_lshrrev_b32 v17, 5, v0
  v_lshrrev_b32 v18, 1, v16
  v_and_b32 v18, 7, v18
  v_xor_b32 v18, v18, v17
  v_lshlrev_b32 v18, 4, v18
  v_lshlrev_b32 v16, 7, v16
  v_add_u32 v16, v16, v18
  v_add_u32 v8, s10, v16
  v_xor_b32 v9, 32, v8
  v_xor_b32 v10, 64, v8
  v_xor_b32 v11, 96, v8
  v_lshlrev_b32 v7, 4, v0
  s_cmp_eq_u32 s9, 3
  s_cbranch_scc1 L_c_p1B
  s_barrier
  ds_read_b128 v[128:131], v8 offset:16384
  ds_read_b64_tr_b16 v[16:17], v1 offset:32768
  ds_read_b64_tr_b16 v[18:19], v1 offset:33280
  ds_read_b64_tr_b16 v[20:21], v2 offset:32768
  ds_read_b64_tr_b16 v[22:23], v2 offset:33280
  ds_read_b64_tr_b16 v[24:25], v3 offset:32768
  ds_read_b64_tr_b16 v[26:27], v3 offset:33280
  ds_read_b64_tr_b16 v[28:29], v4 offset:32768
  ds_read_b64_tr_b16 v[30:31], v4 offset:33280
  s_waitcnt lgkmcnt(6)
  v_mfma_f32_32x32x16_bf16 v[64:79], v[16:19], v[128:131], 0
  ds_read_b128 v[132:135], v9 offset:16384
  ds_read_b64_tr_b16 v[32:33], v1 offset:34816
  ds_read_b64_tr_b16 v[34:35], v1 offset:35328
  ds_read_b64_tr_b16 v[36:37], v2 offset:34816
  ds_read_b64_tr_b16 v[38:39], v2 offset:35328
  s_waitcnt lgkmcnt(9)
  v_mfma_f32_32x32x16_bf16 v[80:95], v[20:23], v[128:131], 0
  ds_read_b64_tr_b16 v[40:41], v3 offset:34816
  ds_read_b64_tr_b16 v[42:43], v3 offset:35328
  ds_read_b64_tr_b16 v[44:45], v4 offset:34816
  ds_read_b64_tr_b16 v[46:47], v4 offset:35328
  s_waitcnt lgkmcnt(11)
  v_mfma_f32_32x32x16_bf16 v[96:111], v[24:27], v[128:131], 0
  s_waitcnt lgkmcnt(9)
  v_mfma_f32_32x32x16_bf16 v[112:127], v[28:31], v[128:131], 0
  s_waitcnt lgkmcnt(6)
  v_mfma_f32_32x32x16_bf16 v[64:79], v[32:35], v[132:135], v[64:79]
  ds_read_b128 v[136:139], v10 offset:16384
  ds_read_b64_tr_b16 v[16:17], v1 offset:36864
  ds_read_b64_tr_b16 v[18:19], v1 offset:37376
  ds_read_b64_tr_b16 v[20:21], v2 offset:36864
  ds_read_b64_tr_b16 v[22:23], v2 offset:37376
  s_waitcnt lgkmcnt(9)
  v_mfma_f32_32x32x16_bf16 v[80:95], v[36:39], v[132:135], v[80:95]
  ds_read_b64_tr_b16 v[24:25], v3 offset:36864
  ds_read_b64_tr_b16 v[26:27], v3 offset:37376
  ds_read_b64_tr_b16 v[28:29], v4 offset:36864
  ds_read_b64_tr_b16 v[30:31], v4 offset:37376
  s_waitcnt lgkmcnt(11)
  v_mfma_f32_32x32x16_bf16 v[96:111], v[40:43], v[132:135], v[96:111]
  s_waitcnt lgkmcnt(9)
  v_mfma_f32_32x32x16_bf16 v[112:127], v[44:47], v[132:135], v[112:127]
  s_waitcnt lgkmcnt(6)
  v_mfma_f32_32x32x16_bf16 v[64:79], v[16:19], v[136:139], v[64:79]
  ds_read_b128 v[140:143], v11 offset:16384
  ds_read_b64_tr_b16 v[32:33], v1 offset:38912
  ds_read_b64_tr_b16 v[34:35], v1 offset:39424
  ds_read_b64_tr_b16 v[36:37], v2 offset:38912
  ds_read_b64_tr_b16 v[38:39], v2 offset:39424
  s_waitcnt lgkmcnt(9)
  v_mfma_f32_32x32x16_bf16 v[80:95], v[20:23], v[136:139], v[80:95]
  ds_read_b64_tr_b16 v[40:41], v3 offset:38912
  ds_read_b64_tr_b16 v[42:43], v3 offset:39424
  ds_read_b64_tr_b16 v[44:45], v4 offset:38912
  ds_read_b64_tr_b16 v[46:47], v4 offset:39424
  s_waitcnt lgkmcnt(11)
  v_mfma_f32_32x32x16_bf16 v[96:111], v[24:27], v[136:139], v[96:111]
  s_waitcnt lgkmcnt(9)
  v_mfma_f32_32x32x16_bf16 v[112:127], v[28:31], v[136:139], v[112:127]
  s_waitcnt lgkmcnt(0)
  s_barrier
  v_mfma_f32_32x32x16_bf16 v[64:79], v[32:35], v[140:143], v[64:79]
  v_add_u32 v1, 49152, v1
  v_add_u32 v2, 49152, v2
  v_add_u32 v3, 49152, v3
  v_add_u32 v4, 49152, v4
  v_add_u32 v5, 49152, v5
  v_add_u32 v6, 49152, v6
  v_add_u32 v8, 49152, v8
  v_add_u32 v9, 49152, v9
  v_add_u32 v10, 49152, v10
  v_add_u32 v11, 49152, v11
  ds_read_b128 v[144:147], v8 offset:0
  ds_read_b64_tr_b16 v[16:17], v1 offset:16384
  ds_read_b64_tr_b16 v[18:19], v1 offset:16896
  ds_read_b64_tr_b16 v[20:21], v2 offset:16384
  ds_read_b64_tr_b16 v[22:23], v2 offset:16896
  v_mfma_f32_32x32x16_bf16 v[80:95], v[36:39], v[140:143], v[80:95]
  ds_read_b64_tr_b16 v[24:25], v3 offset:16384
  ds_read_b64_tr_b16 v[26:27], v3 offset:16896
  ds_read_b64_tr_b16 v[28:29], v4 offset:16384
  ds_read_b64_tr_b16 v[30:31], v4 offset:16896
  v_mfma_f32_32x32x16_bf16 v[96:111], v[40:43], v[140:143], v[96:111]
  v_mfma_f32_32x32x16_bf16 v[112:127], v[44:47], v[140:143], v[112:127]
  s_waitcnt lgkmcnt(6)
  v_mfma_f32_32x32x16_bf16 v[64:79], v[16:19], v[144:147], v[64:79]
  ds_read_b128 v[148:151], v9 offset:0
  ds_read_b64_tr_b16 v[32:33], v1 offset:18432
  ds_read_b64_tr_b16 v[34:35], v1 offset:18944
  ds_read_b64_tr_b16 v[36:37], v2 offset:18432
  ds_read_b64_tr_b16 v[38:39], v2 offset:18944
  s_waitcnt lgkmcnt(9)
  v_mfma_f32_32x32x16_bf16 v[80:95], v[20:23], v[144:147], v[80:95]
  ds_read_b64_tr_b16 v[40:41], v3 offset:18432
  ds_read_b64_tr_b16 v[42:43], v3 offset:18944
  ds_read_b64_tr_b16 v[44:45], v4 offset:18432
  ds_read_b64_tr_b16 v[46:47], v4 offset:18944
  s_waitcnt lgkmcnt(11)
  v_mfma_f32_32x32x16_bf16 v[96:111], v[24:27], v[144:147], v[96:111]
  s_waitcnt lgkmcnt(9)
  v_mfma_f32_32x32x16_bf16 v[112:127], v[28:31], v[144:147], v[112:127]
  s_waitcnt lgkmcnt(6)
  v_mfma_f32_32x32x16_bf16 v[64:79], v[32:35], v[148:151], v[64:79]
  ds_read_b128 v[152:155], v10 offset:0
  ds_read_b64_tr_b16 v[16:17], v1 offset:20480
  ds_read_b64_tr_b16 v[18:19], v1 offset:20992
  ds_read_b64_tr_b16 v[20:21], v2 offset:20480
  ds_read_b64_tr_b16 v[22:23], v2 offset:20992
  s_waitcnt lgkmcnt(9)
  v_mfma_f32_32x32x16_bf16 v[80:95], v[36:39], v[148:151], v[80:95]
  ds_read_b64_tr_b16 v[24:25], v3 offset:20480
  ds_read_b64_tr_b16 v[26:27], v3 offset:20992
  ds_read_b64_tr_b16 v[28:29], v4 offset:20480
  ds_read_b64_tr_b16 v[30:31], v4 offset:20992
  s_waitcnt lgkmcnt(11)
  v_mfma_f32_32x32x16_bf16 v[96:111], v[40:43], v[148:151], v[96:111]
  s_waitcnt lgkmcnt(9)
  v_mfma_f32_32x32x16_bf16 v[112:127], v[44:47], v[148:151], v[112:127]
  s_waitcnt lgkmcnt(6)
  v_mfma_f32_32x32x16_bf16 v[64:79], v[16:19], v[152:155], v[64:79]
  ds_read_b128 v[156:159], v11 offset:0
  ds_read_b64_tr_b16 v[32:33], v1 offset:22528
  ds_read_b64_tr_b16 v[34:35], v1 offset:23040
  ds_read_b64_tr_b16 v[36:37], v2 offset:22528
  ds_read_b64_tr_b16 v[38:39], v2 offset:23040
  s_waitcnt lgkmcnt(9)
  v_mfma_f32_32x32x16_bf16 v[80:95], v[20:23], v[152:155], v[80:95]
  ds_read_b64_tr_b16 v[40:41], v3 offset:22528
  ds_read_b64_tr_b16 v[42:43], v3 offset:23040
  ds_read_b64_tr_b16 v[44:45], v4 offset:22528
  ds_read_b64_tr_b16 v[46:47], v4 offset:23040
  s_waitcnt lgkmcnt(11)
  v_mfma_f32_32x32x16_bf16 v[96:111], v[24:27], v[152:155], v[96:111]
  s_waitcnt lgkmcnt(9)
  v_mfma_f32_32x32x16_bf16 v[112:127], v[28:31], v[152:155], v[112:127]
  s_waitcnt lgkmcnt(0)
  s_barrier
  v_mfma_f32_32x32x16_bf16 v[64:79], v[32:35], v[156:159], v[64:79]
  v_add_u32 v1, 49152, v1
  v_add_u32 v2, 49152, v2
  v_add_u32 v3, 49152, v3
  v_add_u32 v4, 49152, v4
  v_add_u32 v5, 49152, v5
  v_add_u32 v6, 49152, v6
  ds_read_b128 v[160:163], v8 offset:32768
  ds_read_b64_tr_b16 v[16:17], v1 offset:0
  ds_read_b64_tr_b16 v[18:19], v1 offset:512
  ds_read_b64_tr_b16 v[20:21], v2 offset:0
  ds_read_b64_tr_b16 v[22:23], v2 offset:512
  v_mfma_f32_32x32x16_bf16 v[80:95], v[36:39], v[156:159], v[80:95]
  ds_read_b64_tr_b16 v[24:25], v3 offset:0
  ds_read_b64_tr_b16 v[26:27], v3 offset:512
  ds_read_b64_tr_b16 v[28:29], v4 offset:0
  ds_read_b64_tr_b16 v[30:31], v4 offset:512
  v_mfma_f32_32x32x16_bf16 v[96:111], v[40:43], v[156:159], v[96:111]
  v_mfma_f32_32x32x16_bf16 v[112:127], v[44:47], v[156:159], v[112:127]
  s_waitcnt lgkmcnt(6)
  v_mfma_f32_32x32x16_bf16 v[64:79], v[16:19], v[160:163], v[64:79]
  ds_read_b128 v[164:167], v9 offset:32768
  ds_read_b64_tr_b16 v[32:33], v1 offset:2048
  ds_read_b64_tr_b16 v[34:35], v1 offset:2560
  ds_read_b64_tr_b16 v[36:37], v2 offset:2048
  ds_read_b64_tr_b16 v[38:39], v2 offset:2560
  s_waitcnt lgkmcnt(9)
  v_mfma_f32_32x32x16_bf16 v[80:95], v[20:23], v[160:163], v[80:95]
  ds_read_b64_tr_b16 v[40:41], v3 offset:2048
  ds_read_b64_tr_b16 v[42:43], v3 offset:2560
  ds_read_b64_tr_b16 v[44:45], v4 offset:2048
  ds_read_b64_tr_b16 v[46:47], v4 offset:2560
  s_waitcnt lgkmcnt(11)
  v_mfma_f32_32x32x16_bf16 v[96:111], v[24:27], v[160:163], v[96:111]
  s_waitcnt lgkmcnt(9)
  v_mfma_f32_32x32x16_bf16 v[112:127], v[28:31], v[160:163], v[112:127]
  s_waitcnt lgkmcnt(6)
  v_mfma_f32_32x32x16_bf16 v[64:79], v[32:35], v[164:167], v[64:79]
  ds_read_b128 v[168:171], v10 offset:32768
  ds_read_b64_tr_b16 v[16:17], v1 offset:4096
  ds_read_b64_tr_b16 v[18:19], v1 offset:4608
  ds_read_b64_tr_b16 v[20:21], v2 offset:4096
  ds_read_b64_tr_b16 v[22:23], v2 offset:4608
  s_waitcnt lgkmcnt(9)
  v_mfma_f32_32x32x16_bf16 v[80:95], v[36:39], v[164:167], v[80:95]
  ds_read_b64_tr_b16 v[24:25], v3 offset:4096
  ds_read_b64_tr_b16 v[26:27], v3 offset:4608
  ds_read_b64_tr_b16 v[28:29], v4 offset:4096
  ds_read_b64_tr_b16 v[30:31], v4 offset:4608
  s_waitcnt lgkmcnt(11)
  v_mfma_f32_32x32x16_bf16 v[96:111], v[40:43], v[164:167], v[96:111]
  s_waitcnt lgkmcnt(9)
  v_mfma_f32_32x32x16_bf16 v[112:127], v[44:47], v[164:167], v[112:127]
  s_waitcnt lgkmcnt(6)
  v_mfma_f32_32x32x16_bf16 v[64:79], v[16:19], v[168:171], v[64:79]
  ds_read_b128 v[172:175], v11 offset:32768
  ds_read_b64_tr_b16 v[32:33], v1 offset:6144
  ds_read_b64_tr_b16 v[34:35], v1 offset:6656
  ds_read_b64_tr_b16 v[36:37], v2 offset:6144
  ds_read_b64_tr_b16 v[38:39], v2 offset:6656
  s_waitcnt lgkmcnt(9)
  v_mfma_f32_32x32x16_bf16 v[80:95], v[20:23], v[168:171], v[80:95]
  ds_read_b64_tr_b16 v[40:41], v3 offset:6144
  ds_read_b64_tr_b16 v[42:43], v3 offset:6656
  ds_read_b64_tr_b16 v[44:45], v4 offset:6144
  ds_read_b64_tr_b16 v[46:47], v4 offset:6656
  s_waitcnt lgkmcnt(11)
  v_mfma_f32_32x32x16_bf16 v[96:111], v[24:27], v[168:171], v[96:111]
  s_waitcnt lgkmcnt(9)
  v_mfma_f32_32x32x16_bf16 v[112:127], v[28:31], v[168:171], v[112:127]
  s_waitcnt lgkmcnt(0)
  s_barrier
  v_mfma_f32_32x32x16_bf16 v[64:79], v[32:35], v[172:175], v[64:79]
  v_add_u32 v8, 49152, v8
  v_add_u32 v9, 49152, v9
  v_add_u32 v10, 49152, v10
  v_add_u32 v11, 49152, v11
  ds_read_b128 v[176:179], v8 offset:16384
  ds_read_b64_tr_b16 v[16:17], v1 offset:32768
  ds_read_b64_tr_b16 v[18:19], v1 offset:33280
  ds_read_b64_tr_b16 v[20:21], v2 offset:32768
  ds_read_b64_tr_b16 v[22:23], v2 offset:33280
  v_mfma_f32_32x32x16_bf16 v[80:95], v[36:39], v[172:175], v[80:95]
  ds_read_b64_tr_b16 v[24:25], v3 offset:32768
  ds_read_b64_tr_b16 v[26:27], v3 offset:33280
  ds_read_b64_tr_b16 v[28:29], v4 offset:32768
  ds_read_b64_tr_b16 v[30:31], v4 offset:33280
  v_mfma_f32_32x32x16_bf16 v[96:111], v[40:43], v[172:175], v[96:111]
  v_mfma_f32_32x32x16_bf16 v[112:127], v[44:47], v[172:175], v[112:127]
  s_waitcnt lgkmcnt(6)
  v_mfma_f32_32x32x16_bf16 v[64:79], v[16:19], v[176:179], v[64:79]
  ds_read_b128 v[180:183], v9 offset:16384
  ds_read_b64_tr_b16 v[32:33], v1 offset:34816
  ds_read_b64_tr_b16 v[34:35], v1 offset:35328
  ds_read_b64_tr_b16 v[36:37], v2 offset:34816
  ds_read_b64_tr_b16 v[38:39], v2 offset:35328
  s_waitcnt lgkmcnt(9)
  v_mfma_f32_32x32x16_bf16 v[80:95], v[20:23], v[176:179], v[80:95]
  ds_read_b64_tr_b16 v[40:41], v3 offset:34816
  ds_read_b64_tr_b16 v[42:43], v3 offset:35328
  ds_read_b64_tr_b16 v[44:45], v4 offset:34816
  ds_read_b64_tr_b16 v[46:47], v4 offset:35328
  s_waitcnt lgkmcnt(11)
  v_mfma_f32_32x32x16_bf16 v[96:111], v[24:27], v[176:179], v[96:111]
  s_waitcnt lgkmcnt(9)
  v_mfma_f32_32x32x16_bf16 v[112:127], v[28:31], v[176:179], v[112:127]
  s_waitcnt lgkmcnt(6)
  v_mfma_f32_32x32x16_bf16 v[64:79], v[32:35], v[180:183], v[64:79]
  ds_read_b128 v[184:187], v10 offset:16384
  ds_read_b64_tr_b16 v[16:17], v1 offset:36864
  ds_read_b64_tr_b16 v[18:19], v1 offset:37376
  ds_read_b64_tr_b16 v[20:21], v2 offset:36864
  ds_read_b64_tr_b16 v[22:23], v2 offset:37376
  s_waitcnt lgkmcnt(9)
  v_mfma_f32_32x32x16_bf16 v[80:95], v[36:39], v[180:183], v[80:95]
  ds_read_b64_tr_b16 v[24:25], v3 offset:36864
  ds_read_b64_tr_b16 v[26:27], v3 offset:37376
  ds_read_b64_tr_b16 v[28:29], v4 offset:36864
  ds_read_b64_tr_b16 v[30:31], v4 offset:37376
  s_waitcnt lgkmcnt(11)
  v_mfma_f32_32x32x16_bf16 v[96:111], v[40:43], v[180:183], v[96:111]
  s_waitcnt lgkmcnt(9)
  v_mfma_f32_32x32x16_bf16 v[112:127], v[44:47], v[180:183], v[112:127]
  s_waitcnt lgkmcnt(6)
  v_mfma_f32_32x32x16_bf16 v[64:79], v[16:19], v[184:187], v[64:79]
  ds_read_b128 v[188:191], v11 offset:16384
  ds_read_b64_tr_b16 v[32:33], v1 offset:38912
  ds_read_b64_tr_b16 v[34:35], v1 offset:39424
  ds_read_b64_tr_b16 v[36:37], v2 offset:38912
  ds_read_b64_tr_b16 v[38:39], v2 offset:39424
  s_waitcnt lgkmcnt(9)
  v_mfma_f32_32x32x16_bf16 v[80:95], v[20:23], v[184:187], v[80:95]
  ds_read_b64_tr_b16 v[40:41], v3 offset:38912
  ds_read_b64_tr_b16 v[42:43], v3 offset:39424
  ds_read_b64_tr_b16 v[44:45], v4 offset:38912
  ds_read_b64_tr_b16 v[46:47], v4 offset:39424
  s_waitcnt lgkmcnt(11)
  v_mfma_f32_32x32x16_bf16 v[96:111], v[24:27], v[184:187], v[96:111]
  s_waitcnt lgkmcnt(9)
  v_mfma_f32_32x32x16_bf16 v[112:127], v[28:31], v[184:187], v[112:127]
  s_waitcnt lgkmcnt(0)
  s_waitcnt vmcnt(0)
  s_barrier
  v_mfma_f32_32x32x16_bf16 v[64:79], v[32:35], v[188:191], v[64:79]
  v_subrev_u32 v1, 98304, v1
  v_subrev_u32 v2, 98304, v2
  v_subrev_u32 v3, 98304, v3
  v_subrev_u32 v4, 98304, v4
  v_subrev_u32 v5, 98304, v5
  v_subrev_u32 v6, 98304, v6
  v_add_u32 v8, 49152, v8
  v_add_u32 v9, 49152, v9
  v_add_u32 v10, 49152, v10
  v_add_u32 v11, 49152, v11
  ds_read_b128 v[192:195], v8 offset:0
  ds_read_b64_tr_b16 v[16:17], v1 offset:16384
  ds_read_b64_tr_b16 v[18:19], v1 offset:16896
  ds_read_b64_tr_b16 v[20:21], v2 offset:16384
  ds_read_b64_tr_b16 v[22:23], v2 offset:16896
  v_mfma_f32_32x32x16_bf16 v[80:95], v[36:39], v[188:191], v[80:95]
  ds_read_b64_tr_b16 v[24:25], v3 offset:16384
  ds_read_b64_tr_b16 v[26:27], v3 offset:16896
  ds_read_b64_tr_b16 v[28:29], v4 offset:16384
  ds_read_b64_tr_b16 v[30:31], v4 offset:16896
  v_mfma_f32_32x32x16_bf16 v[96:111], v[40:43], v[188:191], v[96:111]
  v_mfma_f32_32x32x16_bf16 v[112:127], v[44:47], v[188:191], v[112:127]
  s_waitcnt lgkmcnt(6)
  v_mfma_f32_32x32x16_bf16 v[64:79], v[16:19], v[192:195], v[64:79]
  ds_read_b128 v[196:199], v9 offset:0
  ds_read_b64_tr_b16 v[32:33], v1 offset:18432
  ds_read_b64_tr_b16 v[34:35], v1 offset:18944
  ds_read_b64_tr_b16 v[36:37], v2 offset:18432
  ds_read_b64_tr_b16 v[38:39], v2 offset:18944
  s_waitcnt lgkmcnt(9)
  v_mfma_f32_32x32x16_bf16 v[80:95], v[20:23], v[192:195], v[80:95]
  ds_read_b64_tr_b16 v[40:41], v3 offset:18432
  ds_read_b64_tr_b16 v[42:43], v3 offset:18944
  ds_read_b64_tr_b16 v[44:45], v4 offset:18432
  ds_read_b64_tr_b16 v[46:47], v4 offset:18944
  s_waitcnt lgkmcnt(11)
  v_mfma_f32_32x32x16_bf16 v[96:111], v[24:27], v[192:195], v[96:111]
  s_waitcnt lgkmcnt(9)
  v_mfma_f32_32x32x16_bf16 v[112:127], v[28:31], v[192:195], v[112:127]
  s_waitcnt lgkmcnt(6)
  v_mfma_f32_32x32x16_bf16 v[64:79], v[32:35], v[196:199], v[64:79]
  ds_read_b128 v[200:203], v10 offset:0
  ds_read_b64_tr_b16 v[16:17], v1 offset:20480
  ds_read_b64_tr_b16 v[18:19], v1 offset:20992
  ds_read_b64_tr_b16 v[20:21], v2 offset:20480
  ds_read_b64_tr_b16 v[22:23], v2 offset:20992
  s_waitcnt lgkmcnt(9)
  v_mfma_f32_32x32x16_bf16 v[80:95], v[36:39], v[196:199], v[80:95]
  ds_read_b64_tr_b16 v[24:25], v3 offset:20480
  ds_read_b64_tr_b16 v[26:27], v3 offset:20992
  ds_read_b64_tr_b16 v[28:29], v4 offset:20480
  ds_read_b64_tr_b16 v[30:31], v4 offset:20992
  s_waitcnt lgkmcnt(11)
  v_mfma_f32_32x32x16_bf16 v[96:111], v[40:43], v[196:199], v[96:111]
  s_waitcnt lgkmcnt(9)
  v_mfma_f32_32x32x16_bf16 v[112:127], v[44:47], v[196:199], v[112:127]
  s_waitcnt lgkmcnt(6)
  v_mfma_f32_32x32x16_bf16 v[64:79], v[16:19], v[200:203], v[64:79]
  ds_read_b128 v[204:207], v11 offset:0
  ds_read_b64_tr_b16 v[32:33], v1 offset:22528
  ds_read_b64_tr_b16 v[34:35], v1 offset:23040
  ds_read_b64_tr_b16 v[36:37], v2 offset:22528
  ds_read_b64_tr_b16 v[38:39], v2 offset:23040
  s_waitcnt lgkmcnt(9)
  v_mfma_f32_32x32x16_bf16 v[80:95], v[20:23], v[200:203], v[80:95]
  ds_read_b64_tr_b16 v[40:41], v3 offset:22528
  ds_read_b64_tr_b16 v[42:43], v3 offset:23040
  ds_read_b64_tr_b16 v[44:45], v4 offset:22528
  ds_read_b64_tr_b16 v[46:47], v4 offset:23040
  s_waitcnt lgkmcnt(11)
  v_mfma_f32_32x32x16_bf16 v[96:111], v[24:27], v[200:203], v[96:111]
  s_waitcnt lgkmcnt(9)
  v_mfma_f32_32x32x16_bf16 v[112:127], v[28:31], v[200:203], v[112:127]
  s_waitcnt lgkmcnt(0)
  s_cmp_eq_u32 s3, 3
  s_cbranch_scc0 L_tw3A_ep
  v_mov_b32 v12, 0
  v_mov_b32 v49, 1
  s_mov_b64 exec, 1
  buffer_atomic_add v49, v12, s[64:67], 0 offen sc0 sc1
  s_mov_b64 exec, -1
L_tw3A_ep:
  s_cmp_eq_u32 s3, 0
  s_cbranch_scc0 L_tw3A_f1
  s_lshl_b32 s10, s6, 7
  s_lshl_b32 s12, s7, 2
  s_add_u32 s10, s10, s12
  s_add_u32 s10, s10, 0
  s_add_u32 s11, s33, 1
  v_mov_b32 v12, s11
  v_mov_b32 v13, s10
  s_mov_b32 s11, 16777216
  s_mov_b64 exec, 1
  buffer_store_dword v12, v13, s[68:71], s11 offen sc1
  s_mov_b64 exec, -1
  s_lshl_b32 s10, s7, 7
  s_lshl_b32 s12, s6, 2
  s_add_u32 s10, s10, s12
  s_add_u32 s10, s10, 2048
  s_add_u32 s11, s33, 1
  v_mov_b32 v12, s11
  v_mov_b32 v13, s10
  s_mov_b32 s11, 16777216
  s_mov_b64 exec, 1
  buffer_store_dword v12, v13, s[68:71], s11 offen sc1
  s_mov_b64 exec, -1
L_tw3A_f1:
  s_barrier
  v_mfma_f32_32x32x16_bf16 v[64:79], v[32:35], v[204:207], v[64:79]
  v_add_u32 v1, 49152, v1
  v_add_u32 v2, 49152, v2
  v_add_u32 v3, 49152, v3
  v_add_u32 v4, 49152, v4
  v_add_u32 v5, 49152, v5
  v_add_u32 v6, 49152, v6
  v_subrev_u32 v8, 147456, v8
  v_subrev_u32 v9, 147456, v9
  v_subrev_u32 v10, 147456, v10
  v_subrev_u32 v11, 147456, v11
  ds_read_b128 v[208:211], v8 offset:32768
  ds_read_b64_tr_b16 v[16:17], v1 offset:0
  ds_read_b64_tr_b16 v[18:19], v1 offset:512
  ds_read_b64_tr_b16 v[20:21], v2 offset:0
  ds_read_b64_tr_b16 v[22:23], v2 offset:512
  v_mfma_f32_32x32x16_bf16 v[80:95], v[36:39], v[204:207], v[80:95]
  ds_read_b64_tr_b16 v[24:25], v3 offset:0
  ds_read_b64_tr_b16 v[26:27], v3 offset:512
  ds_read_b64_tr_b16 v[28:29], v4 offset:0
  ds_read_b64_tr_b16 v[30:31], v4 offset:512
  v_mfma_f32_32x32x16_bf16 v[96:111], v[40:43], v[204:207], v[96:111]
  v_mfma_f32_32x32x16_bf16 v[112:127], v[44:47], v[204:207], v[112:127]
  s_waitcnt lgkmcnt(6)
  v_mfma_f32_32x32x16_bf16 v[64:79], v[16:19], v[208:211], v[64:79]
  ds_read_b128 v[212:215], v9 offset:32768
  ds_read_b64_tr_b16 v[32:33], v1 offset:2048
  ds_read_b64_tr_b16 v[34:35], v1 offset:2560
  ds_read_b64_tr_b16 v[36:37], v2 offset:2048
  ds_read_b64_tr_b16 v[38:39], v2 offset:2560
  s_waitcnt lgkmcnt(9)
  v_mfma_f32_32x32x16_bf16 v[80:95], v[20:23], v[208:211], v[80:95]
  ds_read_b64_tr_b16 v[40:41], v3 offset:2048
  ds_read_b64_tr_b16 v[42:43], v3 offset:2560
  ds_read_b64_tr_b16 v[44:45], v4 offset:2048
  ds_read_b64_tr_b16 v[46:47], v4 offset:2560
  s_waitcnt lgkmcnt(11)
  v_mfma_f32_32x32x16_bf16 v[96:111], v[24:27], v[208:211], v[96:111]
  s_waitcnt lgkmcnt(9)
  v_mfma_f32_32x32x16_bf16 v[112:127], v[28:31], v[208:211], v[112:127]
  s_waitcnt lgkmcnt(6)
  v_mfma_f32_32x32x16_bf16 v[64:79], v[32:35], v[212:215], v[64:79]
  ds_read_b128 v[216:219], v10 offset:32768
  ds_read_b64_tr_b16 v[16:17], v1 offset:4096
  ds_read_b64_tr_b16 v[18:19], v1 offset:4608
  ds_read_b64_tr_b16 v[20:21], v2 offset:4096
  ds_read_b64_tr_b16 v[22:23], v2 offset:4608
  s_waitcnt lgkmcnt(9)
  v_mfma_f32_32x32x16_bf16 v[80:95], v[36:39], v[212:215], v[80:95]
  ds_read_b64_tr_b16 v[24:25], v3 offset:4096
  ds_read_b64_tr_b16 v[26:27], v3 offset:4608
  ds_read_b64_tr_b16 v[28:29], v4 offset:4096
  ds_read_b64_tr_b16 v[30:31], v4 offset:4608
  s_waitcnt lgkmcnt(11)
  v_mfma_f32_32x32x16_bf16 v[96:111], v[40:43], v[212:215], v[96:111]
  s_waitcnt lgkmcnt(9)
  v_mfma_f32_32x32x16_bf16 v[112:127], v[44:47], v[212:215], v[112:127]
  s_waitcnt lgkmcnt(6)
  v_mfma_f32_32x32x16_bf16 v[64:79], v[16:19], v[216:219], v[64:79]
  ds_read_b128 v[220:223], v11 offset:32768
  ds_read_b64_tr_b16 v[32:33], v1 offset:6144
  ds_read_b64_tr_b16 v[34:35], v1 offset:6656
  ds_read_b64_tr_b16 v[36:37], v2 offset:6144
  ds_read_b64_tr_b16 v[38:39], v2 offset:6656
  s_waitcnt lgkmcnt(9)
  v_mfma_f32_32x32x16_bf16 v[80:95], v[20:23], v[216:219], v[80:95]
  ds_read_b64_tr_b16 v[40:41], v3 offset:6144
  ds_read_b64_tr_b16 v[42:43], v3 offset:6656
  ds_read_b64_tr_b16 v[44:45], v4 offset:6144
  ds_read_b64_tr_b16 v[46:47], v4 offset:6656
  s_waitcnt lgkmcnt(11)
  v_mfma_f32_32x32x16_bf16 v[96:111], v[24:27], v[216:219], v[96:111]
  s_waitcnt lgkmcnt(9)
  v_mfma_f32_32x32x16_bf16 v[112:127], v[28:31], v[216:219], v[112:127]
  s_waitcnt lgkmcnt(0)
  s_barrier
  v_mfma_f32_32x32x16_bf16 v[64:79], v[32:35], v[220:223], v[64:79]
  v_add_u32 v8, 49152, v8
  v_add_u32 v9, 49152, v9
  v_add_u32 v10, 49152, v10
  v_add_u32 v11, 49152, v11
  ds_read_b128 v[224:227], v8 offset:16384
  ds_read_b64_tr_b16 v[16:17], v1 offset:32768
  ds_read_b64_tr_b16 v[18:19], v1 offset:33280
  ds_read_b64_tr_b16 v[20:21], v2 offset:32768
  ds_read_b64_tr_b16 v[22:23], v2 offset:33280
  v_mfma_f32_32x32x16_bf16 v[80:95], v[36:39], v[220:223], v[80:95]
  ds_read_b64_tr_b16 v[24:25], v3 offset:32768
  ds_read_b64_tr_b16 v[26:27], v3 offset:33280
  ds_read_b64_tr_b16 v[28:29], v4 offset:32768
  ds_read_b64_tr_b16 v[30:31], v4 offset:33280
  v_mfma_f32_32x32x16_bf16 v[96:111], v[40:43], v[220:223], v[96:111]
  v_mfma_f32_32x32x16_bf16 v[112:127], v[44:47], v[220:223], v[112:127]
  s_waitcnt lgkmcnt(6)
  v_mfma_f32_32x32x16_bf16 v[64:79], v[16:19], v[224:227], v[64:79]
  ds_read_b128 v[228:231], v9 offset:16384
  ds_read_b64_tr_b16 v[32:33], v1 offset:34816
  ds_read_b64_tr_b16 v[34:35], v1 offset:35328
  ds_read_b64_tr_b16 v[36:37], v2 offset:34816
  ds_read_b64_tr_b16 v[38:39], v2 offset:35328
  s_waitcnt lgkmcnt(9)
  v_mfma_f32_32x32x16_bf16 v[80:95], v[20:23], v[224:227], v[80:95]
  ds_read_b64_tr_b16 v[40:41], v3 offset:34816
  ds_read_b64_tr_b16 v[42:43], v3 offset:35328
  ds_read_b64_tr_b16 v[44:45], v4 offset:34816
  ds_read_b64_tr_b16 v[46:47], v4 offset:35328
  s_waitcnt lgkmcnt(11)
  v_mfma_f32_32x32x16_bf16 v[96:111], v[24:27], v[224:227], v[96:111]
  s_waitcnt lgkmcnt(9)
  v_mfma_f32_32x32x16_bf16 v[112:127], v[28:31], v[224:227], v[112:127]
  s_waitcnt lgkmcnt(6)
  v_mfma_f32_32x32x16_bf16 v[64:79], v[32:35], v[228:231], v[64:79]
  ds_read_b128 v[232:235], v10 offset:16384
  ds_read_b64_tr_b16 v[16:17], v1 offset:36864
  ds_read_b64_tr_b16 v[18:19], v1 offset:37376
  ds_read_b64_tr_b16 v[20:21], v2 offset:36864
  ds_read_b64_tr_b16 v[22:23], v2 offset:37376
  s_waitcnt lgkmcnt(9)
  v_mfma_f32_32x32x16_bf16 v[80:95], v[36:39], v[228:231], v[80:95]
  ds_read_b64_tr_b16 v[24:25], v3 offset:36864
  ds_read_b64_tr_b16 v[26:27], v3 offset:37376
  ds_read_b64_tr_b16 v[28:29], v4 offset:36864
  ds_read_b64_tr_b16 v[30:31], v4 offset:37376
  s_waitcnt lgkmcnt(11)
  v_mfma_f32_32x32x16_bf16 v[96:111], v[40:43], v[228:231], v[96:111]
  s_waitcnt lgkmcnt(9)
  v_mfma_f32_32x32x16_bf16 v[112:127], v[44:47], v[228:231], v[112:127]
  s_waitcnt lgkmcnt(6)
  v_mfma_f32_32x32x16_bf16 v[64:79], v[16:19], v[232:235], v[64:79]
  ds_read_b128 v[236:239], v11 offset:16384
  ds_read_b64_tr_b16 v[32:33], v1 offset:38912
  ds_read_b64_tr_b16 v[34:35], v1 offset:39424
  ds_read_b64_tr_b16 v[36:37], v2 offset:38912
  ds_read_b64_tr_b16 v[38:39], v2 offset:39424
  s_waitcnt lgkmcnt(9)
  v_mfma_f32_32x32x16_bf16 v[80:95], v[20:23], v[232:235], v[80:95]
  ds_read_b64_tr_b16 v[40:41], v3 offset:38912
  ds_read_b64_tr_b16 v[42:43], v3 offset:39424
  ds_read_b64_tr_b16 v[44:45], v4 offset:38912
  ds_read_b64_tr_b16 v[46:47], v4 offset:39424
  s_waitcnt lgkmcnt(11)
  v_mfma_f32_32x32x16_bf16 v[96:111], v[24:27], v[232:235], v[96:111]
  s_waitcnt lgkmcnt(9)
  v_mfma_f32_32x32x16_bf16 v[112:127], v[28:31], v[232:235], v[112:127]
  s_waitcnt lgkmcnt(0)
  s_barrier
  v_mfma_f32_32x32x16_bf16 v[64:79], v[32:35], v[236:239], v[64:79]
  v_add_u32 v1, 49152, v1
  v_add_u32 v2, 49152, v2
  v_add_u32 v3, 49152, v3
  v_add_u32 v4, 49152, v4
  v_add_u32 v5, 49152, v5
  v_add_u32 v6, 49152, v6
  v_add_u32 v8, 49152, v8
  v_add_u32 v9, 49152, v9
  v_add_u32 v10, 49152, v10
  v_add_u32 v11, 49152, v11
  ds_read_b128 v[240:243], v8 offset:0
  ds_read_b64_tr_b16 v[16:17], v1 offset:16384
  ds_read_b64_tr_b16 v[18:19], v1 offset:16896
  ds_read_b64_tr_b16 v[20:21], v2 offset:16384
  ds_read_b64_tr_b16 v[22:23], v2 offset:16896
  v_mfma_f32_32x32x16_bf16 v[80:95], v[36:39], v[236:239], v[80:95]
  ds_read_b64_tr_b16 v[24:25], v3 offset:16384
  ds_read_b64_tr_b16 v[26:27], v3 offset:16896
  ds_read_b64_tr_b16 v[28:29], v4 offset:16384
  ds_read_b64_tr_b16 v[30:31], v4 offset:16896
  v_mfma_f32_32x32x16_bf16 v[96:111], v[40:43], v[236:239], v[96:111]
  v_mfma_f32_32x32x16_bf16 v[112:127], v[44:47], v[236:239], v[112:127]
  s_waitcnt lgkmcnt(6)
  v_mfma_f32_32x32x16_bf16 v[64:79], v[16:19], v[240:243], v[64:79]
  ds_read_b128 v[244:247], v9 offset:0
  ds_read_b64_tr_b16 v[32:33], v1 offset:18432
  ds_read_b64_tr_b16 v[34:35], v1 offset:18944
  ds_read_b64_tr_b16 v[36:37], v2 offset:18432
  ds_read_b64_tr_b16 v[38:39], v2 offset:18944
  s_waitcnt lgkmcnt(9)
  v_mfma_f32_32x32x16_bf16 v[80:95], v[20:23], v[240:243], v[80:95]
  ds_read_b64_tr_b16 v[40:41], v3 offset:18432
  ds_read_b64_tr_b16 v[42:43], v3 offset:18944
  ds_read_b64_tr_b16 v[44:45], v4 offset:18432
  ds_read_b64_tr_b16 v[46:47], v4 offset:18944
  s_waitcnt lgkmcnt(11)
  v_mfma_f32_32x32x16_bf16 v[96:111], v[24:27], v[240:243], v[96:111]
  s_waitcnt lgkmcnt(9)
  v_mfma_f32_32x32x16_bf16 v[112:127], v[28:31], v[240:243], v[112:127]
  s_waitcnt lgkmcnt(6)
  v_mfma_f32_32x32x16_bf16 v[64:79], v[32:35], v[244:247], v[64:79]
  ds_read_b128 v[248:251], v10 offset:0
  ds_read_b64_tr_b16 v[16:17], v1 offset:20480
  ds_read_b64_tr_b16 v[18:19], v1 offset:20992
  ds_read_b64_tr_b16 v[20:21], v2 offset:20480
  ds_read_b64_tr_b16 v[22:23], v2 offset:20992
  s_waitcnt lgkmcnt(9)
  v_mfma_f32_32x32x16_bf16 v[80:95], v[36:39], v[244:247], v[80:95]
  ds_read_b64_tr_b16 v[24:25], v3 offset:20480
  ds_read_b64_tr_b16 v[26:27], v3 offset:20992
  ds_read_b64_tr_b16 v[28:29], v4 offset:20480
  ds_read_b64_tr_b16 v[30:31], v4 offset:20992
  s_waitcnt lgkmcnt(11)
  v_mfma_f32_32x32x16_bf16 v[96:111], v[40:43], v[244:247], v[96:111]
  s_waitcnt lgkmcnt(9)
  v_mfma_f32_32x32x16_bf16 v[112:127], v[44:47], v[244:247], v[112:127]
  s_waitcnt lgkmcnt(6)
  v_mfma_f32_32x32x16_bf16 v[64:79], v[16:19], v[248:251], v[64:79]
  ds_read_b128 v[252:255], v11 offset:0
  ds_read_b64_tr_b16 v[32:33], v1 offset:22528
  ds_read_b64_tr_b16 v[34:35], v1 offset:23040
  ds_read_b64_tr_b16 v[36:37], v2 offset:22528
  ds_read_b64_tr_b16 v[38:39], v2 offset:23040
  s_waitcnt lgkmcnt(9)
  v_mfma_f32_32x32x16_bf16 v[80:95], v[20:23], v[248:251], v[80:95]
  ds_read_b64_tr_b16 v[40:41], v3 offset:22528
  ds_read_b64_tr_b16 v[42:43], v3 offset:23040
  ds_read_b64_tr_b16 v[44:45], v4 offset:22528
  ds_read_b64_tr_b16 v[46:47], v4 offset:23040
  s_waitcnt lgkmcnt(11)
  v_mfma_f32_32x32x16_bf16 v[96:111], v[24:27], v[248:251], v[96:111]
  s_waitcnt lgkmcnt(9)
  v_mfma_f32_32x32x16_bf16 v[112:127], v[28:31], v[248:251], v[112:127]
  s_waitcnt lgkmcnt(6)
  v_mfma_f32_32x32x16_bf16 v[64:79], v[32:35], v[252:255], v[64:79]
  s_waitcnt lgkmcnt(4)
  v_mfma_f32_32x32x16_bf16 v[80:95], v[36:39], v[252:255], v[80:95]
  s_waitcnt lgkmcnt(2)
  v_mfma_f32_32x32x16_bf16 v[96:111], v[40:43], v[252:255], v[96:111]
  s_waitcnt lgkmcnt(0)
  v_mfma_f32_32x32x16_bf16 v[112:127], v[44:47], v[252:255], v[112:127]
  s_branch L_c_p1done
L_c_p1B:
  s_barrier
  ds_read_b128 v[128:131], v8 offset:16384
  ds_read_b64_tr_b16 v[16:17], v5 offset:32768
  ds_read_b64_tr_b16 v[18:19], v5 offset:33280
  ds_read_b64_tr_b16 v[20:21], v6 offset:32768
  ds_read_b64_tr_b16 v[22:23], v6 offset:33280
  ds_read_b64_tr_b16 v[24:25], v5 offset:40960
  ds_read_b64_tr_b16 v[26:27], v5 offset:41472
  ds_read_b64_tr_b16 v[28:29], v6 offset:40960
  ds_read_b64_tr_b16 v[30:31], v6 offset:41472
  s_waitcnt lgkmcnt(6)
  v_mfma_f32_32x32x16_bf16 v[64:79], v[16:19], v[128:131], 0
  ds_read_b128 v[132:135], v9 offset:16384
  ds_read_b64_tr_b16 v[32:33], v5 offset:34816
  ds_read_b64_tr_b16 v[34:35], v5 offset:35328
  ds_read_b64_tr_b16 v[36:37], v6 offset:34816
  ds_read_b64_tr_b16 v[38:39], v6 offset:35328
  s_waitcnt lgkmcnt(9)
  v_mfma_f32_32x32x16_bf16 v[80:95], v[20:23], v[128:131], 0
  ds_read_b64_tr_b16 v[40:41], v5 offset:43008
  ds_read_b64_tr_b16 v[42:43], v5 offset:43520
  ds_read_b64_tr_b16 v[44:45], v6 offset:43008
  ds_read_b64_tr_b16 v[46:47], v6 offset:43520
  s_waitcnt lgkmcnt(11)
  v_mfma_f32_32x32x16_bf16 v[96:111], v[24:27], v[128:131], 0
  s_waitcnt lgkmcnt(9)
  v_mfma_f32_32x32x16_bf16 v[112:127], v[28:31], v[128:131], 0
  s_waitcnt lgkmcnt(6)
  v_mfma_f32_32x32x16_bf16 v[64:79], v[32:35], v[132:135], v[64:79]
  ds_read_b128 v[136:139], v10 offset:16384
  ds_read_b64_tr_b16 v[16:17], v5 offset:36864
  ds_read_b64_tr_b16 v[18:19], v5 offset:37376
  ds_read_b64_tr_b16 v[20:21], v6 offset:36864
  ds_read_b64_tr_b16 v[22:23], v6 offset:37376
  s_waitcnt lgkmcnt(9)
  v_mfma_f32_32x32x16_bf16 v[80:95], v[36:39], v[132:135], v[80:95]
  ds_read_b64_tr_b16 v[24:25], v5 offset:45056
  ds_read_b64_tr_b16 v[26:27], v5 offset:45568
  ds_read_b64_tr_b16 v[28:29], v6 offset:45056
  ds_read_b64_tr_b16 v[30:31], v6 offset:45568
  s_waitcnt lgkmcnt(11)
  v_mfma_f32_32x32x16_bf16 v[96:111], v[40:43], v[132:135], v[96:111]
  s_waitcnt lgkmcnt(9)
  v_mfma_f32_32x32x16_bf16 v[112:127], v[44:47], v[132:135], v[112:127]
  s_waitcnt lgkmcnt(6)
  v_mfma_f32_32x32x16_bf16 v[64:79], v[16:19], v[136:139], v[64:79]
  ds_read_b128 v[140:143], v11 offset:16384
  ds_read_b64_tr_b16 v[32:33], v5 offset:38912
  ds_read_b64_tr_b16 v[34:35], v5 offset:39424
  ds_read_b64_tr_b16 v[36:37], v6 offset:38912
  ds_read_b64_tr_b16 v[38:39], v6 offset:39424
  s_waitcnt lgkmcnt(9)
  v_mfma_f32_32x32x16_bf16 v[80:95], v[20:23], v[136:139], v[80:95]
  ds_read_b64_tr_b16 v[40:41], v5 offset:47104
  ds_read_b64_tr_b16 v[42:43], v5 offset:47616
  ds_read_b64_tr_b16 v[44:45], v6 offset:47104
  ds_read_b64_tr_b16 v[46:47], v6 offset:47616
  s_waitcnt lgkmcnt(11)
  v_mfma_f32_32x32x16_bf16 v[96:111], v[24:27], v[136:139], v[96:111]
  s_waitcnt lgkmcnt(9)
  v_mfma_f32_32x32x16_bf16 v[112:127], v[28:31], v[136:139], v[112:127]
  s_waitcnt lgkmcnt(0)
  s_barrier
  v_mfma_f32_32x32x16_bf16 v[64:79], v[32:35], v[140:143], v[64:79]
  v_add_u32 v1, 49152, v1
  v_add_u32 v2, 49152, v2
  v_add_u32 v3, 49152, v3
  v_add_u32 v4, 49152, v4
  v_add_u32 v5, 49152, v5
  v_add_u32 v6, 49152, v6
  v_add_u32 v8, 49152, v8
  v_add_u32 v9, 49152, v9
  v_add_u32 v10, 49152, v10
  v_add_u32 v11, 49152, v11
  ds_read_b128 v[144:147], v8 offset:0
  ds_read_b64_tr_b16 v[16:17], v5 offset:16384
  ds_read_b64_tr_b16 v[18:19], v5 offset:16896
  ds_read_b64_tr_b16 v[20:21], v6 offset:16384
  ds_read_b64_tr_b16 v[22:23], v6 offset:16896
  v_mfma_f32_32x32x16_bf16 v[80:95], v[36:39], v[140:143], v[80:95]
  ds_read_b64_tr_b16 v[24:25], v5 offset:24576
  ds_read_b64_tr_b16 v[26:27], v5 offset:25088
  ds_read_b64_tr_b16 v[28:29], v6 offset:24576
  ds_read_b64_tr_b16 v[30:31], v6 offset:25088
  v_mfma_f32_32x32x16_bf16 v[96:111], v[40:43], v[140:143], v[96:111]
  v_mfma_f32_32x32x16_bf16 v[112:127], v[44:47], v[140:143], v[112:127]
  s_waitcnt lgkmcnt(6)
  v_mfma_f32_32x32x16_bf16 v[64:79], v[16:19], v[144:147], v[64:79]
  ds_read_b128 v[148:151], v9 offset:0
  ds_read_b64_tr_b16 v[32:33], v5 offset:18432
  ds_read_b64_tr_b16 v[34:35], v5 offset:18944
  ds_read_b64_tr_b16 v[36:37], v6 offset:18432
  ds_read_b64_tr_b16 v[38:39], v6 offset:18944
  s_waitcnt lgkmcnt(9)
  v_mfma_f32_32x32x16_bf16 v[80:95], v[20:23], v[144:147], v[80:95]
  ds_read_b64_tr_b16 v[40:41], v5 offset:26624
  ds_read_b64_tr_b16 v[42:43], v5 offset:27136
  ds_read_b64_tr_b16 v[44:45], v6 offset:26624
  ds_read_b64_tr_b16 v[46:47], v6 offset:27136
  s_waitcnt lgkmcnt(11)
  v_mfma_f32_32x32x16_bf16 v[96:111], v[24:27], v[144:147], v[96:111]
  s_waitcnt lgkmcnt(9)
  v_mfma_f32_32x32x16_bf16 v[112:127], v[28:31], v[144:147], v[112:127]
  s_waitcnt lgkmcnt(6)
  v_mfma_f32_32x32x16_bf16 v[64:79], v[32:35], v[148:151], v[64:79]
  ds_read_b128 v[152:155], v10 offset:0
  ds_read_b64_tr_b16 v[16:17], v5 offset:20480
  ds_read_b64_tr_b16 v[18:19], v5 offset:20992
  ds_read_b64_tr_b16 v[20:21], v6 offset:20480
  ds_read_b64_tr_b16 v[22:23], v6 offset:20992
  s_waitcnt lgkmcnt(9)
  v_mfma_f32_32x32x16_bf16 v[80:95], v[36:39], v[148:151], v[80:95]
  ds_read_b64_tr_b16 v[24:25], v5 offset:28672
  ds_read_b64_tr_b16 v[26:27], v5 offset:29184
  ds_read_b64_tr_b16 v[28:29], v6 offset:28672
  ds_read_b64_tr_b16 v[30:31], v6 offset:29184
  s_waitcnt lgkmcnt(11)
  v_mfma_f32_32x32x16_bf16 v[96:111], v[40:43], v[148:151], v[96:111]
  s_waitcnt lgkmcnt(9)
  v_mfma_f32_32x32x16_bf16 v[112:127], v[44:47], v[148:151], v[112:127]
  s_waitcnt lgkmcnt(6)
  v_mfma_f32_32x32x16_bf16 v[64:79], v[16:19], v[152:155], v[64:79]
  ds_read_b128 v[156:159], v11 offset:0
  ds_read_b64_tr_b16 v[32:33], v5 offset:22528
  ds_read_b64_tr_b16 v[34:35], v5 offset:23040
  ds_read_b64_tr_b16 v[36:37], v6 offset:22528
  ds_read_b64_tr_b16 v[38:39], v6 offset:23040
  s_waitcnt lgkmcnt(9)
  v_mfma_f32_32x32x16_bf16 v[80:95], v[20:23], v[152:155], v[80:95]
  ds_read_b64_tr_b16 v[40:41], v5 offset:30720
  ds_read_b64_tr_b16 v[42:43], v5 offset:31232
  ds_read_b64_tr_b16 v[44:45], v6 offset:30720
  ds_read_b64_tr_b16 v[46:47], v6 offset:31232
  s_waitcnt lgkmcnt(11)
  v_mfma_f32_32x32x16_bf16 v[96:111], v[24:27], v[152:155], v[96:111]
  s_waitcnt lgkmcnt(9)
  v_mfma_f32_32x32x16_bf16 v[112:127], v[28:31], v[152:155], v[112:127]
  s_waitcnt lgkmcnt(0)
  s_barrier
  v_mfma_f32_32x32x16_bf16 v[64:79], v[32:35], v[156:159], v[64:79]
  v_add_u32 v1, 49152, v1
  v_add_u32 v2, 49152, v2
  v_add_u32 v3, 49152, v3
  v_add_u32 v4, 49152, v4
  v_add_u32 v5, 49152, v5
  v_add_u32 v6, 49152, v6
  ds_read_b128 v[160:163], v8 offset:32768
  ds_read_b64_tr_b16 v[16:17], v5 offset:0
  ds_read_b64_tr_b16 v[18:19], v5 offset:512
  ds_read_b64_tr_b16 v[20:21], v6 offset:0
  ds_read_b64_tr_b16 v[22:23], v6 offset:512
  v_mfma_f32_32x32x16_bf16 v[80:95], v[36:39], v[156:159], v[80:95]
  ds_read_b64_tr_b16 v[24:25], v5 offset:8192
  ds_read_b64_tr_b16 v[26:27], v5 offset:8704
  ds_read_b64_tr_b16 v[28:29], v6 offset:8192
  ds_read_b64_tr_b16 v[30:31], v6 offset:8704
  v_mfma_f32_32x32x16_bf16 v[96:111], v[40:43], v[156:159], v[96:111]
  v_mfma_f32_32x32x16_bf16 v[112:127], v[44:47], v[156:159], v[112:127]
  s_waitcnt lgkmcnt(6)
  v_mfma_f32_32x32x16_bf16 v[64:79], v[16:19], v[160:163], v[64:79]
  ds_read_b128 v[164:167], v9 offset:32768
  ds_read_b64_tr_b16 v[32:33], v5 offset:2048
  ds_read_b64_tr_b16 v[34:35], v5 offset:2560
  ds_read_b64_tr_b16 v[36:37], v6 offset:2048
  ds_read_b64_tr_b16 v[38:39], v6 offset:2560
  s_waitcnt lgkmcnt(9)
  v_mfma_f32_32x32x16_bf16 v[80:95], v[20:23], v[160:163], v[80:95]
  ds_read_b64_tr_b16 v[40:41], v5 offset:10240
  ds_read_b64_tr_b16 v[42:43], v5 offset:10752
  ds_read_b64_tr_b16 v[44:45], v6 offset:10240
  ds_read_b64_tr_b16 v[46:47], v6 offset:10752
  s_waitcnt lgkmcnt(11)
  v_mfma_f32_32x32x16_bf16 v[96:111], v[24:27], v[160:163], v[96:111]
  s_waitcnt lgkmcnt(9)
  v_mfma_f32_32x32x16_bf16 v[112:127], v[28:31], v[160:163], v[112:127]
  s_waitcnt lgkmcnt(6)
  v_mfma_f32_32x32x16_bf16 v[64:79], v[32:35], v[164:167], v[64:79]
  ds_read_b128 v[168:171], v10 offset:32768
  ds_read_b64_tr_b16 v[16:17], v5 offset:4096
  ds_read_b64_tr_b16 v[18:19], v5 offset:4608
  ds_read_b64_tr_b16 v[20:21], v6 offset:4096
  ds_read_b64_tr_b16 v[22:23], v6 offset:4608
  s_waitcnt lgkmcnt(9)
  v_mfma_f32_32x32x16_bf16 v[80:95], v[36:39], v[164:167], v[80:95]
  ds_read_b64_tr_b16 v[24:25], v5 offset:12288
  ds_read_b64_tr_b16 v[26:27], v5 offset:12800
  ds_read_b64_tr_b16 v[28:29], v6 offset:12288
  ds_read_b64_tr_b16 v[30:31], v6 offset:12800
  s_waitcnt lgkmcnt(11)
  v_mfma_f32_32x32x16_bf16 v[96:111], v[40:43], v[164:167], v[96:111]
  s_waitcnt lgkmcnt(9)
  v_mfma_f32_32x32x16_bf16 v[112:127], v[44:47], v[164:167], v[112:127]
  s_waitcnt lgkmcnt(6)
  v_mfma_f32_32x32x16_bf16 v[64:79], v[16:19], v[168:171], v[64:79]
  ds_read_b128 v[172:175], v11 offset:32768
  ds_read_b64_tr_b16 v[32:33], v5 offset:6144
  ds_read_b64_tr_b16 v[34:35], v5 offset:6656
  ds_read_b64_tr_b16 v[36:37], v6 offset:6144
  ds_read_b64_tr_b16 v[38:39], v6 offset:6656
  s_waitcnt lgkmcnt(9)
  v_mfma_f32_32x32x16_bf16 v[80:95], v[20:23], v[168:171], v[80:95]
  ds_read_b64_tr_b16 v[40:41], v5 offset:14336
  ds_read_b64_tr_b16 v[42:43], v5 offset:14848
  ds_read_b64_tr_b16 v[44:45], v6 offset:14336
  ds_read_b64_tr_b16 v[46:47], v6 offset:14848
  s_waitcnt lgkmcnt(11)
  v_mfma_f32_32x32x16_bf16 v[96:111], v[24:27], v[168:171], v[96:111]
  s_waitcnt lgkmcnt(9)
  v_mfma_f32_32x32x16_bf16 v[112:127], v[28:31], v[168:171], v[112:127]
  s_waitcnt lgkmcnt(0)
  s_barrier
  v_mfma_f32_32x32x16_bf16 v[64:79], v[32:35], v[172:175], v[64:79]
  v_add_u32 v8, 49152, v8
  v_add_u32 v9, 49152, v9
  v_add_u32 v10, 49152, v10
  v_add_u32 v11, 49152, v11
  ds_read_b128 v[176:179], v8 offset:16384
  ds_read_b64_tr_b16 v[16:17], v5 offset:32768
  ds_read_b64_tr_b16 v[18:19], v5 offset:33280
  ds_read_b64_tr_b16 v[20:21], v6 offset:32768
  ds_read_b64_tr_b16 v[22:23], v6 offset:33280
  v_mfma_f32_32x32x16_bf16 v[80:95], v[36:39], v[172:175], v[80:95]
  ds_read_b64_tr_b16 v[24:25], v5 offset:40960
  ds_read_b64_tr_b16 v[26:27], v5 offset:41472
  ds_read_b64_tr_b16 v[28:29], v6 offset:40960
  ds_read_b64_tr_b16 v[30:31], v6 offset:41472
  v_mfma_f32_32x32x16_bf16 v[96:111], v[40:43], v[172:175], v[96:111]
  v_mfma_f32_32x32x16_bf16 v[112:127], v[44:47], v[172:175], v[112:127]
  s_waitcnt lgkmcnt(6)
  v_mfma_f32_32x32x16_bf16 v[64:79], v[16:19], v[176:179], v[64:79]
  ds_read_b128 v[180:183], v9 offset:16384
  ds_read_b64_tr_b16 v[32:33], v5 offset:34816
  ds_read_b64_tr_b16 v[34:35], v5 offset:35328
  ds_read_b64_tr_b16 v[36:37], v6 offset:34816
  ds_read_b64_tr_b16 v[38:39], v6 offset:35328
  s_waitcnt lgkmcnt(9)
  v_mfma_f32_32x32x16_bf16 v[80:95], v[20:23], v[176:179], v[80:95]
  ds_read_b64_tr_b16 v[40:41], v5 offset:43008
  ds_read_b64_tr_b16 v[42:43], v5 offset:43520
  ds_read_b64_tr_b16 v[44:45], v6 offset:43008
  ds_read_b64_tr_b16 v[46:47], v6 offset:43520
  s_waitcnt lgkmcnt(11)
  v_mfma_f32_32x32x16_bf16 v[96:111], v[24:27], v[176:179], v[96:111]
  s_waitcnt lgkmcnt(9)
  v_mfma_f32_32x32x16_bf16 v[112:127], v[28:31], v[176:179], v[112:127]
  s_waitcnt lgkmcnt(6)
  v_mfma_f32_32x32x16_bf16 v[64:79], v[32:35], v[180:183], v[64:79]
  ds_read_b128 v[184:187], v10 offset:16384
  ds_read_b64_tr_b16 v[16:17], v5 offset:36864
  ds_read_b64_tr_b16 v[18:19], v5 offset:37376
  ds_read_b64_tr_b16 v[20:21], v6 offset:36864
  ds_read_b64_tr_b16 v[22:23], v6 offset:37376
  s_waitcnt lgkmcnt(9)
  v_mfma_f32_32x32x16_bf16 v[80:95], v[36:39], v[180:183], v[80:95]
  ds_read_b64_tr_b16 v[24:25], v5 offset:45056
  ds_read_b64_tr_b16 v[26:27], v5 offset:45568
  ds_read_b64_tr_b16 v[28:29], v6 offset:45056
  ds_read_b64_tr_b16 v[30:31], v6 offset:45568
  s_waitcnt lgkmcnt(11)
  v_mfma_f32_32x32x16_bf16 v[96:111], v[40:43], v[180:183], v[96:111]
  s_waitcnt lgkmcnt(9)
  v_mfma_f32_32x32x16_bf16 v[112:127], v[44:47], v[180:183], v[112:127]
  s_waitcnt lgkmcnt(6)
  v_mfma_f32_32x32x16_bf16 v[64:79], v[16:19], v[184:187], v[64:79]
  ds_read_b128 v[188:191], v11 offset:16384
  ds_read_b64_tr_b16 v[32:33], v5 offset:38912
  ds_read_b64_tr_b16 v[34:35], v5 offset:39424
  ds_read_b64_tr_b16 v[36:37], v6 offset:38912
  ds_read_b64_tr_b16 v[38:39], v6 offset:39424
  s_waitcnt lgkmcnt(9)
  v_mfma_f32_32x32x16_bf16 v[80:95], v[20:23], v[184:187], v[80:95]
  ds_read_b64_tr_b16 v[40:41], v5 offset:47104
  ds_read_b64_tr_b16 v[42:43], v5 offset:47616
  ds_read_b64_tr_b16 v[44:45], v6 offset:47104
  ds_read_b64_tr_b16 v[46:47], v6 offset:47616
  s_waitcnt lgkmcnt(11)
  v_mfma_f32_32x32x16_bf16 v[96:111], v[24:27], v[184:187], v[96:111]
  s_waitcnt lgkmcnt(9)
  v_mfma_f32_32x32x16_bf16 v[112:127], v[28:31], v[184:187], v[112:127]
  s_waitcnt lgkmcnt(0)
  s_waitcnt vmcnt(0)
  s_barrier
  v_mfma_f32_32x32x16_bf16 v[64:79], v[32:35], v[188:191], v[64:79]
  v_subrev_u32 v1, 98304, v1
  v_subrev_u32 v2, 98304, v2
  v_subrev_u32 v3, 98304, v3
  v_subrev_u32 v4, 98304, v4
  v_subrev_u32 v5, 98304, v5
  v_subrev_u32 v6, 98304, v6
  v_add_u32 v8, 49152, v8
  v_add_u32 v9, 49152, v9
  v_add_u32 v10, 49152, v10
  v_add_u32 v11, 49152, v11
  ds_read_b128 v[192:195], v8 offset:0
  ds_read_b64_tr_b16 v[16:17], v5 offset:16384
  ds_read_b64_tr_b16 v[18:19], v5 offset:16896
  ds_read_b64_tr_b16 v[20:21], v6 offset:16384
  ds_read_b64_tr_b16 v[22:23], v6 offset:16896
  v_mfma_f32_32x32x16_bf16 v[80:95], v[36:39], v[188:191], v[80:95]
  ds_read_b64_tr_b16 v[24:25], v5 offset:24576
  ds_read_b64_tr_b16 v[26:27], v5 offset:25088
  ds_read_b64_tr_b16 v[28:29], v6 offset:24576
  ds_read_b64_tr_b16 v[30:31], v6 offset:25088
  v_mfma_f32_32x32x16_bf16 v[96:111], v[40:43], v[188:191], v[96:111]
  v_mfma_f32_32x32x16_bf16 v[112:127], v[44:47], v[188:191], v[112:127]
  s_waitcnt lgkmcnt(6)
  v_mfma_f32_32x32x16_bf16 v[64:79], v[16:19], v[192:195], v[64:79]
  ds_read_b128 v[196:199], v9 offset:0
  ds_read_b64_tr_b16 v[32:33], v5 offset:18432
  ds_read_b64_tr_b16 v[34:35], v5 offset:18944
  ds_read_b64_tr_b16 v[36:37], v6 offset:18432
  ds_read_b64_tr_b16 v[38:39], v6 offset:18944
  s_waitcnt lgkmcnt(9)
  v_mfma_f32_32x32x16_bf16 v[80:95], v[20:23], v[192:195], v[80:95]
  ds_read_b64_tr_b16 v[40:41], v5 offset:26624
  ds_read_b64_tr_b16 v[42:43], v5 offset:27136
  ds_read_b64_tr_b16 v[44:45], v6 offset:26624
  ds_read_b64_tr_b16 v[46:47], v6 offset:27136
  s_waitcnt lgkmcnt(11)
  v_mfma_f32_32x32x16_bf16 v[96:111], v[24:27], v[192:195], v[96:111]
  s_waitcnt lgkmcnt(9)
  v_mfma_f32_32x32x16_bf16 v[112:127], v[28:31], v[192:195], v[112:127]
  s_waitcnt lgkmcnt(6)
  v_mfma_f32_32x32x16_bf16 v[64:79], v[32:35], v[196:199], v[64:79]
  ds_read_b128 v[200:203], v10 offset:0
  ds_read_b64_tr_b16 v[16:17], v5 offset:20480
  ds_read_b64_tr_b16 v[18:19], v5 offset:20992
  ds_read_b64_tr_b16 v[20:21], v6 offset:20480
  ds_read_b64_tr_b16 v[22:23], v6 offset:20992
  s_waitcnt lgkmcnt(9)
  v_mfma_f32_32x32x16_bf16 v[80:95], v[36:39], v[196:199], v[80:95]
  ds_read_b64_tr_b16 v[24:25], v5 offset:28672
  ds_read_b64_tr_b16 v[26:27], v5 offset:29184
  ds_read_b64_tr_b16 v[28:29], v6 offset:28672
  ds_read_b64_tr_b16 v[30:31], v6 offset:29184
  s_waitcnt lgkmcnt(11)
  v_mfma_f32_32x32x16_bf16 v[96:111], v[40:43], v[196:199], v[96:111]
  s_waitcnt lgkmcnt(9)
  v_mfma_f32_32x32x16_bf16 v[112:127], v[44:47], v[196:199], v[112:127]
  s_waitcnt lgkmcnt(6)
  v_mfma_f32_32x32x16_bf16 v[64:79], v[16:19], v[200:203], v[64:79]
  ds_read_b128 v[204:207], v11 offset:0
  ds_read_b64_tr_b16 v[32:33], v5 offset:22528
  ds_read_b64_tr_b16 v[34:35], v5 offset:23040
  ds_read_b64_tr_b16 v[36:37], v6 offset:22528
  ds_read_b64_tr_b16 v[38:39], v6 offset:23040
  s_waitcnt lgkmcnt(9)
  v_mfma_f32_32x32x16_bf16 v[80:95], v[20:23], v[200:203], v[80:95]
  ds_read_b64_tr_b16 v[40:41], v5 offset:30720
  ds_read_b64_tr_b16 v[42:43], v5 offset:31232
  ds_read_b64_tr_b16 v[44:45], v6 offset:30720
  ds_read_b64_tr_b16 v[46:47], v6 offset:31232
  s_waitcnt lgkmcnt(11)
  v_mfma_f32_32x32x16_bf16 v[96:111], v[24:27], v[200:203], v[96:111]
  s_waitcnt lgkmcnt(9)
  v_mfma_f32_32x32x16_bf16 v[112:127], v[28:31], v[200:203], v[112:127]
  s_waitcnt lgkmcnt(0)
  s_cmp_eq_u32 s3, 3
  s_cbranch_scc0 L_tw3B_ep
  v_mov_b32 v12, 0
  v_mov_b32 v49, 1
  s_mov_b64 exec, 1
  buffer_atomic_add v49, v12, s[64:67], 0 offen sc0 sc1
  s_mov_b64 exec, -1
L_tw3B_ep:
  s_cmp_eq_u32 s3, 0
  s_cbranch_scc0 L_tw3B_f1
  s_lshl_b32 s10, s6, 7
  s_lshl_b32 s12, s7, 2
  s_add_u32 s10, s10, s12
  s_add_u32 s10, s10, 0
  s_add_u32 s11, s33, 1
  v_mov_b32 v12, s11
  v_mov_b32 v13, s10
  s_mov_b32 s11, 16777216
  s_mov_b64 exec, 1
  buffer_store_dword v12, v13, s[68:71], s11 offen sc1
  s_mov_b64 exec, -1
  s_lshl_b32 s10, s7, 7
  s_lshl_b32 s12, s6, 2
  s_add_u32 s10, s10, s12
  s_add_u32 s10, s10, 2048
  s_add_u32 s11, s33, 1
  v_mov_b32 v12, s11
  v_mov_b32 v13, s10
  s_mov_b32 s11, 16777216
  s_mov_b64 exec, 1
  buffer_store_dword v12, v13, s[68:71], s11 offen sc1
  s_mov_b64 exec, -1
L_tw3B_f1:
  s_barrier
  v_mfma_f32_32x32x16_bf16 v[64:79], v[32:35], v[204:207], v[64:79]
  v_add_u32 v1, 49152, v1
  v_add_u32 v2, 49152, v2
  v_add_u32 v3, 49152, v3
  v_add_u32 v4, 49152, v4
  v_add_u32 v5, 49152, v5
  v_add_u32 v6, 49152, v6
  v_subrev_u32 v8, 147456, v8
  v_subrev_u32 v9, 147456, v9
  v_subrev_u32 v10, 147456, v10
  v_subrev_u32 v11, 147456, v11
  ds_read_b128 v[208:211], v8 offset:32768
  ds_read_b64_tr_b16 v[16:17], v5 offset:0
  ds_read_b64_tr_b16 v[18:19], v5 offset:512
  ds_read_b64_tr_b16 v[20:21], v6 offset:0
  ds_read_b64_tr_b16 v[22:23], v6 offset:512
  v_mfma_f32_32x32x16_bf16 v[80:95], v[36:39], v[204:207], v[80:95]
  ds_read_b64_tr_b16 v[24:25], v5 offset:8192
  ds_read_b64_tr_b16 v[26:27], v5 offset:8704
  ds_read_b64_tr_b16 v[28:29], v6 offset:8192
  ds_read_b64_tr_b16 v[30:31], v6 offset:8704
  v_mfma_f32_32x32x16_bf16 v[96:111], v[40:43], v[204:207], v[96:111]
  v_mfma_f32_32x32x16_bf16 v[112:127], v[44:47], v[204:207], v[112:127]
  s_waitcnt lgkmcnt(6)
  v_mfma_f32_32x32x16_bf16 v[64:79], v[16:19], v[208:211], v[64:79]
  ds_read_b128 v[212:215], v9 offset:32768
  ds_read_b64_tr_b16 v[32:33], v5 offset:2048
  ds_read_b64_tr_b16 v[34:35], v5 offset:2560
  ds_read_b64_tr_b16 v[36:37], v6 offset:2048
  ds_read_b64_tr_b16 v[38:39], v6 offset:2560
  s_waitcnt lgkmcnt(9)
  v_mfma_f32_32x32x16_bf16 v[80:95], v[20:23], v[208:211], v[80:95]
  ds_read_b64_tr_b16 v[40:41], v5 offset:10240
  ds_read_b64_tr_b16 v[42:43], v5 offset:10752
  ds_read_b64_tr_b16 v[44:45], v6 offset:10240
  ds_read_b64_tr_b16 v[46:47], v6 offset:10752
  s_waitcnt lgkmcnt(11)
  v_mfma_f32_32x32x16_bf16 v[96:111], v[24:27], v[208:211], v[96:111]
  s_waitcnt lgkmcnt(9)
  v_mfma_f32_32x32x16_bf16 v[112:127], v[28:31], v[208:211], v[112:127]
  s_waitcnt lgkmcnt(6)
  v_mfma_f32_32x32x16_bf16 v[64:79], v[32:35], v[212:215], v[64:79]
  ds_read_b128 v[216:219], v10 offset:32768
  ds_read_b64_tr_b16 v[16:17], v5 offset:4096
  ds_read_b64_tr_b16 v[18:19], v5 offset:4608
  ds_read_b64_tr_b16 v[20:21], v6 offset:4096
  ds_read_b64_tr_b16 v[22:23], v6 offset:4608
  s_waitcnt lgkmcnt(9)
  v_mfma_f32_32x32x16_bf16 v[80:95], v[36:39], v[212:215], v[80:95]
  ds_read_b64_tr_b16 v[24:25], v5 offset:12288
  ds_read_b64_tr_b16 v[26:27], v5 offset:12800
  ds_read_b64_tr_b16 v[28:29], v6 offset:12288
  ds_read_b64_tr_b16 v[30:31], v6 offset:12800
  s_waitcnt lgkmcnt(11)
  v_mfma_f32_32x32x16_bf16 v[96:111], v[40:43], v[212:215], v[96:111]
  s_waitcnt lgkmcnt(9)
  v_mfma_f32_32x32x16_bf16 v[112:127], v[44:47], v[212:215], v[112:127]
  s_waitcnt lgkmcnt(6)
  v_mfma_f32_32x32x16_bf16 v[64:79], v[16:19], v[216:219], v[64:79]
  ds_read_b128 v[220:223], v11 offset:32768
  ds_read_b64_tr_b16 v[32:33], v5 offset:6144
  ds_read_b64_tr_b16 v[34:35], v5 offset:6656
  ds_read_b64_tr_b16 v[36:37], v6 offset:6144
  ds_read_b64_tr_b16 v[38:39], v6 offset:6656
  s_waitcnt lgkmcnt(9)
  v_mfma_f32_32x32x16_bf16 v[80:95], v[20:23], v[216:219], v[80:95]
  ds_read_b64_tr_b16 v[40:41], v5 offset:14336
  ds_read_b64_tr_b16 v[42:43], v5 offset:14848
  ds_read_b64_tr_b16 v[44:45], v6 offset:14336
  ds_read_b64_tr_b16 v[46:47], v6 offset:14848
  s_waitcnt lgkmcnt(11)
  v_mfma_f32_32x32x16_bf16 v[96:111], v[24:27], v[216:219], v[96:111]
  s_waitcnt lgkmcnt(9)
  v_mfma_f32_32x32x16_bf16 v[112:127], v[28:31], v[216:219], v[112:127]
  s_waitcnt lgkmcnt(0)
  s_barrier
  v_mfma_f32_32x32x16_bf16 v[64:79], v[32:35], v[220:223], v[64:79]
  v_add_u32 v8, 49152, v8
  v_add_u32 v9, 49152, v9
  v_add_u32 v10, 49152, v10
  v_add_u32 v11, 49152, v11
  ds_read_b128 v[224:227], v8 offset:16384
  ds_read_b64_tr_b16 v[16:17], v5 offset:32768
  ds_read_b64_tr_b16 v[18:19], v5 offset:33280
  ds_read_b64_tr_b16 v[20:21], v6 offset:32768
  ds_read_b64_tr_b16 v[22:23], v6 offset:33280
  v_mfma_f32_32x32x16_bf16 v[80:95], v[36:39], v[220:223], v[80:95]
  ds_read_b64_tr_b16 v[24:25], v5 offset:40960
  ds_read_b64_tr_b16 v[26:27], v5 offset:41472
  ds_read_b64_tr_b16 v[28:29], v6 offset:40960
  ds_read_b64_tr_b16 v[30:31], v6 offset:41472
  v_mfma_f32_32x32x16_bf16 v[96:111], v[40:43], v[220:223], v[96:111]
  v_mfma_f32_32x32x16_bf16 v[112:127], v[44:47], v[220:223], v[112:127]
  s_waitcnt lgkmcnt(6)
  v_mfma_f32_32x32x16_bf16 v[64:79], v[16:19], v[224:227], v[64:79]
  ds_read_b128 v[228:231], v9 offset:16384
  ds_read_b64_tr_b16 v[32:33], v5 offset:34816
  ds_read_b64_tr_b16 v[34:35], v5 offset:35328
  ds_read_b64_tr_b16 v[36:37], v6 offset:34816
  ds_read_b64_tr_b16 v[38:39], v6 offset:35328
  s_waitcnt lgkmcnt(9)
  v_mfma_f32_32x32x16_bf16 v[80:95], v[20:23], v[224:227], v[80:95]
  ds_read_b64_tr_b16 v[40:41], v5 offset:43008
  ds_read_b64_tr_b16 v[42:43], v5 offset:43520
  ds_read_b64_tr_b16 v[44:45], v6 offset:43008
  ds_read_b64_tr_b16 v[46:47], v6 offset:43520
  s_waitcnt lgkmcnt(11)
  v_mfma_f32_32x32x16_bf16 v[96:111], v[24:27], v[224:227], v[96:111]
  s_waitcnt lgkmcnt(9)
  v_mfma_f32_32x32x16_bf16 v[112:127], v[28:31], v[224:227], v[112:127]
  s_waitcnt lgkmcnt(6)
  v_mfma_f32_32x32x16_bf16 v[64:79], v[32:35], v[228:231], v[64:79]
  ds_read_b128 v[232:235], v10 offset:16384
  ds_read_b64_tr_b16 v[16:17], v5 offset:36864
  ds_read_b64_tr_b16 v[18:19], v5 offset:37376
  ds_read_b64_tr_b16 v[20:21], v6 offset:36864
  ds_read_b64_tr_b16 v[22:23], v6 offset:37376
  s_waitcnt lgkmcnt(9)
  v_mfma_f32_32x32x16_bf16 v[80:95], v[36:39], v[228:231], v[80:95]
  ds_read_b64_tr_b16 v[24:25], v5 offset:45056
  ds_read_b64_tr_b16 v[26:27], v5 offset:45568
  ds_read_b64_tr_b16 v[28:29], v6 offset:45056
  ds_read_b64_tr_b16 v[30:31], v6 offset:45568
  s_waitcnt lgkmcnt(11)
  v_mfma_f32_32x32x16_bf16 v[96:111], v[40:43], v[228:231], v[96:111]
  s_waitcnt lgkmcnt(9)
  v_mfma_f32_32x32x16_bf16 v[112:127], v[44:47], v[228:231], v[112:127]
  s_waitcnt lgkmcnt(6)
  v_mfma_f32_32x32x16_bf16 v[64:79], v[16:19], v[232:235], v[64:79]
  ds_read_b128 v[236:239], v11 offset:16384
  ds_read_b64_tr_b16 v[32:33], v5 offset:38912
  ds_read_b64_tr_b16 v[34:35], v5 offset:39424
  ds_read_b64_tr_b16 v[36:37], v6 offset:38912
  ds_read_b64_tr_b16 v[38:39], v6 offset:39424
  s_waitcnt lgkmcnt(9)
  v_mfma_f32_32x32x16_bf16 v[80:95], v[20:23], v[232:235], v[80:95]
  ds_read_b64_tr_b16 v[40:41], v5 offset:47104
  ds_read_b64_tr_b16 v[42:43], v5 offset:47616
  ds_read_b64_tr_b16 v[44:45], v6 offset:47104
  ds_read_b64_tr_b16 v[46:47], v6 offset:47616
  s_waitcnt lgkmcnt(11)
  v_mfma_f32_32x32x16_bf16 v[96:111], v[24:27], v[232:235], v[96:111]
  s_waitcnt lgkmcnt(9)
  v_mfma_f32_32x32x16_bf16 v[112:127], v[28:31], v[232:235], v[112:127]
  s_waitcnt lgkmcnt(0)
  s_barrier
  v_mfma_f32_32x32x16_bf16 v[64:79], v[32:35], v[236:239], v[64:79]
  v_add_u32 v1, 49152, v1
  v_add_u32 v2, 49152, v2
  v_add_u32 v3, 49152, v3
  v_add_u32 v4, 49152, v4
  v_add_u32 v5, 49152, v5
  v_add_u32 v6, 49152, v6
  v_add_u32 v8, 49152, v8
  v_add_u32 v9, 49152, v9
  v_add_u32 v10, 49152, v10
  v_add_u32 v11, 49152, v11
  ds_read_b128 v[240:243], v8 offset:0
  ds_read_b64_tr_b16 v[16:17], v5 offset:16384
  ds_read_b64_tr_b16 v[18:19], v5 offset:16896
  ds_read_b64_tr_b16 v[20:21], v6 offset:16384
  ds_read_b64_tr_b16 v[22:23], v6 offset:16896
  v_mfma_f32_32x32x16_bf16 v[80:95], v[36:39], v[236:239], v[80:95]
  ds_read_b64_tr_b16 v[24:25], v5 offset:24576
  ds_read_b64_tr_b16 v[26:27], v5 offset:25088
  ds_read_b64_tr_b16 v[28:29], v6 offset:24576
  ds_read_b64_tr_b16 v[30:31], v6 offset:25088
  v_mfma_f32_32x32x16_bf16 v[96:111], v[40:43], v[236:239], v[96:111]
  v_mfma_f32_32x32x16_bf16 v[112:127], v[44:47], v[236:239], v[112:127]
  s_waitcnt lgkmcnt(6)
  v_mfma_f32_32x32x16_bf16 v[64:79], v[16:19], v[240:243], v[64:79]
  ds_read_b128 v[244:247], v9 offset:0
  ds_read_b64_tr_b16 v[32:33], v5 offset:18432
  ds_read_b64_tr_b16 v[34:35], v5 offset:18944
  ds_read_b64_tr_b16 v[36:37], v6 offset:18432
  ds_read_b64_tr_b16 v[38:39], v6 offset:18944
  s_waitcnt lgkmcnt(9)
  v_mfma_f32_32x32x16_bf16 v[80:95], v[20:23], v[240:243], v[80:95]
  ds_read_b64_tr_b16 v[40:41], v5 offset:26624
  ds_read_b64_tr_b16 v[42:43], v5 offset:27136
  ds_read_b64_tr_b16 v[44:45], v6 offset:26624
  ds_read_b64_tr_b16 v[46:47], v6 offset:27136
  s_waitcnt lgkmcnt(11)
  v_mfma_f32_32x32x16_bf16 v[96:111], v[24:27], v[240:243], v[96:111]
  s_waitcnt lgkmcnt(9)
  v_mfma_f32_32x32x16_bf16 v[112:127], v[28:31], v[240:243], v[112:127]
  s_waitcnt lgkmcnt(6)
  v_mfma_f32_32x32x16_bf16 v[64:79], v[32:35], v[244:247], v[64:79]
  ds_read_b128 v[248:251], v10 offset:0
  ds_read_b64_tr_b16 v[16:17], v5 offset:20480
  ds_read_b64_tr_b16 v[18:19], v5 offset:20992
  ds_read_b64_tr_b16 v[20:21], v6 offset:20480
  ds_read_b64_tr_b16 v[22:23], v6 offset:20992
  s_waitcnt lgkmcnt(9)
  v_mfma_f32_32x32x16_bf16 v[80:95], v[36:39], v[244:247], v[80:95]
  ds_read_b64_tr_b16 v[24:25], v5 offset:28672
  ds_read_b64_tr_b16 v[26:27], v5 offset:29184
  ds_read_b64_tr_b16 v[28:29], v6 offset:28672
  ds_read_b64_tr_b16 v[30:31], v6 offset:29184
  s_waitcnt lgkmcnt(11)
  v_mfma_f32_32x32x16_bf16 v[96:111], v[40:43], v[244:247], v[96:111]
  s_waitcnt lgkmcnt(9)
  v_mfma_f32_32x32x16_bf16 v[112:127], v[44:47], v[244:247], v[112:127]
  s_waitcnt lgkmcnt(6)
  v_mfma_f32_32x32x16_bf16 v[64:79], v[16:19], v[248:251], v[64:79]
  ds_read_b128 v[252:255], v11 offset:0
  ds_read_b64_tr_b16 v[32:33], v5 offset:22528
  ds_read_b64_tr_b16 v[34:35], v5 offset:23040
  ds_read_b64_tr_b16 v[36:37], v6 offset:22528
  ds_read_b64_tr_b16 v[38:39], v6 offset:23040
  s_waitcnt lgkmcnt(9)
  v_mfma_f32_32x32x16_bf16 v[80:95], v[20:23], v[248:251], v[80:95]
  ds_read_b64_tr_b16 v[40:41], v5 offset:30720
  ds_read_b64_tr_b16 v[42:43], v5 offset:31232
  ds_read_b64_tr_b16 v[44:45], v6 offset:30720
  ds_read_b64_tr_b16 v[46:47], v6 offset:31232
  s_waitcnt lgkmcnt(11)
  v_mfma_f32_32x32x16_bf16 v[96:111], v[24:27], v[248:251], v[96:111]
  s_waitcnt lgkmcnt(9)
  v_mfma_f32_32x32x16_bf16 v[112:127], v[28:31], v[248:251], v[112:127]
  s_waitcnt lgkmcnt(6)
  v_mfma_f32_32x32x16_bf16 v[64:79], v[32:35], v[252:255], v[64:79]
  s_waitcnt lgkmcnt(4)
  v_mfma_f32_32x32x16_bf16 v[80:95], v[36:39], v[252:255], v[80:95]
  s_waitcnt lgkmcnt(2)
  v_mfma_f32_32x32x16_bf16 v[96:111], v[40:43], v[252:255], v[96:111]
  s_waitcnt lgkmcnt(0)
  v_mfma_f32_32x32x16_bf16 v[112:127], v[44:47], v[252:255], v[112:127]
L_c_p1done:
  s_waitcnt vmcnt(0)
  s_cmp_eq_u32 s3, 3
  s_cbranch_scc0 L_c_noep2
  v_readfirstlane_b32 s10, v49
  s_nop 3
  s_cmp_eq_u32 s10, 255
  s_cbranch_scc0 L_c_noep2
  s_add_u32 s10, s32, 1
  v_mov_b32 v12, s10
  v_mov_b32 v13, 16787456
  s_mov_b64 exec, 1
  buffer_store_dword v12, v13, s[68:71], 0 offen sc1
  s_mov_b64 exec, -1
L_c_noep2:
  s_barrier
  s_cmp_lt_u32 s9, 2
  s_cbranch_scc1 L_c_p2V
  ds_read_b64_tr_b16 v[16:17], v5 offset:32768
  ds_read_b64_tr_b16 v[18:19], v5 offset:33280
  ds_read_b64_tr_b16 v[20:21], v6 offset:32768
  ds_read_b64_tr_b16 v[22:23], v6 offset:33280
  s_waitcnt lgkmcnt(2)
  v_mfma_f32_32x32x16_bf16 v[32:47], v[16:19], v[128:131], 0
  ds_read_b64_tr_b16 v[24:25], v5 offset:34816
  ds_read_b64_tr_b16 v[26:27], v5 offset:35328
  s_waitcnt lgkmcnt(2)
  v_mfma_f32_32x32x16_bf16 v[48:63], v[20:23], v[128:131], 0
  ds_read_b64_tr_b16 v[28:29], v6 offset:34816
  ds_read_b64_tr_b16 v[30:31], v6 offset:35328
  s_waitcnt lgkmcnt(2)
  v_mfma_f32_32x32x16_bf16 v[32:47], v[24:27], v[132:135], v[32:47]
  ds_read_b64_tr_b16 v[16:17], v5 offset:36864
  ds_read_b64_tr_b16 v[18:19], v5 offset:37376
  s_waitcnt lgkmcnt(2)
  v_mfma_f32_32x32x16_bf16 v[48:63], v[28:31], v[132:135], v[48:63]
  ds_read_b64_tr_b16 v[20:21], v6 offset:36864
  ds_read_b64_tr_b16 v[22:23], v6 offset:37376
  s_waitcnt lgkmcnt(2)
  v_mfma_f32_32x32x16_bf16 v[32:47], v[16:19], v[136:139], v[32:47]
  ds_read_b64_tr_b16 v[24:25], v5 offset:38912
  ds_read_b64_tr_b16 v[26:27], v5 offset:39424
  s_waitcnt lgkmcnt(2)
  v_mfma_f32_32x32x16_bf16 v[48:63], v[20:23], v[136:139], v[48:63]
  ds_read_b64_tr_b16 v[28:29], v6 offset:38912
  ds_read_b64_tr_b16 v[30:31], v6 offset:39424
  s_waitcnt lgkmcnt(2)
  v_mfma_f32_32x32x16_bf16 v[32:47], v[24:27], v[140:143], v[32:47]
  ds_read_b64_tr_b16 v[16:17], v5 offset:40960
  ds_read_b64_tr_b16 v[18:19], v5 offset:41472
  s_waitcnt lgkmcnt(2)
  v_mfma_f32_32x32x16_bf16 v[48:63], v[28:31], v[140:143], v[48:63]
  ds_read_b64_tr_b16 v[20:21], v6 offset:40960
  ds_read_b64_tr_b16 v[22:23], v6 offset:41472
  s_waitcnt lgkmcnt(2)
  v_mfma_f32_32x32x16_bf16 v[32:47], v[16:19], v[144:147], v[32:47]
  ds_read_b64_tr_b16 v[24:25], v5 offset:43008
  ds_read_b64_tr_b16 v[26:27], v5 offset:43520
  s_waitcnt lgkmcnt(2)
  v_mfma_f32_32x32x16_bf16 v[48:63], v[20:23], v[144:147], v[48:63]
  ds_read_b64_tr_b16 v[28:29], v6 offset:43008
  ds_read_b64_tr_b16 v[30:31], v6 offset:43520
  s_waitcnt lgkmcnt(2)
  v_mfma_f32_32x32x16_bf16 v[32:47], v[24:27], v[148:151], v[32:47]
  ds_read_b64_tr_b16 v[16:17], v5 offset:45056
  ds_read_b64_tr_b16 v[18:19], v5 offset:45568
  s_waitcnt lgkmcnt(2)
  v_mfma_f32_32x32x16_bf16 v[48:63], v[28:31], v[148:151], v[48:63]
  ds_read_b64_tr_b16 v[20:21], v6 offset:45056
  ds_read_b64_tr_b16 v[22:23], v6 offset:45568
  s_waitcnt lgkmcnt(2)
  v_mfma_f32_32x32x16_bf16 v[32:47], v[16:19], v[152:155], v[32:47]
  ds_read_b64_tr_b16 v[24:25], v5 offset:47104
  ds_read_b64_tr_b16 v[26:27], v5 offset:47616
  s_waitcnt lgkmcnt(2)
  v_mfma_f32_32x32x16_bf16 v[48:63], v[20:23], v[152:155], v[48:63]
  ds_read_b64_tr_b16 v[28:29], v6 offset:47104
  ds_read_b64_tr_b16 v[30:31], v6 offset:47616
  s_waitcnt lgkmcnt(0)
  s_barrier
  v_mfma_f32_32x32x16_bf16 v[32:47], v[24:27], v[156:159], v[32:47]
  v_add_u32 v1, 49152, v1
  v_add_u32 v2, 49152, v2
  v_add_u32 v3, 49152, v3
  v_add_u32 v4, 49152, v4
  v_add_u32 v5, 49152, v5
  v_add_u32 v6, 49152, v6
  ds_read_b64_tr_b16 v[16:17], v5 offset:0
  ds_read_b64_tr_b16 v[18:19], v5 offset:512
  v_mfma_f32_32x32x16_bf16 v[48:63], v[28:31], v[156:159], v[48:63]
  ds_read_b64_tr_b16 v[20:21], v6 offset:0
  ds_read_b64_tr_b16 v[22:23], v6 offset:512
  s_waitcnt lgkmcnt(2)
  v_mfma_f32_32x32x16_bf16 v[32:47], v[16:19], v[160:163], v[32:47]
  ds_read_b64_tr_b16 v[24:25], v5 offset:2048
  ds_read_b64_tr_b16 v[26:27], v5 offset:2560
  s_waitcnt lgkmcnt(2)
  v_mfma_f32_32x32x16_bf16 v[48:63], v[20:23], v[160:163], v[48:63]
  ds_read_b64_tr_b16 v[28:29], v6 offset:2048
  ds_read_b64_tr_b16 v[30:31], v6 offset:2560
  s_waitcnt lgkmcnt(2)
  v_mfma_f32_32x32x16_bf16 v[32:47], v[24:27], v[164:167], v[32:47]
  ds_read_b64_tr_b16 v[16:17], v5 offset:4096
  ds_read_b64_tr_b16 v[18:19], v5 offset:4608
  s_waitcnt lgkmcnt(2)
  v_mfma_f32_32x32x16_bf16 v[48:63], v[28:31], v[164:167], v[48:63]
  ds_read_b64_tr_b16 v[20:21], v6 offset:4096
  ds_read_b64_tr_b16 v[22:23], v6 offset:4608
  s_waitcnt lgkmcnt(2)
  v_mfma_f32_32x32x16_bf16 v[32:47], v[16:19], v[168:171], v[32:47]
  ds_read_b64_tr_b16 v[24:25], v5 offset:6144
  ds_read_b64_tr_b16 v[26:27], v5 offset:6656
  s_waitcnt lgkmcnt(2)
  v_mfma_f32_32x32x16_bf16 v[48:63], v[20:23], v[168:171], v[48:63]
  ds_read_b64_tr_b16 v[28:29], v6 offset:6144
  ds_read_b64_tr_b16 v[30:31], v6 offset:6656
  s_waitcnt lgkmcnt(2)
  v_mfma_f32_32x32x16_bf16 v[32:47], v[24:27], v[172:175], v[32:47]
  ds_read_b64_tr_b16 v[16:17], v5 offset:8192
  ds_read_b64_tr_b16 v[18:19], v5 offset:8704
  s_waitcnt lgkmcnt(2)
  v_mfma_f32_32x32x16_bf16 v[48:63], v[28:31], v[172:175], v[48:63]
  ds_read_b64_tr_b16 v[20:21], v6 offset:8192
  ds_read_b64_tr_b16 v[22:23], v6 offset:8704
  s_waitcnt lgkmcnt(2)
  v_mfma_f32_32x32x16_bf16 v[32:47], v[16:19], v[176:179], v[32:47]
  ds_read_b64_tr_b16 v[24:25], v5 offset:10240
  ds_read_b64_tr_b16 v[26:27], v5 offset:10752
  s_waitcnt lgkmcnt(2)
  v_mfma_f32_32x32x16_bf16 v[48:63], v[20:23], v[176:179], v[48:63]
  ds_read_b64_tr_b16 v[28:29], v6 offset:10240
  ds_read_b64_tr_b16 v[30:31], v6 offset:10752
  s_waitcnt lgkmcnt(2)
  v_mfma_f32_32x32x16_bf16 v[32:47], v[24:27], v[180:183], v[32:47]
  ds_read_b64_tr_b16 v[16:17], v5 offset:12288
  ds_read_b64_tr_b16 v[18:19], v5 offset:12800
  s_waitcnt lgkmcnt(2)
  v_mfma_f32_32x32x16_bf16 v[48:63], v[28:31], v[180:183], v[48:63]
  ds_read_b64_tr_b16 v[20:21], v6 offset:12288
  ds_read_b64_tr_b16 v[22:23], v6 offset:12800
  s_waitcnt lgkmcnt(2)
  v_mfma_f32_32x32x16_bf16 v[32:47], v[16:19], v[184:187], v[32:47]
  ds_read_b64_tr_b16 v[24:25], v5 offset:14336
  ds_read_b64_tr_b16 v[26:27], v5 offset:14848
  s_waitcnt lgkmcnt(2)
  v_mfma_f32_32x32x16_bf16 v[48:63], v[20:23], v[184:187], v[48:63]
  ds_read_b64_tr_b16 v[28:29], v6 offset:14336
  ds_read_b64_tr_b16 v[30:31], v6 offset:14848
  s_waitcnt lgkmcnt(0)
  s_barrier
  v_mfma_f32_32x32x16_bf16 v[32:47], v[24:27], v[188:191], v[32:47]
  v_subrev_u32 v1, 147456, v1
  v_subrev_u32 v2, 147456, v2
  v_subrev_u32 v3, 147456, v3
  v_subrev_u32 v4, 147456, v4
  v_subrev_u32 v5, 147456, v5
  v_subrev_u32 v6, 147456, v6
  ds_read_b64_tr_b16 v[16:17], v5 offset:16384
  ds_read_b64_tr_b16 v[18:19], v5 offset:16896
  v_mfma_f32_32x32x16_bf16 v[48:63], v[28:31], v[188:191], v[48:63]
  ds_read_b64_tr_b16 v[20:21], v6 offset:16384
  ds_read_b64_tr_b16 v[22:23], v6 offset:16896
  s_waitcnt lgkmcnt(2)
  v_mfma_f32_32x32x16_bf16 v[32:47], v[16:19], v[192:195], v[32:47]
  ds_read_b64_tr_b16 v[24:25], v5 offset:18432
  ds_read_b64_tr_b16 v[26:27], v5 offset:18944
  s_waitcnt lgkmcnt(2)
  v_mfma_f32_32x32x16_bf16 v[48:63], v[20:23], v[192:195], v[48:63]
  ds_read_b64_tr_b16 v[28:29], v6 offset:18432
  ds_read_b64_tr_b16 v[30:31], v6 offset:18944
  s_waitcnt lgkmcnt(2)
  v_mfma_f32_32x32x16_bf16 v[32:47], v[24:27], v[196:199], v[32:47]
  ds_read_b64_tr_b16 v[16:17], v5 offset:20480
  ds_read_b64_tr_b16 v[18:19], v5 offset:20992
  s_waitcnt lgkmcnt(2)
  v_mfma_f32_32x32x16_bf16 v[48:63], v[28:31], v[196:199], v[48:63]
  ds_read_b64_tr_b16 v[20:21], v6 offset:20480
  ds_read_b64_tr_b16 v[22:23], v6 offset:20992
  s_waitcnt lgkmcnt(2)
  v_mfma_f32_32x32x16_bf16 v[32:47], v[16:19], v[200:203], v[32:47]
  ds_read_b64_tr_b16 v[24:25], v5 offset:22528
  ds_read_b64_tr_b16 v[26:27], v5 offset:23040
  s_waitcnt lgkmcnt(2)
  v_mfma_f32_32x32x16_bf16 v[48:63], v[20:23], v[200:203], v[48:63]
  ds_read_b64_tr_b16 v[28:29], v6 offset:22528
  ds_read_b64_tr_b16 v[30:31], v6 offset:23040
  s_waitcnt lgkmcnt(2)
  v_mfma_f32_32x32x16_bf16 v[32:47], v[24:27], v[204:207], v[32:47]
  ds_read_b64_tr_b16 v[16:17], v5 offset:24576
  ds_read_b64_tr_b16 v[18:19], v5 offset:25088
  s_waitcnt lgkmcnt(2)
  v_mfma_f32_32x32x16_bf16 v[48:63], v[28:31], v[204:207], v[48:63]
  ds_read_b64_tr_b16 v[20:21], v6 offset:24576
  ds_read_b64_tr_b16 v[22:23], v6 offset:25088
  s_waitcnt lgkmcnt(2)
  v_mfma_f32_32x32x16_bf16 v[32:47], v[16:19], v[208:211], v[32:47]
  ds_read_b64_tr_b16 v[24:25], v5 offset:26624
  ds_read_b64_tr_b16 v[26:27], v5 offset:27136
  s_waitcnt lgkmcnt(2)
  v_mfma_f32_32x32x16_bf16 v[48:63], v[20:23], v[208:211], v[48:63]
  ds_read_b64_tr_b16 v[28:29], v6 offset:26624
  ds_read_b64_tr_b16 v[30:31], v6 offset:27136
  s_waitcnt lgkmcnt(2)
  v_mfma_f32_32x32x16_bf16 v[32:47], v[24:27], v[212:215], v[32:47]
  ds_read_b64_tr_b16 v[16:17], v5 offset:28672
  ds_read_b64_tr_b16 v[18:19], v5 offset:29184
  s_waitcnt lgkmcnt(2)
  v_mfma_f32_32x32x16_bf16 v[48:63], v[28:31], v[212:215], v[48:63]
  ds_read_b64_tr_b16 v[20:21], v6 offset:28672
  ds_read_b64_tr_b16 v[22:23], v6 offset:29184
  s_waitcnt lgkmcnt(2)
  v_mfma_f32_32x32x16_bf16 v[32:47], v[16:19], v[216:219], v[32:47]
  ds_read_b64_tr_b16 v[24:25], v5 offset:30720
  ds_read_b64_tr_b16 v[26:27], v5 offset:31232
  s_waitcnt lgkmcnt(2)
  v_mfma_f32_32x32x16_bf16 v[48:63], v[20:23], v[216:219], v[48:63]
  ds_read_b64_tr_b16 v[28:29], v6 offset:30720
  ds_read_b64_tr_b16 v[30:31], v6 offset:31232
  s_waitcnt lgkmcnt(0)
  s_barrier
  v_mfma_f32_32x32x16_bf16 v[32:47], v[24:27], v[220:223], v[32:47]
  ds_read_b64_tr_b16 v[16:17], v5 offset:32768
  ds_read_b64_tr_b16 v[18:19], v5 offset:33280
  v_mfma_f32_32x32x16_bf16 v[48:63], v[28:31], v[220:223], v[48:63]
  ds_read_b64_tr_b16 v[20:21], v6 offset:32768
  ds_read_b64_tr_b16 v[22:23], v6 offset:33280
  s_waitcnt lgkmcnt(2)
  v_mfma_f32_32x32x16_bf16 v[32:47], v[16:19], v[224:227], v[32:47]
  ds_read_b64_tr_b16 v[24:25], v5 offset:34816
  ds_read_b64_tr_b16 v[26:27], v5 offset:35328
  s_waitcnt lgkmcnt(2)
  v_mfma_f32_32x32x16_bf16 v[48:63], v[20:23], v[224:227], v[48:63]
  ds_read_b64_tr_b16 v[28:29], v6 offset:34816
  ds_read_b64_tr_b16 v[30:31], v6 offset:35328
  s_waitcnt lgkmcnt(2)
  v_mfma_f32_32x32x16_bf16 v[32:47], v[24:27], v[228:231], v[32:47]
  ds_read_b64_tr_b16 v[16:17], v5 offset:36864
  ds_read_b64_tr_b16 v[18:19], v5 offset:37376
  s_waitcnt lgkmcnt(2)
  v_mfma_f32_32x32x16_bf16 v[48:63], v[28:31], v[228:231], v[48:63]
  ds_read_b64_tr_b16 v[20:21], v6 offset:36864
  ds_read_b64_tr_b16 v[22:23], v6 offset:37376
  s_waitcnt lgkmcnt(2)
  v_mfma_f32_32x32x16_bf16 v[32:47], v[16:19], v[232:235], v[32:47]
  ds_read_b64_tr_b16 v[24:25], v5 offset:38912
  ds_read_b64_tr_b16 v[26:27], v5 offset:39424
  s_waitcnt lgkmcnt(2)
  v_mfma_f32_32x32x16_bf16 v[48:63], v[20:23], v[232:235], v[48:63]
  ds_read_b64_tr_b16 v[28:29], v6 offset:38912
  ds_read_b64_tr_b16 v[30:31], v6 offset:39424
  s_waitcnt lgkmcnt(2)
  v_mfma_f32_32x32x16_bf16 v[32:47], v[24:27], v[236:239], v[32:47]
  ds_read_b64_tr_b16 v[16:17], v5 offset:40960
  ds_read_b64_tr_b16 v[18:19], v5 offset:41472
  s_waitcnt lgkmcnt(2)
  v_mfma_f32_32x32x16_bf16 v[48:63], v[28:31], v[236:239], v[48:63]
  ds_read_b64_tr_b16 v[20:21], v6 offset:40960
  ds_read_b64_tr_b16 v[22:23], v6 offset:41472
  s_waitcnt lgkmcnt(2)
  v_mfma_f32_32x32x16_bf16 v[32:47], v[16:19], v[240:243], v[32:47]
  ds_read_b64_tr_b16 v[24:25], v5 offset:43008
  ds_read_b64_tr_b16 v[26:27], v5 offset:43520
  s_waitcnt lgkmcnt(2)
  v_mfma_f32_32x32x16_bf16 v[48:63], v[20:23], v[240:243], v[48:63]
  ds_read_b64_tr_b16 v[28:29], v6 offset:43008
  ds_read_b64_tr_b16 v[30:31], v6 offset:43520
  s_waitcnt lgkmcnt(2)
  v_mfma_f32_32x32x16_bf16 v[32:47], v[24:27], v[244:247], v[32:47]
  ds_read_b64_tr_b16 v[16:17], v5 offset:45056
  ds_read_b64_tr_b16 v[18:19], v5 offset:45568
  s_waitcnt lgkmcnt(2)
  v_mfma_f32_32x32x16_bf16 v[48:63], v[28:31], v[244:247], v[48:63]
  ds_read_b64_tr_b16 v[20:21], v6 offset:45056
  ds_read_b64_tr_b16 v[22:23], v6 offset:45568
  s_waitcnt lgkmcnt(2)
  v_mfma_f32_32x32x16_bf16 v[32:47], v[16:19], v[248:251], v[32:47]
  ds_read_b64_tr_b16 v[24:25], v5 offset:47104
  ds_read_b64_tr_b16 v[26:27], v5 offset:47616
  s_waitcnt lgkmcnt(2)
  v_mfma_f32_32x32x16_bf16 v[48:63], v[20:23], v[248:251], v[48:63]
  ds_read_b64_tr_b16 v[28:29], v6 offset:47104
  ds_read_b64_tr_b16 v[30:31], v6 offset:47616
  s_waitcnt lgkmcnt(2)
  v_mfma_f32_32x32x16_bf16 v[32:47], v[24:27], v[252:255], v[32:47]
  s_waitcnt lgkmcnt(0)
  v_mfma_f32_32x32x16_bf16 v[48:63], v[28:31], v[252:255], v[48:63]
  s_branch L_c_p2done
L_c_p2V:
  ds_read_b64_tr_b16 v[16:17], v5 offset:32768
  ds_read_b64_tr_b16 v[18:19], v5 offset:33280
  ds_read_b64_tr_b16 v[20:21], v6 offset:32768
  ds_read_b64_tr_b16 v[22:23], v6 offset:33280
  s_waitcnt lgkmcnt(2)
  v_mfma_f32_32x32x16_bf16 v[32:47], v[128:131], v[16:19], 0
  ds_read_b64_tr_b16 v[24:25], v5 offset:34816
  ds_read_b64_tr_b16 v[26:27], v5 offset:35328
  s_waitcnt lgkmcnt(2)
  v_mfma_f32_32x32x16_bf16 v[48:63], v[128:131], v[20:23], 0
  ds_read_b64_tr_b16 v[28:29], v6 offset:34816
  ds_read_b64_tr_b16 v[30:31], v6 offset:35328
  s_waitcnt lgkmcnt(2)
  v_mfma_f32_32x32x16_bf16 v[32:47], v[132:135], v[24:27], v[32:47]
  ds_read_b64_tr_b16 v[16:17], v5 offset:36864
  ds_read_b64_tr_b16 v[18:19], v5 offset:37376
  s_waitcnt lgkmcnt(2)
  v_mfma_f32_32x32x16_bf16 v[48:63], v[132:135], v[28:31], v[48:63]
  ds_read_b64_tr_b16 v[20:21], v6 offset:36864
  ds_read_b64_tr_b16 v[22:23], v6 offset:37376
  s_waitcnt lgkmcnt(2)
  v_mfma_f32_32x32x16_bf16 v[32:47], v[136:139], v[16:19], v[32:47]
  ds_read_b64_tr_b16 v[24:25], v5 offset:38912
  ds_read_b64_tr_b16 v[26:27], v5 offset:39424
  s_waitcnt lgkmcnt(2)
  v_mfma_f32_32x32x16_bf16 v[48:63], v[136:139], v[20:23], v[48:63]
  ds_read_b64_tr_b16 v[28:29], v6 offset:38912
  ds_read_b64_tr_b16 v[30:31], v6 offset:39424
  s_waitcnt lgkmcnt(2)
  v_mfma_f32_32x32x16_bf16 v[32:47], v[140:143], v[24:27], v[32:47]
  ds_read_b64_tr_b16 v[16:17], v5 offset:40960
  ds_read_b64_tr_b16 v[18:19], v5 offset:41472
  s_waitcnt lgkmcnt(2)
  v_mfma_f32_32x32x16_bf16 v[48:63], v[140:143], v[28:31], v[48:63]
  ds_read_b64_tr_b16 v[20:21], v6 offset:40960
  ds_read_b64_tr_b16 v[22:23], v6 offset:41472
  s_waitcnt lgkmcnt(2)
  v_mfma_f32_32x32x16_bf16 v[32:47], v[144:147], v[16:19], v[32:47]
  ds_read_b64_tr_b16 v[24:25], v5 offset:43008
  ds_read_b64_tr_b16 v[26:27], v5 offset:43520
  s_waitcnt lgkmcnt(2)
  v_mfma_f32_32x32x16_bf16 v[48:63], v[144:147], v[20:23], v[48:63]
  ds_read_b64_tr_b16 v[28:29], v6 offset:43008
  ds_read_b64_tr_b16 v[30:31], v6 offset:43520
  s_waitcnt lgkmcnt(2)
  v_mfma_f32_32x32x16_bf16 v[32:47], v[148:151], v[24:27], v[32:47]
  ds_read_b64_tr_b16 v[16:17], v5 offset:45056
  ds_read_b64_tr_b16 v[18:19], v5 offset:45568
  s_waitcnt lgkmcnt(2)
  v_mfma_f32_32x32x16_bf16 v[48:63], v[148:151], v[28:31], v[48:63]
  ds_read_b64_tr_b16 v[20:21], v6 offset:45056
  ds_read_b64_tr_b16 v[22:23], v6 offset:45568
  s_waitcnt lgkmcnt(2)
  v_mfma_f32_32x32x16_bf16 v[32:47], v[152:155], v[16:19], v[32:47]
  ds_read_b64_tr_b16 v[24:25], v5 offset:47104
  ds_read_b64_tr_b16 v[26:27], v5 offset:47616
  s_waitcnt lgkmcnt(2)
  v_mfma_f32_32x32x16_bf16 v[48:63], v[152:155], v[20:23], v[48:63]
  ds_read_b64_tr_b16 v[28:29], v6 offset:47104
  ds_read_b64_tr_b16 v[30:31], v6 offset:47616
  s_waitcnt lgkmcnt(0)
  s_barrier
  v_mfma_f32_32x32x16_bf16 v[32:47], v[156:159], v[24:27], v[32:47]
  v_add_u32 v1, 49152, v1
  v_add_u32 v2, 49152, v2
  v_add_u32 v3, 49152, v3
  v_add_u32 v4, 49152, v4
  v_add_u32 v5, 49152, v5
  v_add_u32 v6, 49152, v6
  ds_read_b64_tr_b16 v[16:17], v5 offset:0
  ds_read_b64_tr_b16 v[18:19], v5 offset:512
  v_mfma_f32_32x32x16_bf16 v[48:63], v[156:159], v[28:31], v[48:63]
  ds_read_b64_tr_b16 v[20:21], v6 offset:0
  ds_read_b64_tr_b16 v[22:23], v6 offset:512
  s_waitcnt lgkmcnt(2)
  v_mfma_f32_32x32x16_bf16 v[32:47], v[160:163], v[16:19], v[32:47]
  ds_read_b64_tr_b16 v[24:25], v5 offset:2048
  ds_read_b64_tr_b16 v[26:27], v5 offset:2560
  s_waitcnt lgkmcnt(2)
  v_mfma_f32_32x32x16_bf16 v[48:63], v[160:163], v[20:23], v[48:63]
  ds_read_b64_tr_b16 v[28:29], v6 offset:2048
  ds_read_b64_tr_b16 v[30:31], v6 offset:2560
  s_waitcnt lgkmcnt(2)
  v_mfma_f32_32x32x16_bf16 v[32:47], v[164:167], v[24:27], v[32:47]
  ds_read_b64_tr_b16 v[16:17], v5 offset:4096
  ds_read_b64_tr_b16 v[18:19], v5 offset:4608
  s_waitcnt lgkmcnt(2)
  v_mfma_f32_32x32x16_bf16 v[48:63], v[164:167], v[28:31], v[48:63]
  ds_read_b64_tr_b16 v[20:21], v6 offset:4096
  ds_read_b64_tr_b16 v[22:23], v6 offset:4608
  s_waitcnt lgkmcnt(2)
  v_mfma_f32_32x32x16_bf16 v[32:47], v[168:171], v[16:19], v[32:47]
  ds_read_b64_tr_b16 v[24:25], v5 offset:6144
  ds_read_b64_tr_b16 v[26:27], v5 offset:6656
  s_waitcnt lgkmcnt(2)
  v_mfma_f32_32x32x16_bf16 v[48:63], v[168:171], v[20:23], v[48:63]
  ds_read_b64_tr_b16 v[28:29], v6 offset:6144
  ds_read_b64_tr_b16 v[30:31], v6 offset:6656
  s_waitcnt lgkmcnt(2)
  v_mfma_f32_32x32x16_bf16 v[32:47], v[172:175], v[24:27], v[32:47]
  ds_read_b64_tr_b16 v[16:17], v5 offset:8192
  ds_read_b64_tr_b16 v[18:19], v5 offset:8704
  s_waitcnt lgkmcnt(2)
  v_mfma_f32_32x32x16_bf16 v[48:63], v[172:175], v[28:31], v[48:63]
  ds_read_b64_tr_b16 v[20:21], v6 offset:8192
  ds_read_b64_tr_b16 v[22:23], v6 offset:8704
  s_waitcnt lgkmcnt(2)
  v_mfma_f32_32x32x16_bf16 v[32:47], v[176:179], v[16:19], v[32:47]
  ds_read_b64_tr_b16 v[24:25], v5 offset:10240
  ds_read_b64_tr_b16 v[26:27], v5 offset:10752
  s_waitcnt lgkmcnt(2)
  v_mfma_f32_32x32x16_bf16 v[48:63], v[176:179], v[20:23], v[48:63]
  ds_read_b64_tr_b16 v[28:29], v6 offset:10240
  ds_read_b64_tr_b16 v[30:31], v6 offset:10752
  s_waitcnt lgkmcnt(2)
  v_mfma_f32_32x32x16_bf16 v[32:47], v[180:183], v[24:27], v[32:47]
  ds_read_b64_tr_b16 v[16:17], v5 offset:12288
  ds_read_b64_tr_b16 v[18:19], v5 offset:12800
  s_waitcnt lgkmcnt(2)
  v_mfma_f32_32x32x16_bf16 v[48:63], v[180:183], v[28:31], v[48:63]
  ds_read_b64_tr_b16 v[20:21], v6 offset:12288
  ds_read_b64_tr_b16 v[22:23], v6 offset:12800
  s_waitcnt lgkmcnt(2)
  v_mfma_f32_32x32x16_bf16 v[32:47], v[184:187], v[16:19], v[32:47]
  ds_read_b64_tr_b16 v[24:25], v5 offset:14336
  ds_read_b64_tr_b16 v[26:27], v5 offset:14848
  s_waitcnt lgkmcnt(2)
  v_mfma_f32_32x32x16_bf16 v[48:63], v[184:187], v[20:23], v[48:63]
  ds_read_b64_tr_b16 v[28:29], v6 offset:14336
  ds_read_b64_tr_b16 v[30:31], v6 offset:14848
  s_waitcnt lgkmcnt(0)
  s_barrier
  v_mfma_f32_32x32x16_bf16 v[32:47], v[188:191], v[24:27], v[32:47]
  v_subrev_u32 v1, 147456, v1
  v_subrev_u32 v2, 147456, v2
  v_subrev_u32 v3, 147456, v3
  v_subrev_u32 v4, 147456, v4
  v_subrev_u32 v5, 147456, v5
  v_subrev_u32 v6, 147456, v6
  ds_read_b64_tr_b16 v[16:17], v5 offset:16384
  ds_read_b64_tr_b16 v[18:19], v5 offset:16896
  v_mfma_f32_32x32x16_bf16 v[48:63], v[188:191], v[28:31], v[48:63]
  ds_read_b64_tr_b16 v[20:21], v6 offset:16384
  ds_read_b64_tr_b16 v[22:23], v6 offset:16896
  s_waitcnt lgkmcnt(2)
  v_mfma_f32_32x32x16_bf16 v[32:47], v[192:195], v[16:19], v[32:47]
  ds_read_b64_tr_b16 v[24:25], v5 offset:18432
  ds_read_b64_tr_b16 v[26:27], v5 offset:18944
  s_waitcnt lgkmcnt(2)
  v_mfma_f32_32x32x16_bf16 v[48:63], v[192:195], v[20:23], v[48:63]
  ds_read_b64_tr_b16 v[28:29], v6 offset:18432
  ds_read_b64_tr_b16 v[30:31], v6 offset:18944
  s_waitcnt lgkmcnt(2)
  v_mfma_f32_32x32x16_bf16 v[32:47], v[196:199], v[24:27], v[32:47]
  ds_read_b64_tr_b16 v[16:17], v5 offset:20480
  ds_read_b64_tr_b16 v[18:19], v5 offset:20992
  s_waitcnt lgkmcnt(2)
  v_mfma_f32_32x32x16_bf16 v[48:63], v[196:199], v[28:31], v[48:63]
  ds_read_b64_tr_b16 v[20:21], v6 offset:20480
  ds_read_b64_tr_b16 v[22:23], v6 offset:20992
  s_waitcnt lgkmcnt(2)
  v_mfma_f32_32x32x16_bf16 v[32:47], v[200:203], v[16:19], v[32:47]
  ds_read_b64_tr_b16 v[24:25], v5 offset:22528
  ds_read_b64_tr_b16 v[26:27], v5 offset:23040
  s_waitcnt lgkmcnt(2)
  v_mfma_f32_32x32x16_bf16 v[48:63], v[200:203], v[20:23], v[48:63]
  ds_read_b64_tr_b16 v[28:29], v6 offset:22528
  ds_read_b64_tr_b16 v[30:31], v6 offset:23040
  s_waitcnt lgkmcnt(2)
  v_mfma_f32_32x32x16_bf16 v[32:47], v[204:207], v[24:27], v[32:47]
  ds_read_b64_tr_b16 v[16:17], v5 offset:24576
  ds_read_b64_tr_b16 v[18:19], v5 offset:25088
  s_waitcnt lgkmcnt(2)
  v_mfma_f32_32x32x16_bf16 v[48:63], v[204:207], v[28:31], v[48:63]
  ds_read_b64_tr_b16 v[20:21], v6 offset:24576
  ds_read_b64_tr_b16 v[22:23], v6 offset:25088
  s_waitcnt lgkmcnt(2)
  v_mfma_f32_32x32x16_bf16 v[32:47], v[208:211], v[16:19], v[32:47]
  ds_read_b64_tr_b16 v[24:25], v5 offset:26624
  ds_read_b64_tr_b16 v[26:27], v5 offset:27136
  s_waitcnt lgkmcnt(2)
  v_mfma_f32_32x32x16_bf16 v[48:63], v[208:211], v[20:23], v[48:63]
  ds_read_b64_tr_b16 v[28:29], v6 offset:26624
  ds_read_b64_tr_b16 v[30:31], v6 offset:27136
  s_waitcnt lgkmcnt(2)
  v_mfma_f32_32x32x16_bf16 v[32:47], v[212:215], v[24:27], v[32:47]
  ds_read_b64_tr_b16 v[16:17], v5 offset:28672
  ds_read_b64_tr_b16 v[18:19], v5 offset:29184
  s_waitcnt lgkmcnt(2)
  v_mfma_f32_32x32x16_bf16 v[48:63], v[212:215], v[28:31], v[48:63]
  ds_read_b64_tr_b16 v[20:21], v6 offset:28672
  ds_read_b64_tr_b16 v[22:23], v6 offset:29184
  s_waitcnt lgkmcnt(2)
  v_mfma_f32_32x32x16_bf16 v[32:47], v[216:219], v[16:19], v[32:47]
  ds_read_b64_tr_b16 v[24:25], v5 offset:30720
  ds_read_b64_tr_b16 v[26:27], v5 offset:31232
  s_waitcnt lgkmcnt(2)
  v_mfma_f32_32x32x16_bf16 v[48:63], v[216:219], v[20:23], v[48:63]
  ds_read_b64_tr_b16 v[28:29], v6 offset:30720
  ds_read_b64_tr_b16 v[30:31], v6 offset:31232
  s_waitcnt lgkmcnt(0)
  s_barrier
  v_mfma_f32_32x32x16_bf16 v[32:47], v[220:223], v[24:27], v[32:47]
  ds_read_b64_tr_b16 v[16:17], v5 offset:32768
  ds_read_b64_tr_b16 v[18:19], v5 offset:33280
  v_mfma_f32_32x32x16_bf16 v[48:63], v[220:223], v[28:31], v[48:63]
  ds_read_b64_tr_b16 v[20:21], v6 offset:32768
  ds_read_b64_tr_b16 v[22:23], v6 offset:33280
  s_waitcnt lgkmcnt(2)
  v_mfma_f32_32x32x16_bf16 v[32:47], v[224:227], v[16:19], v[32:47]
  ds_read_b64_tr_b16 v[24:25], v5 offset:34816
  ds_read_b64_tr_b16 v[26:27], v5 offset:35328
  s_waitcnt lgkmcnt(2)
  v_mfma_f32_32x32x16_bf16 v[48:63], v[224:227], v[20:23], v[48:63]
  ds_read_b64_tr_b16 v[28:29], v6 offset:34816
  ds_read_b64_tr_b16 v[30:31], v6 offset:35328
  s_waitcnt lgkmcnt(2)
  v_mfma_f32_32x32x16_bf16 v[32:47], v[228:231], v[24:27], v[32:47]
  ds_read_b64_tr_b16 v[16:17], v5 offset:36864
  ds_read_b64_tr_b16 v[18:19], v5 offset:37376
  s_waitcnt lgkmcnt(2)
  v_mfma_f32_32x32x16_bf16 v[48:63], v[228:231], v[28:31], v[48:63]
  ds_read_b64_tr_b16 v[20:21], v6 offset:36864
  ds_read_b64_tr_b16 v[22:23], v6 offset:37376
  s_waitcnt lgkmcnt(2)
  v_mfma_f32_32x32x16_bf16 v[32:47], v[232:235], v[16:19], v[32:47]
  ds_read_b64_tr_b16 v[24:25], v5 offset:38912
  ds_read_b64_tr_b16 v[26:27], v5 offset:39424
  s_waitcnt lgkmcnt(2)
  v_mfma_f32_32x32x16_bf16 v[48:63], v[232:235], v[20:23], v[48:63]
  ds_read_b64_tr_b16 v[28:29], v6 offset:38912
  ds_read_b64_tr_b16 v[30:31], v6 offset:39424
  s_waitcnt lgkmcnt(2)
  v_mfma_f32_32x32x16_bf16 v[32:47], v[236:239], v[24:27], v[32:47]
  ds_read_b64_tr_b16 v[16:17], v5 offset:40960
  ds_read_b64_tr_b16 v[18:19], v5 offset:41472
  s_waitcnt lgkmcnt(2)
  v_mfma_f32_32x32x16_bf16 v[48:63], v[236:239], v[28:31], v[48:63]
  ds_read_b64_tr_b16 v[20:21], v6 offset:40960
  ds_read_b64_tr_b16 v[22:23], v6 offset:41472
  s_waitcnt lgkmcnt(2)
  v_mfma_f32_32x32x16_bf16 v[32:47], v[240:243], v[16:19], v[32:47]
  ds_read_b64_tr_b16 v[24:25], v5 offset:43008
  ds_read_b64_tr_b16 v[26:27], v5 offset:43520
  s_waitcnt lgkmcnt(2)
  v_mfma_f32_32x32x16_bf16 v[48:63], v[240:243], v[20:23], v[48:63]
  ds_read_b64_tr_b16 v[28:29], v6 offset:43008
  ds_read_b64_tr_b16 v[30:31], v6 offset:43520
  s_waitcnt lgkmcnt(2)
  v_mfma_f32_32x32x16_bf16 v[32:47], v[244:247], v[24:27], v[32:47]
  ds_read_b64_tr_b16 v[16:17], v5 offset:45056
  ds_read_b64_tr_b16 v[18:19], v5 offset:45568
  s_waitcnt lgkmcnt(2)
  v_mfma_f32_32x32x16_bf16 v[48:63], v[244:247], v[28:31], v[48:63]
  ds_read_b64_tr_b16 v[20:21], v6 offset:45056
  ds_read_b64_tr_b16 v[22:23], v6 offset:45568
  s_waitcnt lgkmcnt(2)
  v_mfma_f32_32x32x16_bf16 v[32:47], v[248:251], v[16:19], v[32:47]
  ds_read_b64_tr_b16 v[24:25], v5 offset:47104
  ds_read_b64_tr_b16 v[26:27], v5 offset:47616
  s_waitcnt lgkmcnt(2)
  v_mfma_f32_32x32x16_bf16 v[48:63], v[248:251], v[20:23], v[48:63]
  ds_read_b64_tr_b16 v[28:29], v6 offset:47104
  ds_read_b64_tr_b16 v[30:31], v6 offset:47616
  s_waitcnt lgkmcnt(2)
  v_mfma_f32_32x32x16_bf16 v[32:47], v[252:255], v[24:27], v[32:47]
  s_waitcnt lgkmcnt(0)
  v_mfma_f32_32x32x16_bf16 v[48:63], v[252:255], v[28:31], v[48:63]
L_c_p2done:
  s_barrier
  s_cmp_eq_u32 s9, 3
  s_cbranch_scc1 L_c_e1B
  v_and_b32 v12, 31, v0
  s_lshl_b32 s10, s3, 5
  v_add_u32 v13, s10, v12
  v_lshlrev_b32 v13, 4, v13
  ds_read_b128 v[16:19], v13 offset:10240
  v_lshlrev_b32 v12, 4, v0
  ds_read_b128 v[24:27], v12 offset:0
  ds_read_b128 v[28:31], v12 offset:1024
  s_waitcnt lgkmcnt(2)
  v_mov_b32 v20, v16
  v_mov_b32 v21, v16
  v_mov_b32 v22, v16
  v_mov_b32 v23, v16
  s_waitcnt lgkmcnt(1)
  s_nop 0
  v_mfma_f32_32x32x16_bf16 v[64:79], v[24:27], v[20:23], v[64:79]
  ds_read_b128 v[24:27], v12 offset:2048
  s_waitcnt lgkmcnt(1)
  v_mfma_f32_32x32x16_bf16 v[80:95], v[28:31], v[20:23], v[80:95]
  ds_read_b128 v[28:31], v12 offset:3072
  s_waitcnt lgkmcnt(1)
  v_mfma_f32_32x32x16_bf16 v[96:111], v[24:27], v[20:23], v[96:111]
  s_waitcnt lgkmcnt(0)
  v_mfma_f32_32x32x16_bf16 v[112:127], v[28:31], v[20:23], v[112:127]
  v_mul_f32 v19, 0xbfb8aa3b, v17
  s_lshl_b32 s13, s6, 2
  s_add_u32 s13, s13, s3
  s_mul_i32 s13, s13, 147456
  s_lshl_b32 s14, s90, 12
  s_add_u32 s13, s13, s14
  s_add_u32 s13, s13, 6291456
  v_mul_f32 v64, v64, v19
  v_mul_f32 v65, v65, v19
  v_mul_f32 v66, v66, v19
  v_mul_f32 v67, v67, v19
  v_mul_f32 v68, v68, v19
  v_mul_f32 v69, v69, v19
  v_mul_f32 v70, v70, v19
  v_mul_f32 v71, v71, v19
  v_exp_f32 v64, v64
  v_exp_f32 v65, v65
  v_exp_f32 v66, v66
  v_exp_f32 v67, v67
  v_exp_f32 v68, v68
  v_exp_f32 v69, v69
  v_exp_f32 v70, v70
  v_exp_f32 v71, v71
  v_fma_f32 v64, v64, v18, v18
  v_fma_f32 v65, v65, v18, v18
  v_fma_f32 v66, v66, v18, v18
  v_fma_f32 v67, v67, v18, v18
  v_fma_f32 v68, v68, v18, v18
  v_fma_f32 v69, v69, v18, v18
  v_fma_f32 v70, v70, v18, v18
  v_fma_f32 v71, v71, v18, v18
  v_rcp_f32 v64, v64
  v_rcp_f32 v65, v65
  v_rcp_f32 v66, v66
  v_rcp_f32 v67, v67
  v_rcp_f32 v68, v68
  v_rcp_f32 v69, v69
  v_rcp_f32 v70, v70
  v_rcp_f32 v71, v71
  v_mul_f32 v64, v64, v72
  v_mul_f32 v65, v65, v73
  v_mul_f32 v66, v66, v74
  v_mul_f32 v67, v67, v75
  v_mul_f32 v68, v68, v76
  v_mul_f32 v69, v69, v77
  v_mul_f32 v70, v70, v78
  v_mul_f32 v71, v71, v79
  v_cvt_pk_bf16_f32 v72, v64, v65
  v_cvt_pk_bf16_f32 v73, v66, v67
  v_cvt_pk_bf16_f32 v74, v68, v69
  v_cvt_pk_bf16_f32 v75, v70, v71
  buffer_store_dwordx4 v[72:75], v7, s[68:71], s13 offen offset:0 sc1
  v_mul_f32 v80, v80, v19
  v_mul_f32 v81, v81, v19
  v_mul_f32 v82, v82, v19
  v_mul_f32 v83, v83, v19
  v_mul_f32 v84, v84, v19
  v_mul_f32 v85, v85, v19
  v_mul_f32 v86, v86, v19
  v_mul_f32 v87, v87, v19
  v_exp_f32 v80, v80
  v_exp_f32 v81, v81
  v_exp_f32 v82, v82
  v_exp_f32 v83, v83
  v_exp_f32 v84, v84
  v_exp_f32 v85, v85
  v_exp_f32 v86, v86
  v_exp_f32 v87, v87
  v_fma_f32 v80, v80, v18, v18
  v_fma_f32 v81, v81, v18, v18
  v_fma_f32 v82, v82, v18, v18
  v_fma_f32 v83, v83, v18, v18
  v_fma_f32 v84, v84, v18, v18
  v_fma_f32 v85, v85, v18, v18
  v_fma_f32 v86, v86, v18, v18
  v_fma_f32 v87, v87, v18, v18
  v_rcp_f32 v80, v80
  v_rcp_f32 v81, v81
  v_rcp_f32 v82, v82
  v_rcp_f32 v83, v83
  v_rcp_f32 v84, v84
  v_rcp_f32 v85, v85
  v_rcp_f32 v86, v86
  v_rcp_f32 v87, v87
  v_mul_f32 v80, v80, v88
  v_mul_f32 v81, v81, v89
  v_mul_f32 v82, v82, v90
  v_mul_f32 v83, v83, v91
  v_mul_f32 v84, v84, v92
  v_mul_f32 v85, v85, v93
  v_mul_f32 v86, v86, v94
  v_mul_f32 v87, v87, v95
  v_cvt_pk_bf16_f32 v88, v80, v81
  v_cvt_pk_bf16_f32 v89, v82, v83
  v_cvt_pk_bf16_f32 v90, v84, v85
  v_cvt_pk_bf16_f32 v91, v86, v87
  buffer_store_dwordx4 v[88:91], v7, s[68:71], s13 offen offset:1024 sc1
  v_mul_f32 v96, v96, v19
  v_mul_f32 v97, v97, v19
  v_mul_f32 v98, v98, v19
  v_mul_f32 v99, v99, v19
  v_mul_f32 v100, v100, v19
  v_mul_f32 v101, v101, v19
  v_mul_f32 v102, v102, v19
  v_mul_f32 v103, v103, v19
  v_exp_f32 v96, v96
  v_exp_f32 v97, v97
  v_exp_f32 v98, v98
  v_exp_f32 v99, v99
  v_exp_f32 v100, v100
  v_exp_f32 v101, v101
  v_exp_f32 v102, v102
  v_exp_f32 v103, v103
  v_fma_f32 v96, v96, v18, v18
  v_fma_f32 v97, v97, v18, v18
  v_fma_f32 v98, v98, v18, v18
  v_fma_f32 v99, v99, v18, v18
  v_fma_f32 v100, v100, v18, v18
  v_fma_f32 v101, v101, v18, v18
  v_fma_f32 v102, v102, v18, v18
  v_fma_f32 v103, v103, v18, v18
  v_rcp_f32 v96, v96
  v_rcp_f32 v97, v97
  v_rcp_f32 v98, v98
  v_rcp_f32 v99, v99
  v_rcp_f32 v100, v100
  v_rcp_f32 v101, v101
  v_rcp_f32 v102, v102
  v_rcp_f32 v103, v103
  v_mul_f32 v96, v96, v104
  v_mul_f32 v97, v97, v105
  v_mul_f32 v98, v98, v106
  v_mul_f32 v99, v99, v107
  v_mul_f32 v100, v100, v108
  v_mul_f32 v101, v101, v109
  v_mul_f32 v102, v102, v110
  v_mul_f32 v103, v103, v111
  v_cvt_pk_bf16_f32 v104, v96, v97
  v_cvt_pk_bf16_f32 v105, v98, v99
  v_cvt_pk_bf16_f32 v106, v100, v101
  v_cvt_pk_bf16_f32 v107, v102, v103
  buffer_store_dwordx4 v[104:107], v7, s[68:71], s13 offen offset:2048 sc1
  v_mul_f32 v112, v112, v19
  v_mul_f32 v113, v113, v19
  v_mul_f32 v114, v114, v19
  v_mul_f32 v115, v115, v19
  v_mul_f32 v116, v116, v19
  v_mul_f32 v117, v117, v19
  v_mul_f32 v118, v118, v19
  v_mul_f32 v119, v119, v19
  v_exp_f32 v112, v112
  v_exp_f32 v113, v113
  v_exp_f32 v114, v114
  v_exp_f32 v115, v115
  v_exp_f32 v116, v116
  v_exp_f32 v117, v117
  v_exp_f32 v118, v118
  v_exp_f32 v119, v119
  v_fma_f32 v112, v112, v18, v18
  v_fma_f32 v113, v113, v18, v18
  v_fma_f32 v114, v114, v18, v18
  v_fma_f32 v115, v115, v18, v18
  v_fma_f32 v116, v116, v18, v18
  v_fma_f32 v117, v117, v18, v18
  v_fma_f32 v118, v118, v18, v18
  v_fma_f32 v119, v119, v18, v18
  v_rcp_f32 v112, v112
  v_rcp_f32 v113, v113
  v_rcp_f32 v114, v114
  v_rcp_f32 v115, v115
  v_rcp_f32 v116, v116
  v_rcp_f32 v117, v117
  v_rcp_f32 v118, v118
  v_rcp_f32 v119, v119
  v_mul_f32 v112, v112, v120
  v_mul_f32 v113, v113, v121
  v_mul_f32 v114, v114, v122
  v_mul_f32 v115, v115, v123
  v_mul_f32 v116, v116, v124
  v_mul_f32 v117, v117, v125
  v_mul_f32 v118, v118, v126
  v_mul_f32 v119, v119, v127
  v_cvt_pk_bf16_f32 v120, v112, v113
  v_cvt_pk_bf16_f32 v121, v114, v115
  v_cvt_pk_bf16_f32 v122, v116, v117
  v_cvt_pk_bf16_f32 v123, v118, v119
  buffer_store_dwordx4 v[120:123], v7, s[68:71], s13 offen offset:3072 sc1
  s_branch L_c_e1done
L_c_e1B:
  s_lshl_b32 s93, s8, 2
  s_add_u32 s93, s93, 1
  s_add_u32 s94, s93, 1
  v_and_b32 v12, 31, v0
  s_lshl_b32 s10, s3, 5
  v_add_u32 v13, s10, v12
  v_lshlrev_b32 v13, 4, v13
  ds_read_b128 v[16:19], v13 offset:10240
  v_lshlrev_b32 v12, 4, v0
  ds_read_b128 v[24:27], v12 offset:0
  ds_read_b128 v[28:31], v12 offset:1024
  s_waitcnt lgkmcnt(2)
  v_mov_b32 v20, v16
  v_mov_b32 v21, v16
  v_mov_b32 v22, v16
  v_mov_b32 v23, v16
  s_waitcnt lgkmcnt(1)
  s_nop 0
  v_mfma_f32_32x32x16_bf16 v[64:79], v[24:27], v[20:23], v[64:79]
  ds_read_b128 v[24:27], v12 offset:2048
  s_waitcnt lgkmcnt(1)
  v_mfma_f32_32x32x16_bf16 v[80:95], v[28:31], v[20:23], v[80:95]
  ds_read_b128 v[28:31], v12 offset:3072
  s_waitcnt lgkmcnt(1)
  v_mfma_f32_32x32x16_bf16 v[96:111], v[24:27], v[20:23], v[96:111]
  s_waitcnt lgkmcnt(0)
  v_mfma_f32_32x32x16_bf16 v[112:127], v[28:31], v[20:23], v[112:127]
  v_and_b32 v14, 31, v0
  v_lshlrev_b32 v14, 5, v14
  v_lshrrev_b32 v12, 5, v0
  v_lshlrev_b32 v12, 4, v12
  v_add_u32 v14, v14, v12
  s_mov_b32 s12, 0x3eb8aa3b
  s_cmp_lt_u32 s93, 8
  s_cselect_b32 s12, s12, 1.0
  v_mul_f32 v19, s12, v17
  s_lshl_b32 s13, s93, 18
  s_lshl_b32 s14, s6, 12
  s_add_u32 s13, s13, s14
  s_lshl_b32 s14, s3, 10
  s_add_u32 s13, s13, s14
  v_mul_f32 v64, v64, v19
  v_mul_f32 v65, v65, v19
  v_mul_f32 v66, v66, v19
  v_mul_f32 v67, v67, v19
  v_mul_f32 v68, v68, v19
  v_mul_f32 v69, v69, v19
  v_mul_f32 v70, v70, v19
  v_mul_f32 v71, v71, v19
  v_mul_f32 v72, v72, v19
  v_mul_f32 v73, v73, v19
  v_mul_f32 v74, v74, v19
  v_mul_f32 v75, v75, v19
  v_mul_f32 v76, v76, v19
  v_mul_f32 v77, v77, v19
  v_mul_f32 v78, v78, v19
  v_mul_f32 v79, v79, v19
  v_cvt_pk_bf16_f32 v64, v64, v65
  v_cvt_pk_bf16_f32 v65, v66, v67
  v_cvt_pk_bf16_f32 v66, v68, v69
  v_cvt_pk_bf16_f32 v67, v70, v71
  v_cvt_pk_bf16_f32 v68, v72, v73
  v_cvt_pk_bf16_f32 v69, v74, v75
  v_cvt_pk_bf16_f32 v70, v76, v77
  v_cvt_pk_bf16_f32 v71, v78, v79
  buffer_store_dwordx4 v[64:67], v14, s[68:71], s13 offen sc1
  s_add_u32 s13, s13, 65536
  buffer_store_dwordx4 v[68:71], v14, s[68:71], s13 offen sc1
  s_add_u32 s13, s13, 65536
  v_mul_f32 v80, v80, v19
  v_mul_f32 v81, v81, v19
  v_mul_f32 v82, v82, v19
  v_mul_f32 v83, v83, v19
  v_mul_f32 v84, v84, v19
  v_mul_f32 v85, v85, v19
  v_mul_f32 v86, v86, v19
  v_mul_f32 v87, v87, v19
  v_mul_f32 v88, v88, v19
  v_mul_f32 v89, v89, v19
  v_mul_f32 v90, v90, v19
  v_mul_f32 v91, v91, v19
  v_mul_f32 v92, v92, v19
  v_mul_f32 v93, v93, v19
  v_mul_f32 v94, v94, v19
  v_mul_f32 v95, v95, v19
  v_cvt_pk_bf16_f32 v80, v80, v81
  v_cvt_pk_bf16_f32 v81, v82, v83
  v_cvt_pk_bf16_f32 v82, v84, v85
  v_cvt_pk_bf16_f32 v83, v86, v87
  v_cvt_pk_bf16_f32 v84, v88, v89
  v_cvt_pk_bf16_f32 v85, v90, v91
  v_cvt_pk_bf16_f32 v86, v92, v93
  v_cvt_pk_bf16_f32 v87, v94, v95
  buffer_store_dwordx4 v[80:83], v14, s[68:71], s13 offen sc1
  s_add_u32 s13, s13, 65536
  buffer_store_dwordx4 v[84:87], v14, s[68:71], s13 offen sc1
  s_add_u32 s13, s13, 65536
  s_mov_b32 s12, 0x3eb8aa3b
  s_cmp_lt_u32 s94, 8
  s_cselect_b32 s12, s12, 1.0
  v_mul_f32 v19, s12, v17
  s_lshl_b32 s13, s94, 18
  s_lshl_b32 s14, s6, 12
  s_add_u32 s13, s13, s14
  s_lshl_b32 s14, s3, 10
  s_add_u32 s13, s13, s14
  v_mul_f32 v96, v96, v19
  v_mul_f32 v97, v97, v19
  v_mul_f32 v98, v98, v19
  v_mul_f32 v99, v99, v19
  v_mul_f32 v100, v100, v19
  v_mul_f32 v101, v101, v19
  v_mul_f32 v102, v102, v19
  v_mul_f32 v103, v103, v19
  v_mul_f32 v104, v104, v19
  v_mul_f32 v105, v105, v19
  v_mul_f32 v106, v106, v19
  v_mul_f32 v107, v107, v19
  v_mul_f32 v108, v108, v19
  v_mul_f32 v109, v109, v19
  v_mul_f32 v110, v110, v19
  v_mul_f32 v111, v111, v19
  v_cvt_pk_bf16_f32 v96, v96, v97
  v_cvt_pk_bf16_f32 v97, v98, v99
  v_cvt_pk_bf16_f32 v98, v100, v101
  v_cvt_pk_bf16_f32 v99, v102, v103
  v_cvt_pk_bf16_f32 v100, v104, v105
  v_cvt_pk_bf16_f32 v101, v106, v107
  v_cvt_pk_bf16_f32 v102, v108, v109
  v_cvt_pk_bf16_f32 v103, v110, v111
  buffer_store_dwordx4 v[96:99], v14, s[68:71], s13 offen sc1
  s_add_u32 s13, s13, 65536
  buffer_store_dwordx4 v[100:103], v14, s[68:71], s13 offen sc1
  s_add_u32 s13, s13, 65536
  v_mul_f32 v112, v112, v19
  v_mul_f32 v113, v113, v19
  v_mul_f32 v114, v114, v19
  v_mul_f32 v115, v115, v19
  v_mul_f32 v116, v116, v19
  v_mul_f32 v117, v117, v19
  v_mul_f32 v118, v118, v19
  v_mul_f32 v119, v119, v19
  v_mul_f32 v120, v120, v19
  v_mul_f32 v121, v121, v19
  v_mul_f32 v122, v122, v19
  v_mul_f32 v123, v123, v19
  v_mul_f32 v124, v124, v19
  v_mul_f32 v125, v125, v19
  v_mul_f32 v126, v126, v19
  v_mul_f32 v127, v127, v19
  v_cvt_pk_bf16_f32 v112, v112, v113
  v_cvt_pk_bf16_f32 v113, v114, v115
  v_cvt_pk_bf16_f32 v114, v116, v117
  v_cvt_pk_bf16_f32 v115, v118, v119
  v_cvt_pk_bf16_f32 v116, v120, v121
  v_cvt_pk_bf16_f32 v117, v122, v123
  v_cvt_pk_bf16_f32 v118, v124, v125
  v_cvt_pk_bf16_f32 v119, v126, v127
  buffer_store_dwordx4 v[112:115], v14, s[68:71], s13 offen sc1
  s_add_u32 s13, s13, 65536
  buffer_store_dwordx4 v[116:119], v14, s[68:71], s13 offen sc1
  s_add_u32 s13, s13, 65536
L_c_e1done:
  s_nop 15
  s_cmp_lt_u32 s9, 2
  s_cbranch_scc1 L_c_e2V
  v_and_b32 v12, 31, v0
  s_lshl_b32 s10, s3, 5
  v_add_u32 v13, s10, v12
  v_lshlrev_b32 v13, 4, v13
  ds_read_b128 v[16:19], v13 offset:10240
  v_lshlrev_b32 v12, 4, v0
  ds_read_b128 v[24:27], v12 offset:4096
  ds_read_b128 v[28:31], v12 offset:5120
  s_waitcnt lgkmcnt(2)
  v_mov_b32 v20, v16
  v_mov_b32 v21, v16
  v_mov_b32 v22, v16
  v_mov_b32 v23, v16
  s_waitcnt lgkmcnt(1)
  s_nop 0
  v_mfma_f32_32x32x16_bf16 v[32:47], v[24:27], v[20:23], v[32:47]
  s_waitcnt lgkmcnt(0)
  v_mfma_f32_32x32x16_bf16 v[48:63], v[28:31], v[20:23], v[48:63]
  v_and_b32 v14, 31, v0
  v_lshlrev_b32 v14, 5, v14
  v_lshrrev_b32 v12, 5, v0
  v_lshlrev_b32 v12, 4, v12
  v_add_u32 v14, v14, v12
  s_mov_b32 s12, 0x3eb8aa3b
  s_cmp_lt_u32 s92, 8
  s_cselect_b32 s12, s12, 1.0
  v_mul_f32 v19, s12, v17
  s_lshl_b32 s13, s92, 18
  s_lshl_b32 s14, s6, 12
  s_add_u32 s13, s13, s14
  s_lshl_b32 s14, s3, 10
  s_add_u32 s13, s13, s14
  v_mul_f32 v32, v32, v19
  v_mul_f32 v33, v33, v19
  v_mul_f32 v34, v34, v19
  v_mul_f32 v35, v35, v19
  v_mul_f32 v36, v36, v19
  v_mul_f32 v37, v37, v19
  v_mul_f32 v38, v38, v19
  v_mul_f32 v39, v39, v19
  v_mul_f32 v40, v40, v19
  v_mul_f32 v41, v41, v19
  v_mul_f32 v42, v42, v19
  v_mul_f32 v43, v43, v19
  v_mul_f32 v44, v44, v19
  v_mul_f32 v45, v45, v19
  v_mul_f32 v46, v46, v19
  v_mul_f32 v47, v47, v19
  v_cvt_pk_bf16_f32 v32, v32, v33
  v_cvt_pk_bf16_f32 v33, v34, v35
  v_cvt_pk_bf16_f32 v34, v36, v37
  v_cvt_pk_bf16_f32 v35, v38, v39
  v_cvt_pk_bf16_f32 v36, v40, v41
  v_cvt_pk_bf16_f32 v37, v42, v43
  v_cvt_pk_bf16_f32 v38, v44, v45
  v_cvt_pk_bf16_f32 v39, v46, v47
  buffer_store_dwordx4 v[32:35], v14, s[68:71], s13 offen sc1
  s_add_u32 s13, s13, 65536
  buffer_store_dwordx4 v[36:39], v14, s[68:71], s13 offen sc1
  s_add_u32 s13, s13, 65536
  v_mul_f32 v48, v48, v19
  v_mul_f32 v49, v49, v19
  v_mul_f32 v50, v50, v19
  v_mul_f32 v51, v51, v19
  v_mul_f32 v52, v52, v19
  v_mul_f32 v53, v53, v19
  v_mul_f32 v54, v54, v19
  v_mul_f32 v55, v55, v19
  v_mul_f32 v56, v56, v19
  v_mul_f32 v57, v57, v19
  v_mul_f32 v58, v58, v19
  v_mul_f32 v59, v59, v19
  v_mul_f32 v60, v60, v19
  v_mul_f32 v61, v61, v19
  v_mul_f32 v62, v62, v19
  v_mul_f32 v63, v63, v19
  v_cvt_pk_bf16_f32 v48, v48, v49
  v_cvt_pk_bf16_f32 v49, v50, v51
  v_cvt_pk_bf16_f32 v50, v52, v53
  v_cvt_pk_bf16_f32 v51, v54, v55
  v_cvt_pk_bf16_f32 v52, v56, v57
  v_cvt_pk_bf16_f32 v53, v58, v59
  v_cvt_pk_bf16_f32 v54, v60, v61
  v_cvt_pk_bf16_f32 v55, v62, v63
  buffer_store_dwordx4 v[48:51], v14, s[68:71], s13 offen sc1
  s_add_u32 s13, s13, 65536
  buffer_store_dwordx4 v[52:55], v14, s[68:71], s13 offen sc1
  s_add_u32 s13, s13, 65536
  s_branch L_c_e2done
L_c_e2V:
  v_and_b32 v12, 31, v0
  s_lshl_b32 s10, s3, 5
  v_add_u32 v13, s10, v12
  v_lshlrev_b32 v13, 4, v13
  ds_read_b128 v[16:19], v13 offset:10240
  v_lshlrev_b32 v12, 4, v0
  ds_read_b128 v[24:27], v12 offset:4096
  ds_read_b128 v[28:31], v12 offset:5120
  s_waitcnt lgkmcnt(2)
  v_mov_b32 v20, v16
  v_mov_b32 v21, v16
  v_mov_b32 v22, v16
  v_mov_b32 v23, v16
  s_waitcnt lgkmcnt(1)
  s_nop 0
  v_mfma_f32_32x32x16_bf16 v[32:47], v[20:23], v[24:27], v[32:47]
  s_waitcnt lgkmcnt(0)
  v_mfma_f32_32x32x16_bf16 v[48:63], v[20:23], v[28:31], v[48:63]
  v_lshrrev_b32 v12, 5, v0
  v_lshlrev_b32 v12, 4, v12
  s_lshl_b32 s10, s3, 7
  v_add_u32 v12, s10, v12
  ds_read_b128 v[64:67], v12 offset:12288
  ds_read_b128 v[68:71], v12 offset:12320
  ds_read_b128 v[72:75], v12 offset:12352
  ds_read_b128 v[76:79], v12 offset:12384
  v_and_b32 v14, 15, v0
  v_lshlrev_b32 v14, 5, v14
  v_lshrrev_b32 v15, 5, v0
  v_lshlrev_b32 v15, 4, v15
  v_add_u32 v14, v14, v15
  v_lshrrev_b32 v15, 4, v0
  v_and_b32 v15, 1, v15
  v_lshlrev_b32 v15, 16, v15
  v_add_u32 v14, v14, v15
  s_lshl_b32 s13, s92, 18
  s_lshl_b32 s14, s6, 12
  s_add_u32 s13, s13, s14
  s_lshl_b32 s14, s3, 10
  s_add_u32 s13, s13, s14
  s_waitcnt lgkmcnt(0)
  v_mul_f32 v32, v32, v64
  v_mul_f32 v33, v33, v65
  v_mul_f32 v34, v34, v66
  v_mul_f32 v35, v35, v67
  v_mul_f32 v36, v36, v68
  v_mul_f32 v37, v37, v69
  v_mul_f32 v38, v38, v70
  v_mul_f32 v39, v39, v71
  v_mul_f32 v40, v40, v72
  v_mul_f32 v41, v41, v73
  v_mul_f32 v42, v42, v74
  v_mul_f32 v43, v43, v75
  v_mul_f32 v44, v44, v76
  v_mul_f32 v45, v45, v77
  v_mul_f32 v46, v46, v78
  v_mul_f32 v47, v47, v79
  v_cvt_pk_bf16_f32 v32, v32, v33
  v_cvt_pk_bf16_f32 v33, v34, v35
  v_cvt_pk_bf16_f32 v34, v36, v37
  v_cvt_pk_bf16_f32 v35, v38, v39
  v_cvt_pk_bf16_f32 v36, v40, v41
  v_cvt_pk_bf16_f32 v37, v42, v43
  v_cvt_pk_bf16_f32 v38, v44, v45
  v_cvt_pk_bf16_f32 v39, v46, v47
  buffer_store_dwordx4 v[32:35], v14, s[68:71], s13 offen sc1
  buffer_store_dwordx4 v[36:39], v14, s[68:71], s13 offen offset:512 sc1
  s_add_u32 s13, s13, 131072
  v_mul_f32 v48, v48, v64
  v_mul_f32 v49, v49, v65
  v_mul_f32 v50, v50, v66
  v_mul_f32 v51, v51, v67
  v_mul_f32 v52, v52, v68
  v_mul_f32 v53, v53, v69
  v_mul_f32 v54, v54, v70
  v_mul_f32 v55, v55, v71
  v_mul_f32 v56, v56, v72
  v_mul_f32 v57, v57, v73
  v_mul_f32 v58, v58, v74
  v_mul_f32 v59, v59, v75
  v_mul_f32 v60, v60, v76
  v_mul_f32 v61, v61, v77
  v_mul_f32 v62, v62, v78
  v_mul_f32 v63, v63, v79
  v_cvt_pk_bf16_f32 v48, v48, v49
  v_cvt_pk_bf16_f32 v49, v50, v51
  v_cvt_pk_bf16_f32 v50, v52, v53
  v_cvt_pk_bf16_f32 v51, v54, v55
  v_cvt_pk_bf16_f32 v52, v56, v57
  v_cvt_pk_bf16_f32 v53, v58, v59
  v_cvt_pk_bf16_f32 v54, v60, v61
  v_cvt_pk_bf16_f32 v55, v62, v63
  buffer_store_dwordx4 v[48:51], v14, s[68:71], s13 offen sc1
  buffer_store_dwordx4 v[52:55], v14, s[68:71], s13 offen offset:512 sc1
  s_add_u32 s13, s13, 131072
L_c_e2done:
  s_nop 15
  v_add_u32 v1, 49152, v1
  v_add_u32 v2, 49152, v2
  v_add_u32 v3, 49152, v3
  v_add_u32 v4, 49152, v4
  v_add_u32 v5, 49152, v5
  v_add_u32 v6, 49152, v6
  ds_read_b64_tr_b16 v[16:17], v1 offset:0
  ds_read_b64_tr_b16 v[18:19], v1 offset:512
  ds_read_b64_tr_b16 v[20:21], v2 offset:0
  ds_read_b64_tr_b16 v[22:23], v2 offset:512
  ds_read_b64_tr_b16 v[24:25], v3 offset:0
  ds_read_b64_tr_b16 v[26:27], v3 offset:512
  ds_read_b64_tr_b16 v[28:29], v4 offset:0
  ds_read_b64_tr_b16 v[30:31], v4 offset:512
  s_waitcnt lgkmcnt(6)
  v_mfma_f32_32x32x16_bf16 v[64:79], v[16:19], v[128:131], 0
  ds_read_b64_tr_b16 v[32:33], v1 offset:2048
  ds_read_b64_tr_b16 v[34:35], v1 offset:2560
  ds_read_b64_tr_b16 v[36:37], v2 offset:2048
  ds_read_b64_tr_b16 v[38:39], v2 offset:2560
  s_waitcnt lgkmcnt(8)
  v_mfma_f32_32x32x16_bf16 v[80:95], v[20:23], v[128:131], 0
  ds_read_b64_tr_b16 v[40:41], v3 offset:2048
  ds_read_b64_tr_b16 v[42:43], v3 offset:2560
  ds_read_b64_tr_b16 v[44:45], v4 offset:2048
  ds_read_b64_tr_b16 v[46:47], v4 offset:2560
  s_waitcnt lgkmcnt(10)
  v_mfma_f32_32x32x16_bf16 v[96:111], v[24:27], v[128:131], 0
  s_waitcnt lgkmcnt(8)
  v_mfma_f32_32x32x16_bf16 v[112:127], v[28:31], v[128:131], 0
  s_waitcnt lgkmcnt(6)
  v_mfma_f32_32x32x16_bf16 v[64:79], v[32:35], v[132:135], v[64:79]
  ds_read_b64_tr_b16 v[16:17], v1 offset:4096
  ds_read_b64_tr_b16 v[18:19], v1 offset:4608
  ds_read_b64_tr_b16 v[20:21], v2 offset:4096
  ds_read_b64_tr_b16 v[22:23], v2 offset:4608
  s_waitcnt lgkmcnt(8)
  v_mfma_f32_32x32x16_bf16 v[80:95], v[36:39], v[132:135], v[80:95]
  ds_read_b64_tr_b16 v[24:25], v3 offset:4096
  ds_read_b64_tr_b16 v[26:27], v3 offset:4608
  ds_read_b64_tr_b16 v[28:29], v4 offset:4096
  ds_read_b64_tr_b16 v[30:31], v4 offset:4608
  s_waitcnt lgkmcnt(10)
  v_mfma_f32_32x32x16_bf16 v[96:111], v[40:43], v[132:135], v[96:111]
  s_waitcnt lgkmcnt(8)
  v_mfma_f32_32x32x16_bf16 v[112:127], v[44:47], v[132:135], v[112:127]
  s_waitcnt lgkmcnt(6)
  v_mfma_f32_32x32x16_bf16 v[64:79], v[16:19], v[136:139], v[64:79]
  ds_read_b64_tr_b16 v[32:33], v1 offset:6144
  ds_read_b64_tr_b16 v[34:35], v1 offset:6656
  ds_read_b64_tr_b16 v[36:37], v2 offset:6144
  ds_read_b64_tr_b16 v[38:39], v2 offset:6656
  s_waitcnt lgkmcnt(8)
  v_mfma_f32_32x32x16_bf16 v[80:95], v[20:23], v[136:139], v[80:95]
  ds_read_b64_tr_b16 v[40:41], v3 offset:6144
  ds_read_b64_tr_b16 v[42:43], v3 offset:6656
  ds_read_b64_tr_b16 v[44:45], v4 offset:6144
  ds_read_b64_tr_b16 v[46:47], v4 offset:6656
  s_waitcnt lgkmcnt(10)
  v_mfma_f32_32x32x16_bf16 v[96:111], v[24:27], v[136:139], v[96:111]
  s_waitcnt lgkmcnt(8)
  v_mfma_f32_32x32x16_bf16 v[112:127], v[28:31], v[136:139], v[112:127]
  s_waitcnt lgkmcnt(0)
  s_barrier
  v_mfma_f32_32x32x16_bf16 v[64:79], v[32:35], v[140:143], v[64:79]
  ds_read_b64_tr_b16 v[16:17], v1 offset:16384
  ds_read_b64_tr_b16 v[18:19], v1 offset:16896
  ds_read_b64_tr_b16 v[20:21], v2 offset:16384
  ds_read_b64_tr_b16 v[22:23], v2 offset:16896
  v_mfma_f32_32x32x16_bf16 v[80:95], v[36:39], v[140:143], v[80:95]
  ds_read_b64_tr_b16 v[24:25], v3 offset:16384
  ds_read_b64_tr_b16 v[26:27], v3 offset:16896
  ds_read_b64_tr_b16 v[28:29], v4 offset:16384
  ds_read_b64_tr_b16 v[30:31], v4 offset:16896
  v_mfma_f32_32x32x16_bf16 v[96:111], v[40:43], v[140:143], v[96:111]
  v_mfma_f32_32x32x16_bf16 v[112:127], v[44:47], v[140:143], v[112:127]
  s_waitcnt lgkmcnt(6)
  v_mfma_f32_32x32x16_bf16 v[64:79], v[16:19], v[144:147], v[64:79]
  ds_read_b64_tr_b16 v[32:33], v1 offset:18432
  ds_read_b64_tr_b16 v[34:35], v1 offset:18944
  ds_read_b64_tr_b16 v[36:37], v2 offset:18432
  ds_read_b64_tr_b16 v[38:39], v2 offset:18944
  s_waitcnt lgkmcnt(8)
  v_mfma_f32_32x32x16_bf16 v[80:95], v[20:23], v[144:147], v[80:95]
  ds_read_b64_tr_b16 v[40:41], v3 offset:18432
  ds_read_b64_tr_b16 v[42:43], v3 offset:18944
  ds_read_b64_tr_b16 v[44:45], v4 offset:18432
  ds_read_b64_tr_b16 v[46:47], v4 offset:18944
  s_waitcnt lgkmcnt(10)
  v_mfma_f32_32x32x16_bf16 v[96:111], v[24:27], v[144:147], v[96:111]
  s_waitcnt lgkmcnt(8)
  v_mfma_f32_32x32x16_bf16 v[112:127], v[28:31], v[144:147], v[112:127]
  s_waitcnt lgkmcnt(6)
  v_mfma_f32_32x32x16_bf16 v[64:79], v[32:35], v[148:151], v[64:79]
  ds_read_b64_tr_b16 v[16:17], v1 offset:20480
  ds_read_b64_tr_b16 v[18:19], v1 offset:20992
  ds_read_b64_tr_b16 v[20:21], v2 offset:20480
  ds_read_b64_tr_b16 v[22:23], v2 offset:20992
  s_waitcnt lgkmcnt(8)
  v_mfma_f32_32x32x16_bf16 v[80:95], v[36:39], v[148:151], v[80:95]
  ds_read_b64_tr_b16 v[24:25], v3 offset:20480
  ds_read_b64_tr_b16 v[26:27], v3 offset:20992
  ds_read_b64_tr_b16 v[28:29], v4 offset:20480
  ds_read_b64_tr_b16 v[30:31], v4 offset:20992
  s_waitcnt lgkmcnt(10)
  v_mfma_f32_32x32x16_bf16 v[96:111], v[40:43], v[148:151], v[96:111]
  s_waitcnt lgkmcnt(8)
  v_mfma_f32_32x32x16_bf16 v[112:127], v[44:47], v[148:151], v[112:127]
  s_waitcnt lgkmcnt(6)
  v_mfma_f32_32x32x16_bf16 v[64:79], v[16:19], v[152:155], v[64:79]
  ds_read_b64_tr_b16 v[32:33], v1 offset:22528
  ds_read_b64_tr_b16 v[34:35], v1 offset:23040
  ds_read_b64_tr_b16 v[36:37], v2 offset:22528
  ds_read_b64_tr_b16 v[38:39], v2 offset:23040
  s_waitcnt lgkmcnt(8)
  v_mfma_f32_32x32x16_bf16 v[80:95], v[20:23], v[152:155], v[80:95]
  ds_read_b64_tr_b16 v[40:41], v3 offset:22528
  ds_read_b64_tr_b16 v[42:43], v3 offset:23040
  ds_read_b64_tr_b16 v[44:45], v4 offset:22528
  ds_read_b64_tr_b16 v[46:47], v4 offset:23040
  s_waitcnt lgkmcnt(10)
  v_mfma_f32_32x32x16_bf16 v[96:111], v[24:27], v[152:155], v[96:111]
  s_waitcnt lgkmcnt(8)
  v_mfma_f32_32x32x16_bf16 v[112:127], v[28:31], v[152:155], v[112:127]
  s_waitcnt lgkmcnt(0)
  s_waitcnt vmcnt(0)
  s_barrier
  s_cmp_eq_u32 s3, 0
  s_cbranch_scc0 L_c_nof2
  s_lshl_b32 s10, s6, 7
  s_lshl_b32 s12, s7, 2
  s_add_u32 s10, s10, s12
  s_add_u32 s10, s10, 4096
  s_add_u32 s11, s33, 2
  v_mov_b32 v12, s11
  v_mov_b32 v13, s10
  s_mov_b32 s11, 16777216
  s_mov_b64 exec, 1
  buffer_store_dword v12, v13, s[68:71], s11 offen sc1
  s_mov_b64 exec, -1
L_c_nof2:
  v_mfma_f32_32x32x16_bf16 v[64:79], v[32:35], v[156:159], v[64:79]
  ds_read_b64_tr_b16 v[16:17], v1 offset:32768
  ds_read_b64_tr_b16 v[18:19], v1 offset:33280
  ds_read_b64_tr_b16 v[20:21], v2 offset:32768
  ds_read_b64_tr_b16 v[22:23], v2 offset:33280
  v_mfma_f32_32x32x16_bf16 v[80:95], v[36:39], v[156:159], v[80:95]
  ds_read_b64_tr_b16 v[24:25], v3 offset:32768
  ds_read_b64_tr_b16 v[26:27], v3 offset:33280
  ds_read_b64_tr_b16 v[28:29], v4 offset:32768
  ds_read_b64_tr_b16 v[30:31], v4 offset:33280
  v_mfma_f32_32x32x16_bf16 v[96:111], v[40:43], v[156:159], v[96:111]
  v_mfma_f32_32x32x16_bf16 v[112:127], v[44:47], v[156:159], v[112:127]
  s_waitcnt lgkmcnt(6)
  v_mfma_f32_32x32x16_bf16 v[64:79], v[16:19], v[160:163], v[64:79]
  ds_read_b64_tr_b16 v[32:33], v1 offset:34816
  ds_read_b64_tr_b16 v[34:35], v1 offset:35328
  ds_read_b64_tr_b16 v[36:37], v2 offset:34816
  ds_read_b64_tr_b16 v[38:39], v2 offset:35328
  s_waitcnt lgkmcnt(8)
  v_mfma_f32_32x32x16_bf16 v[80:95], v[20:23], v[160:163], v[80:95]
  ds_read_b64_tr_b16 v[40:41], v3 offset:34816
  ds_read_b64_tr_b16 v[42:43], v3 offset:35328
  ds_read_b64_tr_b16 v[44:45], v4 offset:34816
  ds_read_b64_tr_b16 v[46:47], v4 offset:35328
  s_waitcnt lgkmcnt(10)
  v_mfma_f32_32x32x16_bf16 v[96:111], v[24:27], v[160:163], v[96:111]
  s_waitcnt lgkmcnt(8)
  v_mfma_f32_32x32x16_bf16 v[112:127], v[28:31], v[160:163], v[112:127]
  s_waitcnt lgkmcnt(6)
  v_mfma_f32_32x32x16_bf16 v[64:79], v[32:35], v[164:167], v[64:79]
  ds_read_b64_tr_b16 v[16:17], v1 offset:36864
  ds_read_b64_tr_b16 v[18:19], v1 offset:37376
  ds_read_b64_tr_b16 v[20:21], v2 offset:36864
  ds_read_b64_tr_b16 v[22:23], v2 offset:37376
  s_waitcnt lgkmcnt(8)
  v_mfma_f32_32x32x16_bf16 v[80:95], v[36:39], v[164:167], v[80:95]
  ds_read_b64_tr_b16 v[24:25], v3 offset:36864
  ds_read_b64_tr_b16 v[26:27], v3 offset:37376
  ds_read_b64_tr_b16 v[28:29], v4 offset:36864
  ds_read_b64_tr_b16 v[30:31], v4 offset:37376
  s_waitcnt lgkmcnt(10)
  v_mfma_f32_32x32x16_bf16 v[96:111], v[40:43], v[164:167], v[96:111]
  s_waitcnt lgkmcnt(8)
  v_mfma_f32_32x32x16_bf16 v[112:127], v[44:47], v[164:167], v[112:127]
  s_waitcnt lgkmcnt(6)
  v_mfma_f32_32x32x16_bf16 v[64:79], v[16:19], v[168:171], v[64:79]
  ds_read_b64_tr_b16 v[32:33], v1 offset:38912
  ds_read_b64_tr_b16 v[34:35], v1 offset:39424
  ds_read_b64_tr_b16 v[36:37], v2 offset:38912
  ds_read_b64_tr_b16 v[38:39], v2 offset:39424
  s_waitcnt lgkmcnt(8)
  v_mfma_f32_32x32x16_bf16 v[80:95], v[20:23], v[168:171], v[80:95]
  ds_read_b64_tr_b16 v[40:41], v3 offset:38912
  ds_read_b64_tr_b16 v[42:43], v3 offset:39424
  ds_read_b64_tr_b16 v[44:45], v4 offset:38912
  ds_read_b64_tr_b16 v[46:47], v4 offset:39424
  s_waitcnt lgkmcnt(10)
  v_mfma_f32_32x32x16_bf16 v[96:111], v[24:27], v[168:171], v[96:111]
  s_waitcnt lgkmcnt(8)
  v_mfma_f32_32x32x16_bf16 v[112:127], v[28:31], v[168:171], v[112:127]
  s_waitcnt lgkmcnt(6)
  v_mfma_f32_32x32x16_bf16 v[64:79], v[32:35], v[172:175], v[64:79]
  v_add_u32 v1, 49152, v1
  v_add_u32 v2, 49152, v2
  v_add_u32 v3, 49152, v3
  v_add_u32 v4, 49152, v4
  v_add_u32 v5, 49152, v5
  v_add_u32 v6, 49152, v6
  ds_read_b64_tr_b16 v[16:17], v1 offset:0
  ds_read_b64_tr_b16 v[18:19], v1 offset:512
  ds_read_b64_tr_b16 v[20:21], v2 offset:0
  ds_read_b64_tr_b16 v[22:23], v2 offset:512
  s_waitcnt lgkmcnt(8)
  v_mfma_f32_32x32x16_bf16 v[80:95], v[36:39], v[172:175], v[80:95]
  ds_read_b64_tr_b16 v[24:25], v3 offset:0
  ds_read_b64_tr_b16 v[26:27], v3 offset:512
  ds_read_b64_tr_b16 v[28:29], v4 offset:0
  ds_read_b64_tr_b16 v[30:31], v4 offset:512
  s_waitcnt lgkmcnt(10)
  v_mfma_f32_32x32x16_bf16 v[96:111], v[40:43], v[172:175], v[96:111]
  s_waitcnt lgkmcnt(8)
  v_mfma_f32_32x32x16_bf16 v[112:127], v[44:47], v[172:175], v[112:127]
  s_waitcnt lgkmcnt(6)
  v_mfma_f32_32x32x16_bf16 v[64:79], v[16:19], v[176:179], v[64:79]
  ds_read_b64_tr_b16 v[32:33], v1 offset:2048
  ds_read_b64_tr_b16 v[34:35], v1 offset:2560
  ds_read_b64_tr_b16 v[36:37], v2 offset:2048
  ds_read_b64_tr_b16 v[38:39], v2 offset:2560
  s_waitcnt lgkmcnt(8)
  v_mfma_f32_32x32x16_bf16 v[80:95], v[20:23], v[176:179], v[80:95]
  ds_read_b64_tr_b16 v[40:41], v3 offset:2048
  ds_read_b64_tr_b16 v[42:43], v3 offset:2560
  ds_read_b64_tr_b16 v[44:45], v4 offset:2048
  ds_read_b64_tr_b16 v[46:47], v4 offset:2560
  s_waitcnt lgkmcnt(10)
  v_mfma_f32_32x32x16_bf16 v[96:111], v[24:27], v[176:179], v[96:111]
  s_waitcnt lgkmcnt(8)
  v_mfma_f32_32x32x16_bf16 v[112:127], v[28:31], v[176:179], v[112:127]
  s_waitcnt lgkmcnt(6)
  v_mfma_f32_32x32x16_bf16 v[64:79], v[32:35], v[180:183], v[64:79]
  ds_read_b64_tr_b16 v[16:17], v1 offset:4096
  ds_read_b64_tr_b16 v[18:19], v1 offset:4608
  ds_read_b64_tr_b16 v[20:21], v2 offset:4096
  ds_read_b64_tr_b16 v[22:23], v2 offset:4608
  s_waitcnt lgkmcnt(8)
  v_mfma_f32_32x32x16_bf16 v[80:95], v[36:39], v[180:183], v[80:95]
  ds_read_b64_tr_b16 v[24:25], v3 offset:4096
  ds_read_b64_tr_b16 v[26:27], v3 offset:4608
  ds_read_b64_tr_b16 v[28:29], v4 offset:4096
  ds_read_b64_tr_b16 v[30:31], v4 offset:4608
  s_waitcnt lgkmcnt(10)
  v_mfma_f32_32x32x16_bf16 v[96:111], v[40:43], v[180:183], v[96:111]
  s_waitcnt lgkmcnt(8)
  v_mfma_f32_32x32x16_bf16 v[112:127], v[44:47], v[180:183], v[112:127]
  s_waitcnt lgkmcnt(6)
  v_mfma_f32_32x32x16_bf16 v[64:79], v[16:19], v[184:187], v[64:79]
  ds_read_b64_tr_b16 v[32:33], v1 offset:6144
  ds_read_b64_tr_b16 v[34:35], v1 offset:6656
  ds_read_b64_tr_b16 v[36:37], v2 offset:6144
  ds_read_b64_tr_b16 v[38:39], v2 offset:6656
  s_waitcnt lgkmcnt(8)
  v_mfma_f32_32x32x16_bf16 v[80:95], v[20:23], v[184:187], v[80:95]
  ds_read_b64_tr_b16 v[40:41], v3 offset:6144
  ds_read_b64_tr_b16 v[42:43], v3 offset:6656
  ds_read_b64_tr_b16 v[44:45], v4 offset:6144
  ds_read_b64_tr_b16 v[46:47], v4 offset:6656
  s_waitcnt lgkmcnt(10)
  v_mfma_f32_32x32x16_bf16 v[96:111], v[24:27], v[184:187], v[96:111]
  s_waitcnt lgkmcnt(8)
  v_mfma_f32_32x32x16_bf16 v[112:127], v[28:31], v[184:187], v[112:127]
  s_waitcnt lgkmcnt(6)
  v_mfma_f32_32x32x16_bf16 v[64:79], v[32:35], v[188:191], v[64:79]
  ds_read_b64_tr_b16 v[16:17], v1 offset:16384
  ds_read_b64_tr_b16 v[18:19], v1 offset:16896
  ds_read_b64_tr_b16 v[20:21], v2 offset:16384
  ds_read_b64_tr_b16 v[22:23], v2 offset:16896
  s_waitcnt lgkmcnt(8)
  v_mfma_f32_32x32x16_bf16 v[80:95], v[36:39], v[188:191], v[80:95]
  ds_read_b64_tr_b16 v[24:25], v3 offset:16384
  ds_read_b64_tr_b16 v[26:27], v3 offset:16896
  ds_read_b64_tr_b16 v[28:29], v4 offset:16384
  ds_read_b64_tr_b16 v[30:31], v4 offset:16896
  s_waitcnt lgkmcnt(10)
  v_mfma_f32_32x32x16_bf16 v[96:111], v[40:43], v[188:191], v[96:111]
  s_waitcnt lgkmcnt(8)
  v_mfma_f32_32x32x16_bf16 v[112:127], v[44:47], v[188:191], v[112:127]
  s_waitcnt lgkmcnt(6)
  v_mfma_f32_32x32x16_bf16 v[64:79], v[16:19], v[192:195], v[64:79]
  ds_read_b64_tr_b16 v[32:33], v1 offset:18432
  ds_read_b64_tr_b16 v[34:35], v1 offset:18944
  ds_read_b64_tr_b16 v[36:37], v2 offset:18432
  ds_read_b64_tr_b16 v[38:39], v2 offset:18944
  s_waitcnt lgkmcnt(8)
  v_mfma_f32_32x32x16_bf16 v[80:95], v[20:23], v[192:195], v[80:95]
  ds_read_b64_tr_b16 v[40:41], v3 offset:18432
  ds_read_b64_tr_b16 v[42:43], v3 offset:18944
  ds_read_b64_tr_b16 v[44:45], v4 offset:18432
  ds_read_b64_tr_b16 v[46:47], v4 offset:18944
  s_waitcnt lgkmcnt(10)
  v_mfma_f32_32x32x16_bf16 v[96:111], v[24:27], v[192:195], v[96:111]
  s_waitcnt lgkmcnt(8)
  v_mfma_f32_32x32x16_bf16 v[112:127], v[28:31], v[192:195], v[112:127]
  s_waitcnt lgkmcnt(6)
  v_mfma_f32_32x32x16_bf16 v[64:79], v[32:35], v[196:199], v[64:79]
  ds_read_b64_tr_b16 v[16:17], v1 offset:20480
  ds_read_b64_tr_b16 v[18:19], v1 offset:20992
  ds_read_b64_tr_b16 v[20:21], v2 offset:20480
  ds_read_b64_tr_b16 v[22:23], v2 offset:20992
  s_waitcnt lgkmcnt(8)
  v_mfma_f32_32x32x16_bf16 v[80:95], v[36:39], v[196:199], v[80:95]
  ds_read_b64_tr_b16 v[24:25], v3 offset:20480
  ds_read_b64_tr_b16 v[26:27], v3 offset:20992
  ds_read_b64_tr_b16 v[28:29], v4 offset:20480
  ds_read_b64_tr_b16 v[30:31], v4 offset:20992
  s_waitcnt lgkmcnt(10)
  v_mfma_f32_32x32x16_bf16 v[96:111], v[40:43], v[196:199], v[96:111]
  s_waitcnt lgkmcnt(8)
  v_mfma_f32_32x32x16_bf16 v[112:127], v[44:47], v[196:199], v[112:127]
  s_waitcnt lgkmcnt(6)
  v_mfma_f32_32x32x16_bf16 v[64:79], v[16:19], v[200:203], v[64:79]
  ds_read_b64_tr_b16 v[32:33], v1 offset:22528
  ds_read_b64_tr_b16 v[34:35], v1 offset:23040
  ds_read_b64_tr_b16 v[36:37], v2 offset:22528
  ds_read_b64_tr_b16 v[38:39], v2 offset:23040
  s_waitcnt lgkmcnt(8)
  v_mfma_f32_32x32x16_bf16 v[80:95], v[20:23], v[200:203], v[80:95]
  ds_read_b64_tr_b16 v[40:41], v3 offset:22528
  ds_read_b64_tr_b16 v[42:43], v3 offset:23040
  ds_read_b64_tr_b16 v[44:45], v4 offset:22528
  ds_read_b64_tr_b16 v[46:47], v4 offset:23040
  s_waitcnt lgkmcnt(10)
  v_mfma_f32_32x32x16_bf16 v[96:111], v[24:27], v[200:203], v[96:111]
  s_waitcnt lgkmcnt(8)
  v_mfma_f32_32x32x16_bf16 v[112:127], v[28:31], v[200:203], v[112:127]
  s_waitcnt lgkmcnt(6)
  v_mfma_f32_32x32x16_bf16 v[64:79], v[32:35], v[204:207], v[64:79]
  ds_read_b64_tr_b16 v[16:17], v1 offset:32768
  ds_read_b64_tr_b16 v[18:19], v1 offset:33280
  ds_read_b64_tr_b16 v[20:21], v2 offset:32768
  ds_read_b64_tr_b16 v[22:23], v2 offset:33280
  s_waitcnt lgkmcnt(8)
  v_mfma_f32_32x32x16_bf16 v[80:95], v[36:39], v[204:207], v[80:95]
  ds_read_b64_tr_b16 v[24:25], v3 offset:32768
  ds_read_b64_tr_b16 v[26:27], v3 offset:33280
  ds_read_b64_tr_b16 v[28:29], v4 offset:32768
  ds_read_b64_tr_b16 v[30:31], v4 offset:33280
  s_waitcnt lgkmcnt(10)
  v_mfma_f32_32x32x16_bf16 v[96:111], v[40:43], v[204:207], v[96:111]
  s_waitcnt lgkmcnt(8)
  v_mfma_f32_32x32x16_bf16 v[112:127], v[44:47], v[204:207], v[112:127]
  s_waitcnt lgkmcnt(6)
  v_mfma_f32_32x32x16_bf16 v[64:79], v[16:19], v[208:211], v[64:79]
  ds_read_b64_tr_b16 v[32:33], v1 offset:34816
  ds_read_b64_tr_b16 v[34:35], v1 offset:35328
  ds_read_b64_tr_b16 v[36:37], v2 offset:34816
  ds_read_b64_tr_b16 v[38:39], v2 offset:35328
  s_waitcnt lgkmcnt(8)
  v_mfma_f32_32x32x16_bf16 v[80:95], v[20:23], v[208:211], v[80:95]
  ds_read_b64_tr_b16 v[40:41], v3 offset:34816
  ds_read_b64_tr_b16 v[42:43], v3 offset:35328
  ds_read_b64_tr_b16 v[44:45], v4 offset:34816
  ds_read_b64_tr_b16 v[46:47], v4 offset:35328
  s_waitcnt lgkmcnt(10)
  v_mfma_f32_32x32x16_bf16 v[96:111], v[24:27], v[208:211], v[96:111]
  s_waitcnt lgkmcnt(8)
  v_mfma_f32_32x32x16_bf16 v[112:127], v[28:31], v[208:211], v[112:127]
  s_waitcnt lgkmcnt(6)
  v_mfma_f32_32x32x16_bf16 v[64:79], v[32:35], v[212:215], v[64:79]
  ds_read_b64_tr_b16 v[16:17], v1 offset:36864
  ds_read_b64_tr_b16 v[18:19], v1 offset:37376
  ds_read_b64_tr_b16 v[20:21], v2 offset:36864
  ds_read_b64_tr_b16 v[22:23], v2 offset:37376
  s_waitcnt lgkmcnt(8)
  v_mfma_f32_32x32x16_bf16 v[80:95], v[36:39], v[212:215], v[80:95]
  ds_read_b64_tr_b16 v[24:25], v3 offset:36864
  ds_read_b64_tr_b16 v[26:27], v3 offset:37376
  ds_read_b64_tr_b16 v[28:29], v4 offset:36864
  ds_read_b64_tr_b16 v[30:31], v4 offset:37376
  s_waitcnt lgkmcnt(10)
  v_mfma_f32_32x32x16_bf16 v[96:111], v[40:43], v[212:215], v[96:111]
  s_waitcnt lgkmcnt(8)
  v_mfma_f32_32x32x16_bf16 v[112:127], v[44:47], v[212:215], v[112:127]
  s_waitcnt lgkmcnt(6)
  v_mfma_f32_32x32x16_bf16 v[64:79], v[16:19], v[216:219], v[64:79]
  ds_read_b64_tr_b16 v[32:33], v1 offset:38912
  ds_read_b64_tr_b16 v[34:35], v1 offset:39424
  ds_read_b64_tr_b16 v[36:37], v2 offset:38912
  ds_read_b64_tr_b16 v[38:39], v2 offset:39424
  s_waitcnt lgkmcnt(8)
  v_mfma_f32_32x32x16_bf16 v[80:95], v[20:23], v[216:219], v[80:95]
  ds_read_b64_tr_b16 v[40:41], v3 offset:38912
  ds_read_b64_tr_b16 v[42:43], v3 offset:39424
  ds_read_b64_tr_b16 v[44:45], v4 offset:38912
  ds_read_b64_tr_b16 v[46:47], v4 offset:39424
  s_waitcnt lgkmcnt(10)
  v_mfma_f32_32x32x16_bf16 v[96:111], v[24:27], v[216:219], v[96:111]
  s_waitcnt lgkmcnt(8)
  v_mfma_f32_32x32x16_bf16 v[112:127], v[28:31], v[216:219], v[112:127]
  s_waitcnt lgkmcnt(6)
  v_mfma_f32_32x32x16_bf16 v[64:79], v[32:35], v[220:223], v[64:79]
  v_add_u32 v1, 49152, v1
  v_add_u32 v2, 49152, v2
  v_add_u32 v3, 49152, v3
  v_add_u32 v4, 49152, v4
  v_add_u32 v5, 49152, v5
  v_add_u32 v6, 49152, v6
  ds_read_b64_tr_b16 v[16:17], v1 offset:0
  ds_read_b64_tr_b16 v[18:19], v1 offset:512
  ds_read_b64_tr_b16 v[20:21], v2 offset:0
  ds_read_b64_tr_b16 v[22:23], v2 offset:512
  s_waitcnt lgkmcnt(8)
  v_mfma_f32_32x32x16_bf16 v[80:95], v[36:39], v[220:223], v[80:95]
  ds_read_b64_tr_b16 v[24:25], v3 offset:0
  ds_read_b64_tr_b16 v[26:27], v3 offset:512
  ds_read_b64_tr_b16 v[28:29], v4 offset:0
  ds_read_b64_tr_b16 v[30:31], v4 offset:512
  s_waitcnt lgkmcnt(10)
  v_mfma_f32_32x32x16_bf16 v[96:111], v[40:43], v[220:223], v[96:111]
  s_waitcnt lgkmcnt(8)
  v_mfma_f32_32x32x16_bf16 v[112:127], v[44:47], v[220:223], v[112:127]
  s_waitcnt lgkmcnt(6)
  v_mfma_f32_32x32x16_bf16 v[64:79], v[16:19], v[224:227], v[64:79]
  ds_read_b64_tr_b16 v[32:33], v1 offset:2048
  ds_read_b64_tr_b16 v[34:35], v1 offset:2560
  ds_read_b64_tr_b16 v[36:37], v2 offset:2048
  ds_read_b64_tr_b16 v[38:39], v2 offset:2560
  s_waitcnt lgkmcnt(8)
  v_mfma_f32_32x32x16_bf16 v[80:95], v[20:23], v[224:227], v[80:95]
  ds_read_b64_tr_b16 v[40:41], v3 offset:2048
  ds_read_b64_tr_b16 v[42:43], v3 offset:2560
  ds_read_b64_tr_b16 v[44:45], v4 offset:2048
  ds_read_b64_tr_b16 v[46:47], v4 offset:2560
  s_waitcnt lgkmcnt(10)
  v_mfma_f32_32x32x16_bf16 v[96:111], v[24:27], v[224:227], v[96:111]
  s_waitcnt lgkmcnt(8)
  v_mfma_f32_32x32x16_bf16 v[112:127], v[28:31], v[224:227], v[112:127]
  s_waitcnt lgkmcnt(6)
  v_mfma_f32_32x32x16_bf16 v[64:79], v[32:35], v[228:231], v[64:79]
  ds_read_b64_tr_b16 v[16:17], v1 offset:4096
  ds_read_b64_tr_b16 v[18:19], v1 offset:4608
  ds_read_b64_tr_b16 v[20:21], v2 offset:4096
  ds_read_b64_tr_b16 v[22:23], v2 offset:4608
  s_waitcnt lgkmcnt(8)
  v_mfma_f32_32x32x16_bf16 v[80:95], v[36:39], v[228:231], v[80:95]
  ds_read_b64_tr_b16 v[24:25], v3 offset:4096
  ds_read_b64_tr_b16 v[26:27], v3 offset:4608
  ds_read_b64_tr_b16 v[28:29], v4 offset:4096
  ds_read_b64_tr_b16 v[30:31], v4 offset:4608
  s_waitcnt lgkmcnt(10)
  v_mfma_f32_32x32x16_bf16 v[96:111], v[40:43], v[228:231], v[96:111]
  s_waitcnt lgkmcnt(8)
  v_mfma_f32_32x32x16_bf16 v[112:127], v[44:47], v[228:231], v[112:127]
  s_waitcnt lgkmcnt(6)
  v_mfma_f32_32x32x16_bf16 v[64:79], v[16:19], v[232:235], v[64:79]
  ds_read_b64_tr_b16 v[32:33], v1 offset:6144
  ds_read_b64_tr_b16 v[34:35], v1 offset:6656
  ds_read_b64_tr_b16 v[36:37], v2 offset:6144
  ds_read_b64_tr_b16 v[38:39], v2 offset:6656
  s_waitcnt lgkmcnt(8)
  v_mfma_f32_32x32x16_bf16 v[80:95], v[20:23], v[232:235], v[80:95]
  ds_read_b64_tr_b16 v[40:41], v3 offset:6144
  ds_read_b64_tr_b16 v[42:43], v3 offset:6656
  ds_read_b64_tr_b16 v[44:45], v4 offset:6144
  ds_read_b64_tr_b16 v[46:47], v4 offset:6656
  s_waitcnt lgkmcnt(10)
  v_mfma_f32_32x32x16_bf16 v[96:111], v[24:27], v[232:235], v[96:111]
  s_waitcnt lgkmcnt(8)
  v_mfma_f32_32x32x16_bf16 v[112:127], v[28:31], v[232:235], v[112:127]
  s_waitcnt lgkmcnt(6)
  v_mfma_f32_32x32x16_bf16 v[64:79], v[32:35], v[236:239], v[64:79]
  v_subrev_u32 v1, 147456, v1
  v_subrev_u32 v2, 147456, v2
  v_subrev_u32 v3, 147456, v3
  v_subrev_u32 v4, 147456, v4
  v_subrev_u32 v5, 147456, v5
  v_subrev_u32 v6, 147456, v6
  ds_read_b64_tr_b16 v[16:17], v1 offset:16384
  ds_read_b64_tr_b16 v[18:19], v1 offset:16896
  ds_read_b64_tr_b16 v[20:21], v2 offset:16384
  ds_read_b64_tr_b16 v[22:23], v2 offset:16896
  s_waitcnt lgkmcnt(8)
  v_mfma_f32_32x32x16_bf16 v[80:95], v[36:39], v[236:239], v[80:95]
  ds_read_b64_tr_b16 v[24:25], v3 offset:16384
  ds_read_b64_tr_b16 v[26:27], v3 offset:16896
  ds_read_b64_tr_b16 v[28:29], v4 offset:16384
  ds_read_b64_tr_b16 v[30:31], v4 offset:16896
  s_waitcnt lgkmcnt(10)
  v_mfma_f32_32x32x16_bf16 v[96:111], v[40:43], v[236:239], v[96:111]
  s_waitcnt lgkmcnt(8)
  v_mfma_f32_32x32x16_bf16 v[112:127], v[44:47], v[236:239], v[112:127]
  s_waitcnt lgkmcnt(6)
  v_mfma_f32_32x32x16_bf16 v[64:79], v[16:19], v[240:243], v[64:79]
  ds_read_b64_tr_b16 v[32:33], v1 offset:18432
  ds_read_b64_tr_b16 v[34:35], v1 offset:18944
  ds_read_b64_tr_b16 v[36:37], v2 offset:18432
  ds_read_b64_tr_b16 v[38:39], v2 offset:18944
  s_waitcnt lgkmcnt(8)
  v_mfma_f32_32x32x16_bf16 v[80:95], v[20:23], v[240:243], v[80:95]
  ds_read_b64_tr_b16 v[40:41], v3 offset:18432
  ds_read_b64_tr_b16 v[42:43], v3 offset:18944
  ds_read_b64_tr_b16 v[44:45], v4 offset:18432
  ds_read_b64_tr_b16 v[46:47], v4 offset:18944
  s_waitcnt lgkmcnt(10)
  v_mfma_f32_32x32x16_bf16 v[96:111], v[24:27], v[240:243], v[96:111]
  s_waitcnt lgkmcnt(8)
  v_mfma_f32_32x32x16_bf16 v[112:127], v[28:31], v[240:243], v[112:127]
  s_waitcnt lgkmcnt(6)
  v_mfma_f32_32x32x16_bf16 v[64:79], v[32:35], v[244:247], v[64:79]
  ds_read_b64_tr_b16 v[16:17], v1 offset:20480
  ds_read_b64_tr_b16 v[18:19], v1 offset:20992
  ds_read_b64_tr_b16 v[20:21], v2 offset:20480
  ds_read_b64_tr_b16 v[22:23], v2 offset:20992
  s_waitcnt lgkmcnt(8)
  v_mfma_f32_32x32x16_bf16 v[80:95], v[36:39], v[244:247], v[80:95]
  ds_read_b64_tr_b16 v[24:25], v3 offset:20480
  ds_read_b64_tr_b16 v[26:27], v3 offset:20992
  ds_read_b64_tr_b16 v[28:29], v4 offset:20480
  ds_read_b64_tr_b16 v[30:31], v4 offset:20992
  s_waitcnt lgkmcnt(10)
  v_mfma_f32_32x32x16_bf16 v[96:111], v[40:43], v[244:247], v[96:111]
  s_waitcnt lgkmcnt(8)
  v_mfma_f32_32x32x16_bf16 v[112:127], v[44:47], v[244:247], v[112:127]
  s_waitcnt lgkmcnt(6)
  v_mfma_f32_32x32x16_bf16 v[64:79], v[16:19], v[248:251], v[64:79]
  ds_read_b64_tr_b16 v[32:33], v1 offset:22528
  ds_read_b64_tr_b16 v[34:35], v1 offset:23040
  ds_read_b64_tr_b16 v[36:37], v2 offset:22528
  ds_read_b64_tr_b16 v[38:39], v2 offset:23040
  s_waitcnt lgkmcnt(8)
  v_mfma_f32_32x32x16_bf16 v[80:95], v[20:23], v[248:251], v[80:95]
  ds_read_b64_tr_b16 v[40:41], v3 offset:22528
  ds_read_b64_tr_b16 v[42:43], v3 offset:23040
  ds_read_b64_tr_b16 v[44:45], v4 offset:22528
  ds_read_b64_tr_b16 v[46:47], v4 offset:23040
  s_waitcnt lgkmcnt(10)
  v_mfma_f32_32x32x16_bf16 v[96:111], v[24:27], v[248:251], v[96:111]
  s_waitcnt lgkmcnt(8)
  v_mfma_f32_32x32x16_bf16 v[112:127], v[28:31], v[248:251], v[112:127]
  s_waitcnt lgkmcnt(6)
  v_mfma_f32_32x32x16_bf16 v[64:79], v[32:35], v[252:255], v[64:79]
  s_waitcnt lgkmcnt(4)
  v_mfma_f32_32x32x16_bf16 v[80:95], v[36:39], v[252:255], v[80:95]
  s_waitcnt lgkmcnt(2)
  v_mfma_f32_32x32x16_bf16 v[96:111], v[40:43], v[252:255], v[96:111]
  s_waitcnt lgkmcnt(0)
  v_mfma_f32_32x32x16_bf16 v[112:127], v[44:47], v[252:255], v[112:127]
  v_mov_b32 v12, 12808
  v_mov_b32 v13, 1
  s_mov_b64 exec, 1
  ds_add_u32 v12, v13
  s_mov_b64 exec, -1
  v_and_b32 v12, 31, v0
  s_lshl_b32 s10, s3, 5
  v_add_u32 v13, s10, v12
  v_lshlrev_b32 v13, 4, v13
  ds_read_b128 v[16:19], v13 offset:10240
  v_lshlrev_b32 v12, 4, v0
  ds_read_b128 v[24:27], v12 offset:6144
  ds_read_b128 v[28:31], v12 offset:7168
  s_waitcnt lgkmcnt(2)
  v_mov_b32 v20, v16
  v_mov_b32 v21, v16
  v_mov_b32 v22, v16
  v_mov_b32 v23, v16
  s_waitcnt lgkmcnt(1)
  s_nop 0
  v_mfma_f32_32x32x16_bf16 v[64:79], v[24:27], v[20:23], v[64:79]
  ds_read_b128 v[24:27], v12 offset:8192
  s_waitcnt lgkmcnt(1)
  v_mfma_f32_32x32x16_bf16 v[80:95], v[28:31], v[20:23], v[80:95]
  ds_read_b128 v[28:31], v12 offset:9216
  s_waitcnt lgkmcnt(1)
  v_mfma_f32_32x32x16_bf16 v[96:111], v[24:27], v[20:23], v[96:111]
  s_waitcnt lgkmcnt(0)
  v_mfma_f32_32x32x16_bf16 v[112:127], v[28:31], v[20:23], v[112:127]
  v_mul_f32 v19, 0xbfb8aa3b, v17
  s_lshl_b32 s13, s6, 2
  s_add_u32 s13, s13, s3
  s_mul_i32 s13, s13, 147456
  s_lshl_b32 s14, s91, 12
  s_add_u32 s13, s13, s14
  s_add_u32 s13, s13, 6291456
  v_mul_f32 v64, v64, v19
  v_mul_f32 v65, v65, v19
  v_mul_f32 v66, v66, v19
  v_mul_f32 v67, v67, v19
  v_mul_f32 v68, v68, v19
  v_mul_f32 v69, v69, v19
  v_mul_f32 v70, v70, v19
  v_mul_f32 v71, v71, v19
  v_exp_f32 v64, v64
  v_exp_f32 v65, v65
  v_exp_f32 v66, v66
  v_exp_f32 v67, v67
  v_exp_f32 v68, v68
  v_exp_f32 v69, v69
  v_exp_f32 v70, v70
  v_exp_f32 v71, v71
  v_fma_f32 v64, v64, v18, v18
  v_fma_f32 v65, v65, v18, v18
  v_fma_f32 v66, v66, v18, v18
  v_fma_f32 v67, v67, v18, v18
  v_fma_f32 v68, v68, v18, v18
  v_fma_f32 v69, v69, v18, v18
  v_fma_f32 v70, v70, v18, v18
  v_fma_f32 v71, v71, v18, v18
  v_rcp_f32 v64, v64
  v_rcp_f32 v65, v65
  v_rcp_f32 v66, v66
  v_rcp_f32 v67, v67
  v_rcp_f32 v68, v68
  v_rcp_f32 v69, v69
  v_rcp_f32 v70, v70
  v_rcp_f32 v71, v71
  v_mul_f32 v64, v64, v72
  v_mul_f32 v65, v65, v73
  v_mul_f32 v66, v66, v74
  v_mul_f32 v67, v67, v75
  v_mul_f32 v68, v68, v76
  v_mul_f32 v69, v69, v77
  v_mul_f32 v70, v70, v78
  v_mul_f32 v71, v71, v79
  v_cvt_pk_bf16_f32 v72, v64, v65
  v_cvt_pk_bf16_f32 v73, v66, v67
  v_cvt_pk_bf16_f32 v74, v68, v69
  v_cvt_pk_bf16_f32 v75, v70, v71
  buffer_store_dwordx4 v[72:75], v7, s[68:71], s13 offen offset:0 sc1
  v_mul_f32 v80, v80, v19
  v_mul_f32 v81, v81, v19
  v_mul_f32 v82, v82, v19
  v_mul_f32 v83, v83, v19
  v_mul_f32 v84, v84, v19
  v_mul_f32 v85, v85, v19
  v_mul_f32 v86, v86, v19
  v_mul_f32 v87, v87, v19
  v_exp_f32 v80, v80
  v_exp_f32 v81, v81
  v_exp_f32 v82, v82
  v_exp_f32 v83, v83
  v_exp_f32 v84, v84
  v_exp_f32 v85, v85
  v_exp_f32 v86, v86
  v_exp_f32 v87, v87
  v_fma_f32 v80, v80, v18, v18
  v_fma_f32 v81, v81, v18, v18
  v_fma_f32 v82, v82, v18, v18
  v_fma_f32 v83, v83, v18, v18
  v_fma_f32 v84, v84, v18, v18
  v_fma_f32 v85, v85, v18, v18
  v_fma_f32 v86, v86, v18, v18
  v_fma_f32 v87, v87, v18, v18
  v_rcp_f32 v80, v80
  v_rcp_f32 v81, v81
  v_rcp_f32 v82, v82
  v_rcp_f32 v83, v83
  v_rcp_f32 v84, v84
  v_rcp_f32 v85, v85
  v_rcp_f32 v86, v86
  v_rcp_f32 v87, v87
  v_mul_f32 v80, v80, v88
  v_mul_f32 v81, v81, v89
  v_mul_f32 v82, v82, v90
  v_mul_f32 v83, v83, v91
  v_mul_f32 v84, v84, v92
  v_mul_f32 v85, v85, v93
  v_mul_f32 v86, v86, v94
  v_mul_f32 v87, v87, v95
  v_cvt_pk_bf16_f32 v88, v80, v81
  v_cvt_pk_bf16_f32 v89, v82, v83
  v_cvt_pk_bf16_f32 v90, v84, v85
  v_cvt_pk_bf16_f32 v91, v86, v87
  buffer_store_dwordx4 v[88:91], v7, s[68:71], s13 offen offset:1024 sc1
  v_mul_f32 v96, v96, v19
  v_mul_f32 v97, v97, v19
  v_mul_f32 v98, v98, v19
  v_mul_f32 v99, v99, v19
  v_mul_f32 v100, v100, v19
  v_mul_f32 v101, v101, v19
  v_mul_f32 v102, v102, v19
  v_mul_f32 v103, v103, v19
  v_exp_f32 v96, v96
  v_exp_f32 v97, v97
  v_exp_f32 v98, v98
  v_exp_f32 v99, v99
  v_exp_f32 v100, v100
  v_exp_f32 v101, v101
  v_exp_f32 v102, v102
  v_exp_f32 v103, v103
  v_fma_f32 v96, v96, v18, v18
  v_fma_f32 v97, v97, v18, v18
  v_fma_f32 v98, v98, v18, v18
  v_fma_f32 v99, v99, v18, v18
  v_fma_f32 v100, v100, v18, v18
  v_fma_f32 v101, v101, v18, v18
  v_fma_f32 v102, v102, v18, v18
  v_fma_f32 v103, v103, v18, v18
  v_rcp_f32 v96, v96
  v_rcp_f32 v97, v97
  v_rcp_f32 v98, v98
  v_rcp_f32 v99, v99
  v_rcp_f32 v100, v100
  v_rcp_f32 v101, v101
  v_rcp_f32 v102, v102
  v_rcp_f32 v103, v103
  v_mul_f32 v96, v96, v104
  v_mul_f32 v97, v97, v105
  v_mul_f32 v98, v98, v106
  v_mul_f32 v99, v99, v107
  v_mul_f32 v100, v100, v108
  v_mul_f32 v101, v101, v109
  v_mul_f32 v102, v102, v110
  v_mul_f32 v103, v103, v111
  v_cvt_pk_bf16_f32 v104, v96, v97
  v_cvt_pk_bf16_f32 v105, v98, v99
  v_cvt_pk_bf16_f32 v106, v100, v101
  v_cvt_pk_bf16_f32 v107, v102, v103
  buffer_store_dwordx4 v[104:107], v7, s[68:71], s13 offen offset:2048 sc1
  v_mul_f32 v112, v112, v19
  v_mul_f32 v113, v113, v19
  v_mul_f32 v114, v114, v19
  v_mul_f32 v115, v115, v19
  v_mul_f32 v116, v116, v19
  v_mul_f32 v117, v117, v19
  v_mul_f32 v118, v118, v19
  v_mul_f32 v119, v119, v19
  v_exp_f32 v112, v112
  v_exp_f32 v113, v113
  v_exp_f32 v114, v114
  v_exp_f32 v115, v115
  v_exp_f32 v116, v116
  v_exp_f32 v117, v117
  v_exp_f32 v118, v118
  v_exp_f32 v119, v119
  v_fma_f32 v112, v112, v18, v18
  v_fma_f32 v113, v113, v18, v18
  v_fma_f32 v114, v114, v18, v18
  v_fma_f32 v115, v115, v18, v18
  v_fma_f32 v116, v116, v18, v18
  v_fma_f32 v117, v117, v18, v18
  v_fma_f32 v118, v118, v18, v18
  v_fma_f32 v119, v119, v18, v18
  v_rcp_f32 v112, v112
  v_rcp_f32 v113, v113
  v_rcp_f32 v114, v114
  v_rcp_f32 v115, v115
  v_rcp_f32 v116, v116
  v_rcp_f32 v117, v117
  v_rcp_f32 v118, v118
  v_rcp_f32 v119, v119
  v_mul_f32 v112, v112, v120
  v_mul_f32 v113, v113, v121
  v_mul_f32 v114, v114, v122
  v_mul_f32 v115, v115, v123
  v_mul_f32 v116, v116, v124
  v_mul_f32 v117, v117, v125
  v_mul_f32 v118, v118, v126
  v_mul_f32 v119, v119, v127
  v_cvt_pk_bf16_f32 v120, v112, v113
  v_cvt_pk_bf16_f32 v121, v114, v115
  v_cvt_pk_bf16_f32 v122, v116, v117
  v_cvt_pk_bf16_f32 v123, v118, v119
  buffer_store_dwordx4 v[120:123], v7, s[68:71], s13 offen offset:3072 sc1
  v_mov_b32 v12, 12808
  s_mov_b32 s15, 0
L_cbar:
  s_add_u32 s15, s15, 1
  s_cmp_gt_u32 s15, 1000000
  s_cbranch_scc1 L_cbar_ok
  ds_read_b32 v13, v12
  s_waitcnt lgkmcnt(0)
  v_readfirstlane_b32 s10, v13
  s_nop 3
  s_cmp_ge_u32 s10, 4
  s_cbranch_scc1 L_cbar_ok
  s_sleep 1
  s_branch L_cbar
L_cbar_ok:
  s_mul_i32 s88, s3, 24576
  s_add_u32 s88, s88, 16384
  s_mul_i32 s89, s86, 294912
  s_add_u32 s89, s89, 6291456
  s_mul_i32 s10, s3, 28672
  s_add_u32 s84, s89, s10
  s_lshl_b32 s10, s3, 13
  s_add_u32 s85, s89, s10
  s_add_u32 s85, s85, 114688
  s_lshl_b32 s11, s87, 7
  s_mul_i32 s10, s3, 458752
  s_add_u32 s82, s10, s11
  s_lshl_b32 s10, s3, 17
  s_add_u32 s83, s10, s11
  v_lshrrev_b32 v128, 3, v0
  v_lshlrev_b32 v128, 10, v128
  v_and_b32 v129, 7, v0
  v_lshrrev_b32 v130, 4, v0
  v_and_b32 v130, 1, v130
  v_lshlrev_b32 v130, 2, v130
  v_xor_b32 v129, v129, v130
  v_lshlrev_b32 v129, 4, v129
  v_add_u32 v242, v128, v129
  v_lshlrev_b32 v243, 4, v0
  v_lshrrev_b32 v128, 4, v0
  v_and_b32 v129, 1, v128
  v_lshrrev_b32 v130, 1, v128
  v_and_b32 v131, 15, v0
  v_lshrrev_b32 v132, 2, v131
  v_and_b32 v133, 3, v131
  v_lshlrev_b32 v134, 2, v130
  v_add_u32 v134, v134, v132
  v_lshlrev_b32 v134, 7, v134
  v_and_b32 v135, 1, v133
  v_lshlrev_b32 v135, 3, v135
  v_add_u32 v134, v134, v135
  v_lshrrev_b32 v135, 1, v133
  v_lshlrev_b32 v135, 4, v135
  v_lshrrev_b32 v136, 1, v132
  v_lshlrev_b32 v136, 6, v136
  v_xor_b32 v135, v135, v136
  v_lshlrev_b32 v136, 5, v129
  v_xor_b32 v135, v135, v136
  v_add_u32 v134, v134, v135
  v_add_u32 v240, s88, v134
  v_xor_b32 v241, 64, v240
  s_waitcnt vmcnt(0)
  v_mov_b32 v12, 12816
  v_mov_b32 v13, 1
  s_mov_b64 exec, 1
  ds_add_rtn_u32 v13, v12, v13
  s_waitcnt lgkmcnt(0)
  s_mov_b64 exec, -1
  v_readfirstlane_b32 s10, v13
  s_nop 3
  s_cmp_eq_u32 s10, 3
  s_cbranch_scc0 L_c_fl2_skip
  s_lshl_b32 s10, s6, 7
  s_lshl_b32 s12, s7, 2
  s_add_u32 s10, s10, s12
  s_add_u32 s10, s10, 6144
  s_add_u32 s11, s33, 3
  v_mov_b32 v12, s11
  v_mov_b32 v13, s10
  s_mov_b32 s11, 16777216
  s_mov_b64 exec, 1
  buffer_store_dword v12, v13, s[68:71], s11 offen sc1
  s_mov_b64 exec, -1
L_c_fl2_skip:
  v_mov_b32 v12, 12852
  s_mov_b32 s15, 0
L_c_prio:
  s_add_u32 s15, s15, 1
  s_cmp_gt_u32 s15, 1000000
  s_cbranch_scc1 L_c_prio_ok
  ds_read_b32 v13, v12
  s_waitcnt lgkmcnt(0)
  v_readfirstlane_b32 s10, v13
  s_nop 3
  s_cmp_ge_u32 s10, 4
  s_cbranch_scc1 L_c_prio_ok
  s_sleep 1
  s_branch L_c_prio
L_c_prio_ok:
  s_add_u32 s10, s82, 0
  s_add_u32 m0, s88, 0
  s_add_u32 s11, s10, 8192
  buffer_load_dwordx4 v242, s[56:59], s10 offen lds
  s_add_u32 m0, s88, 1024
  s_nop 0
  buffer_load_dwordx4 v242, s[56:59], s11 offen lds
  s_add_u32 s10, s82, 16384
  s_add_u32 m0, s88, 2048
  s_add_u32 s11, s10, 8192
  buffer_load_dwordx4 v242, s[56:59], s10 offen lds
  s_add_u32 m0, s88, 3072
  s_nop 0
  buffer_load_dwordx4 v242, s[56:59], s11 offen lds
  s_add_u32 s10, s82, 32768
  s_add_u32 m0, s88, 4096
  s_add_u32 s11, s10, 8192
  buffer_load_dwordx4 v242, s[56:59], s10 offen lds
  s_add_u32 m0, s88, 5120
  s_nop 0
  buffer_load_dwordx4 v242, s[56:59], s11 offen lds
  s_add_u32 s10, s82, 49152
  s_add_u32 m0, s88, 6144
  s_add_u32 s11, s10, 8192
  buffer_load_dwordx4 v242, s[56:59], s10 offen lds
  s_add_u32 m0, s88, 7168
  s_nop 0
  buffer_load_dwordx4 v242, s[56:59], s11 offen lds
  s_add_u32 s10, s82, 131072
  s_add_u32 m0, s88, 8192
  s_add_u32 s11, s10, 8192
  buffer_load_dwordx4 v242, s[56:59], s10 offen lds
  s_add_u32 m0, s88, 9216
  s_nop 0
  buffer_load_dwordx4 v242, s[56:59], s11 offen lds
  s_add_u32 s10, s82, 147456
  s_add_u32 m0, s88, 10240
  s_add_u32 s11, s10, 8192
  buffer_load_dwordx4 v242, s[56:59], s10 offen lds
  s_add_u32 m0, s88, 11264
  s_nop 0
  buffer_load_dwordx4 v242, s[56:59], s11 offen lds
  s_add_u32 s10, s82, 163840
  s_add_u32 m0, s88, 12288
  s_add_u32 s11, s10, 8192
  buffer_load_dwordx4 v242, s[56:59], s10 offen lds
  s_add_u32 m0, s88, 13312
  s_nop 0
  buffer_load_dwordx4 v242, s[56:59], s11 offen lds
  s_add_u32 s10, s82, 180224
  s_add_u32 m0, s88, 14336
  s_add_u32 s11, s10, 8192
  buffer_load_dwordx4 v242, s[56:59], s10 offen lds
  s_add_u32 m0, s88, 15360
  s_nop 0
  buffer_load_dwordx4 v242, s[56:59], s11 offen lds
  s_add_u32 s10, s82, 262144
  s_add_u32 m0, s88, 16384
  s_add_u32 s11, s10, 8192
  buffer_load_dwordx4 v242, s[56:59], s10 offen lds
  s_add_u32 m0, s88, 17408
  s_nop 0
  buffer_load_dwordx4 v242, s[56:59], s11 offen lds
  s_add_u32 s10, s82, 278528
  s_add_u32 m0, s88, 18432
  s_add_u32 s11, s10, 8192
  buffer_load_dwordx4 v242, s[56:59], s10 offen lds
  s_add_u32 m0, s88, 19456
  s_nop 0
  buffer_load_dwordx4 v242, s[56:59], s11 offen lds
  s_add_u32 s10, s82, 294912
  s_add_u32 m0, s88, 20480
  s_add_u32 s11, s10, 8192
  buffer_load_dwordx4 v242, s[56:59], s10 offen lds
  s_add_u32 m0, s88, 21504
  s_nop 0
  buffer_load_dwordx4 v242, s[56:59], s11 offen lds
  s_add_u32 s10, s82, 311296
  s_add_u32 m0, s88, 22528
  s_add_u32 s11, s10, 8192
  buffer_load_dwordx4 v242, s[56:59], s10 offen lds
  s_add_u32 m0, s88, 23552
  s_nop 0
  buffer_load_dwordx4 v242, s[56:59], s11 offen lds
  s_cmp_eq_u32 s3, 0
  s_cbranch_scc0 L_fw_f0_np
  s_lshr_b32 s10, s86, 1
  s_add_u32 s10, s10, 32
  s_lshl_b32 s10, s10, 7
  v_lshlrev_b32 v245, 2, v0
  v_add_u32 v245, s10, v245
  s_add_u32 s13, s33, 2
  s_mov_b32 s14, 16777216
  s_mov_b32 s15, 0
L_fw_f0:
  s_add_u32 s15, s15, 1
  s_cmp_gt_u32 s15, 100000
  s_cbranch_scc1 L_fw_f0_ok
  buffer_load_dword v244, v245, s[68:71], s14 offen sc1
  s_waitcnt vmcnt(0)
  v_cmp_ne_u32 vcc, s13, v244
  s_nop 3
  s_and_b64 vcc, vcc, 0xffff
  s_cmp_eq_u64 vcc, 0
  s_cbranch_scc1 L_fw_f0_ok
  s_sleep 4
  s_branch L_fw_f0
L_fw_f0_ok:
  v_mov_b32 v244, 12832
  v_mov_b32 v245, 1
  s_mov_b64 exec, 1
  ds_add_u32 v244, v245
  s_mov_b64 exec, -1
  s_branch L_fw_f0_dn
L_fw_f0_np:
  v_mov_b32 v244, 12832
  s_mov_b32 s15, 0
L_fw_f0_l:
  s_add_u32 s15, s15, 1
  s_cmp_gt_u32 s15, 1000000
  s_cbranch_scc1 L_fw_f0_l_ok
  ds_read_b32 v245, v244
  s_waitcnt lgkmcnt(0)
  v_readfirstlane_b32 s10, v245
  s_nop 3
  s_cmp_ge_u32 s10, 1
  s_cbranch_scc1 L_fw_f0_l_ok
  s_sleep 1
  s_branch L_fw_f0_l
L_fw_f0_l_ok:
L_fw_f0_dn:
  s_add_u32 s10, s84, 0
  s_add_u32 s11, s10, 147456
  buffer_load_dwordx4 v[128:131], v243, s[68:71], s10 offen sc1
  buffer_load_dwordx4 v[132:135], v243, s[68:71], s11 offen sc1
  s_add_u32 s10, s84, 1024
  s_add_u32 s11, s10, 147456
  buffer_load_dwordx4 v[136:139], v243, s[68:71], s10 offen sc1
  buffer_load_dwordx4 v[140:143], v243, s[68:71], s11 offen sc1
  s_add_u32 s10, s84, 2048
  s_add_u32 s11, s10, 147456
  buffer_load_dwordx4 v[144:147], v243, s[68:71], s10 offen sc1
  buffer_load_dwordx4 v[148:151], v243, s[68:71], s11 offen sc1
  s_add_u32 s10, s84, 3072
  s_add_u32 s11, s10, 147456
  buffer_load_dwordx4 v[152:155], v243, s[68:71], s10 offen sc1
  buffer_load_dwordx4 v[156:159], v243, s[68:71], s11 offen sc1
  s_add_u32 s10, s84, 8192
  s_add_u32 s11, s10, 147456
  buffer_load_dwordx4 v[160:163], v243, s[68:71], s10 offen sc1
  buffer_load_dwordx4 v[164:167], v243, s[68:71], s11 offen sc1
  s_add_u32 s10, s84, 9216
  s_add_u32 s11, s10, 147456
  buffer_load_dwordx4 v[168:171], v243, s[68:71], s10 offen sc1
  buffer_load_dwordx4 v[172:175], v243, s[68:71], s11 offen sc1
  s_add_u32 s10, s84, 10240
  s_add_u32 s11, s10, 147456
  buffer_load_dwordx4 v[176:179], v243, s[68:71], s10 offen sc1
  buffer_load_dwordx4 v[180:183], v243, s[68:71], s11 offen sc1
  s_add_u32 s10, s84, 11264
  s_add_u32 s11, s10, 147456
  buffer_load_dwordx4 v[184:187], v243, s[68:71], s10 offen sc1
  buffer_load_dwordx4 v[188:191], v243, s[68:71], s11 offen sc1
  s_add_u32 s10, s84, 16384
  s_add_u32 s11, s10, 147456
  buffer_load_dwordx4 v[192:195], v243, s[68:71], s10 offen sc1
  buffer_load_dwordx4 v[196:199], v243, s[68:71], s11 offen sc1
  s_add_u32 s10, s84, 17408
  s_add_u32 s11, s10, 147456
  buffer_load_dwordx4 v[200:203], v243, s[68:71], s10 offen sc1
  buffer_load_dwordx4 v[204:207], v243, s[68:71], s11 offen sc1
  s_add_u32 s10, s84, 18432
  s_add_u32 s11, s10, 147456
  buffer_load_dwordx4 v[208:211], v243, s[68:71], s10 offen sc1
  buffer_load_dwordx4 v[212:215], v243, s[68:71], s11 offen sc1
  s_add_u32 s10, s84, 19456
  s_add_u32 s11, s10, 147456
  buffer_load_dwordx4 v[216:219], v243, s[68:71], s10 offen sc1
  buffer_load_dwordx4 v[220:223], v243, s[68:71], s11 offen sc1
  s_waitcnt vmcnt(22)
  ds_read_b64_tr_b16 v[224:225], v240 offset:0
  ds_read_b64_tr_b16 v[226:227], v240 offset:1024
  ds_read_b64_tr_b16 v[228:229], v241 offset:0
  ds_read_b64_tr_b16 v[230:231], v241 offset:1024
  s_waitcnt vmcnt(20)
  ds_read_b64_tr_b16 v[232:233], v240 offset:2048
  ds_read_b64_tr_b16 v[234:235], v240 offset:3072
  ds_read_b64_tr_b16 v[236:237], v241 offset:2048
  ds_read_b64_tr_b16 v[238:239], v241 offset:3072
  s_waitcnt lgkmcnt(4)
  v_mfma_f32_32x32x16_bf16 v[64:79], v[224:227], v[128:131], 0
  v_mfma_f32_32x32x16_bf16 v[80:95], v[228:231], v[128:131], 0
  v_mfma_f32_32x32x16_bf16 v[96:111], v[224:227], v[132:135], 0
  v_mfma_f32_32x32x16_bf16 v[112:127], v[228:231], v[132:135], 0
  s_add_u32 s10, s82, 65536
  s_add_u32 m0, s88, 0
  s_add_u32 s11, s10, 8192
  buffer_load_dwordx4 v242, s[56:59], s10 offen lds
  s_add_u32 m0, s88, 1024
  s_nop 0
  buffer_load_dwordx4 v242, s[56:59], s11 offen lds
  s_waitcnt vmcnt(20)
  ds_read_b64_tr_b16 v[224:225], v240 offset:4096
  ds_read_b64_tr_b16 v[226:227], v240 offset:5120
  ds_read_b64_tr_b16 v[228:229], v241 offset:4096
  ds_read_b64_tr_b16 v[230:231], v241 offset:5120
  s_waitcnt lgkmcnt(4)
  v_mfma_f32_32x32x16_bf16 v[64:79], v[232:235], v[136:139], v[64:79]
  v_mfma_f32_32x32x16_bf16 v[80:95], v[236:239], v[136:139], v[80:95]
  v_mfma_f32_32x32x16_bf16 v[96:111], v[232:235], v[140:143], v[96:111]
  v_mfma_f32_32x32x16_bf16 v[112:127], v[236:239], v[140:143], v[112:127]
  s_add_u32 s10, s82, 81920
  s_add_u32 m0, s88, 2048
  s_add_u32 s11, s10, 8192
  buffer_load_dwordx4 v242, s[56:59], s10 offen lds
  s_add_u32 m0, s88, 3072
  s_nop 0
  buffer_load_dwordx4 v242, s[56:59], s11 offen lds
  s_waitcnt vmcnt(20)
  ds_read_b64_tr_b16 v[232:233], v240 offset:6144
  ds_read_b64_tr_b16 v[234:235], v240 offset:7168
  ds_read_b64_tr_b16 v[236:237], v241 offset:6144
  ds_read_b64_tr_b16 v[238:239], v241 offset:7168
  s_waitcnt lgkmcnt(4)
  v_mfma_f32_32x32x16_bf16 v[64:79], v[224:227], v[144:147], v[64:79]
  v_mfma_f32_32x32x16_bf16 v[80:95], v[228:231], v[144:147], v[80:95]
  v_mfma_f32_32x32x16_bf16 v[96:111], v[224:227], v[148:151], v[96:111]
  v_mfma_f32_32x32x16_bf16 v[112:127], v[228:231], v[148:151], v[112:127]
  s_add_u32 s10, s82, 98304
  s_add_u32 m0, s88, 4096
  s_add_u32 s11, s10, 8192
  buffer_load_dwordx4 v242, s[56:59], s10 offen lds
  s_add_u32 m0, s88, 5120
  s_nop 0
  buffer_load_dwordx4 v242, s[56:59], s11 offen lds
  s_waitcnt vmcnt(20)
  ds_read_b64_tr_b16 v[224:225], v240 offset:8192
  ds_read_b64_tr_b16 v[226:227], v240 offset:9216
  ds_read_b64_tr_b16 v[228:229], v241 offset:8192
  ds_read_b64_tr_b16 v[230:231], v241 offset:9216
  s_waitcnt lgkmcnt(4)
  v_mfma_f32_32x32x16_bf16 v[64:79], v[232:235], v[152:155], v[64:79]
  v_mfma_f32_32x32x16_bf16 v[80:95], v[236:239], v[152:155], v[80:95]
  v_mfma_f32_32x32x16_bf16 v[96:111], v[232:235], v[156:159], v[96:111]
  v_mfma_f32_32x32x16_bf16 v[112:127], v[236:239], v[156:159], v[112:127]
  s_add_u32 s10, s82, 114688
  s_add_u32 m0, s88, 6144
  s_add_u32 s11, s10, 8192
  buffer_load_dwordx4 v242, s[56:59], s10 offen lds
  s_add_u32 m0, s88, 7168
  s_nop 0
  buffer_load_dwordx4 v242, s[56:59], s11 offen lds
  s_waitcnt vmcnt(20)
  ds_read_b64_tr_b16 v[232:233], v240 offset:10240
  ds_read_b64_tr_b16 v[234:235], v240 offset:11264
  ds_read_b64_tr_b16 v[236:237], v241 offset:10240
  ds_read_b64_tr_b16 v[238:239], v241 offset:11264
  s_waitcnt lgkmcnt(4)
  v_mfma_f32_32x32x16_bf16 v[64:79], v[224:227], v[160:163], v[64:79]
  v_mfma_f32_32x32x16_bf16 v[80:95], v[228:231], v[160:163], v[80:95]
  v_mfma_f32_32x32x16_bf16 v[96:111], v[224:227], v[164:167], v[96:111]
  v_mfma_f32_32x32x16_bf16 v[112:127], v[228:231], v[164:167], v[112:127]
  s_add_u32 s10, s82, 196608
  s_add_u32 m0, s88, 8192
  s_add_u32 s11, s10, 8192
  buffer_load_dwordx4 v242, s[56:59], s10 offen lds
  s_add_u32 m0, s88, 9216
  s_nop 0
  buffer_load_dwordx4 v242, s[56:59], s11 offen lds
  s_waitcnt vmcnt(20)
  ds_read_b64_tr_b16 v[224:225], v240 offset:12288
  ds_read_b64_tr_b16 v[226:227], v240 offset:13312
  ds_read_b64_tr_b16 v[228:229], v241 offset:12288
  ds_read_b64_tr_b16 v[230:231], v241 offset:13312
  s_waitcnt lgkmcnt(4)
  v_mfma_f32_32x32x16_bf16 v[64:79], v[232:235], v[168:171], v[64:79]
  v_mfma_f32_32x32x16_bf16 v[80:95], v[236:239], v[168:171], v[80:95]
  v_mfma_f32_32x32x16_bf16 v[96:111], v[232:235], v[172:175], v[96:111]
  v_mfma_f32_32x32x16_bf16 v[112:127], v[236:239], v[172:175], v[112:127]
  s_add_u32 s10, s82, 212992
  s_add_u32 m0, s88, 10240
  s_add_u32 s11, s10, 8192
  buffer_load_dwordx4 v242, s[56:59], s10 offen lds
  s_add_u32 m0, s88, 11264
  s_nop 0
  buffer_load_dwordx4 v242, s[56:59], s11 offen lds
  s_waitcnt vmcnt(20)
  ds_read_b64_tr_b16 v[232:233], v240 offset:14336
  ds_read_b64_tr_b16 v[234:235], v240 offset:15360
  ds_read_b64_tr_b16 v[236:237], v241 offset:14336
  ds_read_b64_tr_b16 v[238:239], v241 offset:15360
  s_waitcnt lgkmcnt(4)
  v_mfma_f32_32x32x16_bf16 v[64:79], v[224:227], v[176:179], v[64:79]
  v_mfma_f32_32x32x16_bf16 v[80:95], v[228:231], v[176:179], v[80:95]
  v_mfma_f32_32x32x16_bf16 v[96:111], v[224:227], v[180:183], v[96:111]
  v_mfma_f32_32x32x16_bf16 v[112:127], v[228:231], v[180:183], v[112:127]
  s_add_u32 s10, s82, 229376
  s_add_u32 m0, s88, 12288
  s_add_u32 s11, s10, 8192
  buffer_load_dwordx4 v242, s[56:59], s10 offen lds
  s_add_u32 m0, s88, 13312
  s_nop 0
  buffer_load_dwordx4 v242, s[56:59], s11 offen lds
  s_waitcnt vmcnt(20)
  ds_read_b64_tr_b16 v[224:225], v240 offset:16384
  ds_read_b64_tr_b16 v[226:227], v240 offset:17408
  ds_read_b64_tr_b16 v[228:229], v241 offset:16384
  ds_read_b64_tr_b16 v[230:231], v241 offset:17408
  s_waitcnt lgkmcnt(4)
  v_mfma_f32_32x32x16_bf16 v[64:79], v[232:235], v[184:187], v[64:79]
  v_mfma_f32_32x32x16_bf16 v[80:95], v[236:239], v[184:187], v[80:95]
  v_mfma_f32_32x32x16_bf16 v[96:111], v[232:235], v[188:191], v[96:111]
  v_mfma_f32_32x32x16_bf16 v[112:127], v[236:239], v[188:191], v[112:127]
  s_add_u32 s10, s82, 245760
  s_add_u32 m0, s88, 14336
  s_add_u32 s11, s10, 8192
  buffer_load_dwordx4 v242, s[56:59], s10 offen lds
  s_add_u32 m0, s88, 15360
  s_nop 0
  buffer_load_dwordx4 v242, s[56:59], s11 offen lds
  s_waitcnt vmcnt(20)
  ds_read_b64_tr_b16 v[232:233], v240 offset:18432
  ds_read_b64_tr_b16 v[234:235], v240 offset:19456
  ds_read_b64_tr_b16 v[236:237], v241 offset:18432
  ds_read_b64_tr_b16 v[238:239], v241 offset:19456
  s_waitcnt lgkmcnt(4)
  v_mfma_f32_32x32x16_bf16 v[64:79], v[224:227], v[192:195], v[64:79]
  v_mfma_f32_32x32x16_bf16 v[80:95], v[228:231], v[192:195], v[80:95]
  v_mfma_f32_32x32x16_bf16 v[96:111], v[224:227], v[196:199], v[96:111]
  v_mfma_f32_32x32x16_bf16 v[112:127], v[228:231], v[196:199], v[112:127]
  s_add_u32 s10, s82, 327680
  s_add_u32 m0, s88, 16384
  s_add_u32 s11, s10, 8192
  buffer_load_dwordx4 v242, s[56:59], s10 offen lds
  s_add_u32 m0, s88, 17408
  s_nop 0
  buffer_load_dwordx4 v242, s[56:59], s11 offen lds
  s_waitcnt vmcnt(20)
  ds_read_b64_tr_b16 v[224:225], v240 offset:20480
  ds_read_b64_tr_b16 v[226:227], v240 offset:21504
  ds_read_b64_tr_b16 v[228:229], v241 offset:20480
  ds_read_b64_tr_b16 v[230:231], v241 offset:21504
  s_waitcnt lgkmcnt(4)
  v_mfma_f32_32x32x16_bf16 v[64:79], v[232:235], v[200:203], v[64:79]
  v_mfma_f32_32x32x16_bf16 v[80:95], v[236:239], v[200:203], v[80:95]
  v_mfma_f32_32x32x16_bf16 v[96:111], v[232:235], v[204:207], v[96:111]
  v_mfma_f32_32x32x16_bf16 v[112:127], v[236:239], v[204:207], v[112:127]
  s_add_u32 s10, s82, 344064
  s_add_u32 m0, s88, 18432
  s_add_u32 s11, s10, 8192
  buffer_load_dwordx4 v242, s[56:59], s10 offen lds
  s_add_u32 m0, s88, 19456
  s_nop 0
  buffer_load_dwordx4 v242, s[56:59], s11 offen lds
  s_waitcnt vmcnt(20)
  ds_read_b64_tr_b16 v[232:233], v240 offset:22528
  ds_read_b64_tr_b16 v[234:235], v240 offset:23552
  ds_read_b64_tr_b16 v[236:237], v241 offset:22528
  ds_read_b64_tr_b16 v[238:239], v241 offset:23552
  s_waitcnt lgkmcnt(4)
  v_mfma_f32_32x32x16_bf16 v[64:79], v[224:227], v[208:211], v[64:79]
  v_mfma_f32_32x32x16_bf16 v[80:95], v[228:231], v[208:211], v[80:95]
  v_mfma_f32_32x32x16_bf16 v[96:111], v[224:227], v[212:215], v[96:111]
  v_mfma_f32_32x32x16_bf16 v[112:127], v[228:231], v[212:215], v[112:127]
  s_add_u32 s10, s82, 360448
  s_add_u32 m0, s88, 20480
  s_add_u32 s11, s10, 8192
  buffer_load_dwordx4 v242, s[56:59], s10 offen lds
  s_add_u32 m0, s88, 21504
  s_nop 0
  buffer_load_dwordx4 v242, s[56:59], s11 offen lds
  s_waitcnt lgkmcnt(0)
  v_mfma_f32_32x32x16_bf16 v[64:79], v[232:235], v[216:219], v[64:79]
  v_mfma_f32_32x32x16_bf16 v[80:95], v[236:239], v[216:219], v[80:95]
  v_mfma_f32_32x32x16_bf16 v[96:111], v[232:235], v[220:223], v[96:111]
  v_mfma_f32_32x32x16_bf16 v[112:127], v[236:239], v[220:223], v[112:127]
  s_add_u32 s10, s82, 376832
  s_add_u32 m0, s88, 22528
  s_add_u32 s11, s10, 8192
  buffer_load_dwordx4 v242, s[56:59], s10 offen lds
  s_add_u32 m0, s88, 23552
  s_nop 0
  buffer_load_dwordx4 v242, s[56:59], s11 offen lds
  s_waitcnt vmcnt(0)
  s_cmp_eq_u32 s3, 0
  s_cbranch_scc0 L_fw_f1_np
  s_lshr_b32 s10, s86, 1
  s_add_u32 s10, s10, 48
  s_lshl_b32 s10, s10, 7
  v_lshlrev_b32 v245, 2, v0
  v_add_u32 v245, s10, v245
  s_add_u32 s13, s33, 3
  s_mov_b32 s14, 16777216
  s_mov_b32 s15, 0
L_fw_f1:
  s_add_u32 s15, s15, 1
  s_cmp_gt_u32 s15, 100000
  s_cbranch_scc1 L_fw_f1_ok
  buffer_load_dword v244, v245, s[68:71], s14 offen sc1
  s_waitcnt vmcnt(0)
  v_cmp_ne_u32 vcc, s13, v244
  s_nop 3
  s_and_b64 vcc, vcc, 0xffff
  s_cmp_eq_u64 vcc, 0
  s_cbranch_scc1 L_fw_f1_ok
  s_sleep 4
  s_branch L_fw_f1
L_fw_f1_ok:
  v_mov_b32 v244, 12836
  v_mov_b32 v245, 1
  s_mov_b64 exec, 1
  ds_add_u32 v244, v245
  s_mov_b64 exec, -1
  s_branch L_fw_f1_dn
L_fw_f1_np:
  v_mov_b32 v244, 12836
  s_mov_b32 s15, 0
L_fw_f1_l:
  s_add_u32 s15, s15, 1
  s_cmp_gt_u32 s15, 1000000
  s_cbranch_scc1 L_fw_f1_l_ok
  ds_read_b32 v245, v244
  s_waitcnt lgkmcnt(0)
  v_readfirstlane_b32 s10, v245
  s_nop 3
  s_cmp_ge_u32 s10, 1
  s_cbranch_scc1 L_fw_f1_l_ok
  s_sleep 1
  s_branch L_fw_f1_l
L_fw_f1_l_ok:
L_fw_f1_dn:
  s_add_u32 s10, s84, 4096
  s_add_u32 s11, s10, 147456
  buffer_load_dwordx4 v[128:131], v243, s[68:71], s10 offen sc1
  buffer_load_dwordx4 v[132:135], v243, s[68:71], s11 offen sc1
  s_add_u32 s10, s84, 5120
  s_add_u32 s11, s10, 147456
  buffer_load_dwordx4 v[136:139], v243, s[68:71], s10 offen sc1
  buffer_load_dwordx4 v[140:143], v243, s[68:71], s11 offen sc1
  s_add_u32 s10, s84, 6144
  s_add_u32 s11, s10, 147456
  buffer_load_dwordx4 v[144:147], v243, s[68:71], s10 offen sc1
  buffer_load_dwordx4 v[148:151], v243, s[68:71], s11 offen sc1
  s_add_u32 s10, s84, 7168
  s_add_u32 s11, s10, 147456
  buffer_load_dwordx4 v[152:155], v243, s[68:71], s10 offen sc1
  buffer_load_dwordx4 v[156:159], v243, s[68:71], s11 offen sc1
  s_add_u32 s10, s84, 12288
  s_add_u32 s11, s10, 147456
  buffer_load_dwordx4 v[160:163], v243, s[68:71], s10 offen sc1
  buffer_load_dwordx4 v[164:167], v243, s[68:71], s11 offen sc1
  s_add_u32 s10, s84, 13312
  s_add_u32 s11, s10, 147456
  buffer_load_dwordx4 v[168:171], v243, s[68:71], s10 offen sc1
  buffer_load_dwordx4 v[172:175], v243, s[68:71], s11 offen sc1
  s_add_u32 s10, s84, 14336
  s_add_u32 s11, s10, 147456
  buffer_load_dwordx4 v[176:179], v243, s[68:71], s10 offen sc1
  buffer_load_dwordx4 v[180:183], v243, s[68:71], s11 offen sc1
  s_add_u32 s10, s84, 15360
  s_add_u32 s11, s10, 147456
  buffer_load_dwordx4 v[184:187], v243, s[68:71], s10 offen sc1
  buffer_load_dwordx4 v[188:191], v243, s[68:71], s11 offen sc1
  s_add_u32 s10, s84, 20480
  s_add_u32 s11, s10, 147456
  buffer_load_dwordx4 v[192:195], v243, s[68:71], s10 offen sc1
  buffer_load_dwordx4 v[196:199], v243, s[68:71], s11 offen sc1
  s_add_u32 s10, s84, 21504
  s_add_u32 s11, s10, 147456
  buffer_load_dwordx4 v[200:203], v243, s[68:71], s10 offen sc1
  buffer_load_dwordx4 v[204:207], v243, s[68:71], s11 offen sc1
  s_add_u32 s10, s84, 22528
  s_add_u32 s11, s10, 147456
  buffer_load_dwordx4 v[208:211], v243, s[68:71], s10 offen sc1
  buffer_load_dwordx4 v[212:215], v243, s[68:71], s11 offen sc1
  s_add_u32 s10, s84, 23552
  s_add_u32 s11, s10, 147456
  buffer_load_dwordx4 v[216:219], v243, s[68:71], s10 offen sc1
  buffer_load_dwordx4 v[220:223], v243, s[68:71], s11 offen sc1
  s_waitcnt vmcnt(22)
  ds_read_b64_tr_b16 v[224:225], v240 offset:0
  ds_read_b64_tr_b16 v[226:227], v240 offset:1024
  ds_read_b64_tr_b16 v[228:229], v241 offset:0
  ds_read_b64_tr_b16 v[230:231], v241 offset:1024
  s_waitcnt vmcnt(20)
  ds_read_b64_tr_b16 v[232:233], v240 offset:2048
  ds_read_b64_tr_b16 v[234:235], v240 offset:3072
  ds_read_b64_tr_b16 v[236:237], v241 offset:2048
  ds_read_b64_tr_b16 v[238:239], v241 offset:3072
  s_waitcnt lgkmcnt(4)
  v_mfma_f32_32x32x16_bf16 v[64:79], v[224:227], v[128:131], v[64:79]
  v_mfma_f32_32x32x16_bf16 v[80:95], v[228:231], v[128:131], v[80:95]
  v_mfma_f32_32x32x16_bf16 v[96:111], v[224:227], v[132:135], v[96:111]
  v_mfma_f32_32x32x16_bf16 v[112:127], v[228:231], v[132:135], v[112:127]
  s_add_u32 s10, s82, 393216
  s_add_u32 m0, s88, 0
  s_add_u32 s11, s10, 8192
  buffer_load_dwordx4 v242, s[56:59], s10 offen lds
  s_add_u32 m0, s88, 1024
  s_nop 0
  buffer_load_dwordx4 v242, s[56:59], s11 offen lds
  s_add_u32 s10, s84, 24576
  s_add_u32 s11, s10, 147456
  buffer_load_dwordx4 v[128:131], v243, s[68:71], s10 offen sc1
  buffer_load_dwordx4 v[132:135], v243, s[68:71], s11 offen sc1
  s_waitcnt vmcnt(22)
  ds_read_b64_tr_b16 v[224:225], v240 offset:4096
  ds_read_b64_tr_b16 v[226:227], v240 offset:5120
  ds_read_b64_tr_b16 v[228:229], v241 offset:4096
  ds_read_b64_tr_b16 v[230:231], v241 offset:5120
  s_waitcnt lgkmcnt(4)
  v_mfma_f32_32x32x16_bf16 v[64:79], v[232:235], v[136:139], v[64:79]
  v_mfma_f32_32x32x16_bf16 v[80:95], v[236:239], v[136:139], v[80:95]
  v_mfma_f32_32x32x16_bf16 v[96:111], v[232:235], v[140:143], v[96:111]
  v_mfma_f32_32x32x16_bf16 v[112:127], v[236:239], v[140:143], v[112:127]
  s_add_u32 s10, s82, 409600
  s_add_u32 m0, s88, 2048
  s_add_u32 s11, s10, 8192
  buffer_load_dwordx4 v242, s[56:59], s10 offen lds
  s_add_u32 m0, s88, 3072
  s_nop 0
  buffer_load_dwordx4 v242, s[56:59], s11 offen lds
  s_add_u32 s10, s84, 25600
  s_add_u32 s11, s10, 147456
  buffer_load_dwordx4 v[136:139], v243, s[68:71], s10 offen sc1
  buffer_load_dwordx4 v[140:143], v243, s[68:71], s11 offen sc1
  s_waitcnt vmcnt(24)
  ds_read_b64_tr_b16 v[232:233], v240 offset:6144
  ds_read_b64_tr_b16 v[234:235], v240 offset:7168
  ds_read_b64_tr_b16 v[236:237], v241 offset:6144
  ds_read_b64_tr_b16 v[238:239], v241 offset:7168
  s_waitcnt lgkmcnt(4)
  v_mfma_f32_32x32x16_bf16 v[64:79], v[224:227], v[144:147], v[64:79]
  v_mfma_f32_32x32x16_bf16 v[80:95], v[228:231], v[144:147], v[80:95]
  v_mfma_f32_32x32x16_bf16 v[96:111], v[224:227], v[148:151], v[96:111]
  v_mfma_f32_32x32x16_bf16 v[112:127], v[228:231], v[148:151], v[112:127]
  s_add_u32 s10, s82, 425984
  s_add_u32 m0, s88, 4096
  s_add_u32 s11, s10, 8192
  buffer_load_dwordx4 v242, s[56:59], s10 offen lds
  s_add_u32 m0, s88, 5120
  s_nop 0
  buffer_load_dwordx4 v242, s[56:59], s11 offen lds
  s_add_u32 s10, s84, 26624
  s_add_u32 s11, s10, 147456
  buffer_load_dwordx4 v[144:147], v243, s[68:71], s10 offen sc1
  buffer_load_dwordx4 v[148:151], v243, s[68:71], s11 offen sc1
  s_waitcnt vmcnt(26)
  ds_read_b64_tr_b16 v[224:225], v240 offset:8192
  ds_read_b64_tr_b16 v[226:227], v240 offset:9216
  ds_read_b64_tr_b16 v[228:229], v241 offset:8192
  ds_read_b64_tr_b16 v[230:231], v241 offset:9216
  s_waitcnt lgkmcnt(4)
  v_mfma_f32_32x32x16_bf16 v[64:79], v[232:235], v[152:155], v[64:79]
  v_mfma_f32_32x32x16_bf16 v[80:95], v[236:239], v[152:155], v[80:95]
  v_mfma_f32_32x32x16_bf16 v[96:111], v[232:235], v[156:159], v[96:111]
  v_mfma_f32_32x32x16_bf16 v[112:127], v[236:239], v[156:159], v[112:127]
  s_add_u32 s10, s82, 442368
  s_add_u32 m0, s88, 6144
  s_add_u32 s11, s10, 8192
  buffer_load_dwordx4 v242, s[56:59], s10 offen lds
  s_add_u32 m0, s88, 7168
  s_nop 0
  buffer_load_dwordx4 v242, s[56:59], s11 offen lds
  s_add_u32 s10, s84, 27648
  s_add_u32 s11, s10, 147456
  buffer_load_dwordx4 v[152:155], v243, s[68:71], s10 offen sc1
  buffer_load_dwordx4 v[156:159], v243, s[68:71], s11 offen sc1
  s_waitcnt vmcnt(28)
  ds_read_b64_tr_b16 v[232:233], v240 offset:10240
  ds_read_b64_tr_b16 v[234:235], v240 offset:11264
  ds_read_b64_tr_b16 v[236:237], v241 offset:10240
  ds_read_b64_tr_b16 v[238:239], v241 offset:11264
  s_waitcnt lgkmcnt(4)
  v_mfma_f32_32x32x16_bf16 v[64:79], v[224:227], v[160:163], v[64:79]
  v_mfma_f32_32x32x16_bf16 v[80:95], v[228:231], v[160:163], v[80:95]
  v_mfma_f32_32x32x16_bf16 v[96:111], v[224:227], v[164:167], v[96:111]
  v_mfma_f32_32x32x16_bf16 v[112:127], v[228:231], v[164:167], v[112:127]
  s_add_u32 s10, s83, 0
  s_add_u32 m0, s88, 8192
  s_add_u32 s11, s10, 8192
  buffer_load_dwordx4 v242, s[44:47], s10 offen lds
  s_add_u32 m0, s88, 9216
  s_nop 0
  buffer_load_dwordx4 v242, s[44:47], s11 offen lds
  s_waitcnt vmcnt(28)
  ds_read_b64_tr_b16 v[224:225], v240 offset:12288
  ds_read_b64_tr_b16 v[226:227], v240 offset:13312
  ds_read_b64_tr_b16 v[228:229], v241 offset:12288
  ds_read_b64_tr_b16 v[230:231], v241 offset:13312
  s_waitcnt lgkmcnt(4)
  v_mfma_f32_32x32x16_bf16 v[64:79], v[232:235], v[168:171], v[64:79]
  v_mfma_f32_32x32x16_bf16 v[80:95], v[236:239], v[168:171], v[80:95]
  v_mfma_f32_32x32x16_bf16 v[96:111], v[232:235], v[172:175], v[96:111]
  v_mfma_f32_32x32x16_bf16 v[112:127], v[236:239], v[172:175], v[112:127]
  s_add_u32 s10, s83, 16384
  s_add_u32 m0, s88, 10240
  s_add_u32 s11, s10, 8192
  buffer_load_dwordx4 v242, s[44:47], s10 offen lds
  s_add_u32 m0, s88, 11264
  s_nop 0
  buffer_load_dwordx4 v242, s[44:47], s11 offen lds
  s_waitcnt vmcnt(28)
  ds_read_b64_tr_b16 v[232:233], v240 offset:14336
  ds_read_b64_tr_b16 v[234:235], v240 offset:15360
  ds_read_b64_tr_b16 v[236:237], v241 offset:14336
  ds_read_b64_tr_b16 v[238:239], v241 offset:15360
  s_waitcnt lgkmcnt(4)
  v_mfma_f32_32x32x16_bf16 v[64:79], v[224:227], v[176:179], v[64:79]
  v_mfma_f32_32x32x16_bf16 v[80:95], v[228:231], v[176:179], v[80:95]
  v_mfma_f32_32x32x16_bf16 v[96:111], v[224:227], v[180:183], v[96:111]
  v_mfma_f32_32x32x16_bf16 v[112:127], v[228:231], v[180:183], v[112:127]
  s_add_u32 s10, s83, 32768
  s_add_u32 m0, s88, 12288
  s_add_u32 s11, s10, 8192
  buffer_load_dwordx4 v242, s[44:47], s10 offen lds
  s_add_u32 m0, s88, 13312
  s_nop 0
  buffer_load_dwordx4 v242, s[44:47], s11 offen lds
  s_waitcnt vmcnt(28)
  ds_read_b64_tr_b16 v[224:225], v240 offset:16384
  ds_read_b64_tr_b16 v[226:227], v240 offset:17408
  ds_read_b64_tr_b16 v[228:229], v241 offset:16384
  ds_read_b64_tr_b16 v[230:231], v241 offset:17408
  s_waitcnt lgkmcnt(4)
  v_mfma_f32_32x32x16_bf16 v[64:79], v[232:235], v[184:187], v[64:79]
  v_mfma_f32_32x32x16_bf16 v[80:95], v[236:239], v[184:187], v[80:95]
  v_mfma_f32_32x32x16_bf16 v[96:111], v[232:235], v[188:191], v[96:111]
  v_mfma_f32_32x32x16_bf16 v[112:127], v[236:239], v[188:191], v[112:127]
  s_add_u32 s10, s83, 49152
  s_add_u32 m0, s88, 14336
  s_add_u32 s11, s10, 8192
  buffer_load_dwordx4 v242, s[44:47], s10 offen lds
  s_add_u32 m0, s88, 15360
  s_nop 0
  buffer_load_dwordx4 v242, s[44:47], s11 offen lds
  s_waitcnt vmcnt(28)
  ds_read_b64_tr_b16 v[232:233], v240 offset:18432
  ds_read_b64_tr_b16 v[234:235], v240 offset:19456
  ds_read_b64_tr_b16 v[236:237], v241 offset:18432
  ds_read_b64_tr_b16 v[238:239], v241 offset:19456
  s_waitcnt lgkmcnt(4)
  v_mfma_f32_32x32x16_bf16 v[64:79], v[224:227], v[192:195], v[64:79]
  v_mfma_f32_32x32x16_bf16 v[80:95], v[228:231], v[192:195], v[80:95]
  v_mfma_f32_32x32x16_bf16 v[96:111], v[224:227], v[196:199], v[96:111]
  v_mfma_f32_32x32x16_bf16 v[112:127], v[228:231], v[196:199], v[112:127]
  s_add_u32 s10, s83, 65536
  s_add_u32 m0, s88, 16384
  s_add_u32 s11, s10, 8192
  buffer_load_dwordx4 v242, s[44:47], s10 offen lds
  s_add_u32 m0, s88, 17408
  s_nop 0
  buffer_load_dwordx4 v242, s[44:47], s11 offen lds
  s_waitcnt vmcnt(28)
  ds_read_b64_tr_b16 v[224:225], v240 offset:20480
  ds_read_b64_tr_b16 v[226:227], v240 offset:21504
  ds_read_b64_tr_b16 v[228:229], v241 offset:20480
  ds_read_b64_tr_b16 v[230:231], v241 offset:21504
  s_waitcnt lgkmcnt(4)
  v_mfma_f32_32x32x16_bf16 v[64:79], v[232:235], v[200:203], v[64:79]
  v_mfma_f32_32x32x16_bf16 v[80:95], v[236:239], v[200:203], v[80:95]
  v_mfma_f32_32x32x16_bf16 v[96:111], v[232:235], v[204:207], v[96:111]
  v_mfma_f32_32x32x16_bf16 v[112:127], v[236:239], v[204:207], v[112:127]
  s_add_u32 s10, s83, 81920
  s_add_u32 m0, s88, 18432
  s_add_u32 s11, s10, 8192
  buffer_load_dwordx4 v242, s[44:47], s10 offen lds
  s_add_u32 m0, s88, 19456
  s_nop 0
  buffer_load_dwordx4 v242, s[44:47], s11 offen lds
  s_waitcnt vmcnt(28)
  ds_read_b64_tr_b16 v[232:233], v240 offset:22528
  ds_read_b64_tr_b16 v[234:235], v240 offset:23552
  ds_read_b64_tr_b16 v[236:237], v241 offset:22528
  ds_read_b64_tr_b16 v[238:239], v241 offset:23552
  s_waitcnt lgkmcnt(4)
  v_mfma_f32_32x32x16_bf16 v[64:79], v[224:227], v[208:211], v[64:79]
  v_mfma_f32_32x32x16_bf16 v[80:95], v[228:231], v[208:211], v[80:95]
  v_mfma_f32_32x32x16_bf16 v[96:111], v[224:227], v[212:215], v[96:111]
  v_mfma_f32_32x32x16_bf16 v[112:127], v[228:231], v[212:215], v[112:127]
  s_add_u32 s10, s83, 98304
  s_add_u32 m0, s88, 20480
  s_add_u32 s11, s10, 8192
  buffer_load_dwordx4 v242, s[44:47], s10 offen lds
  s_add_u32 m0, s88, 21504
  s_nop 0
  buffer_load_dwordx4 v242, s[44:47], s11 offen lds
  s_waitcnt vmcnt(26)
  ds_read_b64_tr_b16 v[224:225], v240 offset:0
  ds_read_b64_tr_b16 v[226:227], v240 offset:1024
  ds_read_b64_tr_b16 v[228:229], v241 offset:0
  ds_read_b64_tr_b16 v[230:231], v241 offset:1024
  s_waitcnt lgkmcnt(4)
  v_mfma_f32_32x32x16_bf16 v[64:79], v[232:235], v[216:219], v[64:79]
  v_mfma_f32_32x32x16_bf16 v[80:95], v[236:239], v[216:219], v[80:95]
  v_mfma_f32_32x32x16_bf16 v[96:111], v[232:235], v[220:223], v[96:111]
  v_mfma_f32_32x32x16_bf16 v[112:127], v[236:239], v[220:223], v[112:127]
  s_add_u32 s10, s83, 114688
  s_add_u32 m0, s88, 22528
  s_add_u32 s11, s10, 8192
  buffer_load_dwordx4 v242, s[44:47], s10 offen lds
  s_add_u32 m0, s88, 23552
  s_nop 0
  buffer_load_dwordx4 v242, s[44:47], s11 offen lds
  s_waitcnt vmcnt(24)
  ds_read_b64_tr_b16 v[232:233], v240 offset:2048
  ds_read_b64_tr_b16 v[234:235], v240 offset:3072
  ds_read_b64_tr_b16 v[236:237], v241 offset:2048
  ds_read_b64_tr_b16 v[238:239], v241 offset:3072
  s_waitcnt lgkmcnt(4)
  v_mfma_f32_32x32x16_bf16 v[64:79], v[224:227], v[128:131], v[64:79]
  v_mfma_f32_32x32x16_bf16 v[80:95], v[228:231], v[128:131], v[80:95]
  v_mfma_f32_32x32x16_bf16 v[96:111], v[224:227], v[132:135], v[96:111]
  v_mfma_f32_32x32x16_bf16 v[112:127], v[228:231], v[132:135], v[112:127]
  s_waitcnt vmcnt(20)
  ds_read_b64_tr_b16 v[224:225], v240 offset:4096
  ds_read_b64_tr_b16 v[226:227], v240 offset:5120
  ds_read_b64_tr_b16 v[228:229], v241 offset:4096
  ds_read_b64_tr_b16 v[230:231], v241 offset:5120
  s_waitcnt lgkmcnt(4)
  v_mfma_f32_32x32x16_bf16 v[64:79], v[232:235], v[136:139], v[64:79]
  v_mfma_f32_32x32x16_bf16 v[80:95], v[236:239], v[136:139], v[80:95]
  v_mfma_f32_32x32x16_bf16 v[96:111], v[232:235], v[140:143], v[96:111]
  v_mfma_f32_32x32x16_bf16 v[112:127], v[236:239], v[140:143], v[112:127]
  s_waitcnt vmcnt(16)
  ds_read_b64_tr_b16 v[232:233], v240 offset:6144
  ds_read_b64_tr_b16 v[234:235], v240 offset:7168
  ds_read_b64_tr_b16 v[236:237], v241 offset:6144
  ds_read_b64_tr_b16 v[238:239], v241 offset:7168
  s_waitcnt lgkmcnt(4)
  v_mfma_f32_32x32x16_bf16 v[64:79], v[224:227], v[144:147], v[64:79]
  v_mfma_f32_32x32x16_bf16 v[80:95], v[228:231], v[144:147], v[80:95]
  v_mfma_f32_32x32x16_bf16 v[96:111], v[224:227], v[148:151], v[96:111]
  v_mfma_f32_32x32x16_bf16 v[112:127], v[228:231], v[148:151], v[112:127]
  s_waitcnt lgkmcnt(0)
  v_mfma_f32_32x32x16_bf16 v[64:79], v[232:235], v[152:155], v[64:79]
  v_mfma_f32_32x32x16_bf16 v[80:95], v[236:239], v[152:155], v[80:95]
  v_mfma_f32_32x32x16_bf16 v[96:111], v[232:235], v[156:159], v[96:111]
  v_mfma_f32_32x32x16_bf16 v[112:127], v[236:239], v[156:159], v[112:127]
  s_waitcnt vmcnt(0)
  s_cmp_eq_u32 s3, 0
  s_cbranch_scc0 L_fw_f2_np
  s_lshr_b32 s10, s86, 2
  s_add_u32 s10, s10, 64
  s_lshl_b32 s10, s10, 7
  v_lshlrev_b32 v245, 2, v0
  v_add_u32 v245, s10, v245
  s_add_u32 s13, s33, 4
  s_mov_b32 s14, 16777216
  s_mov_b32 s15, 0
L_fw_f2:
  s_add_u32 s15, s15, 1
  s_cmp_gt_u32 s15, 100000
  s_cbranch_scc1 L_fw_f2_ok
  buffer_load_dword v244, v245, s[68:71], s14 offen sc1
  s_waitcnt vmcnt(0)
  v_cmp_ne_u32 vcc, s13, v244
  s_nop 3
  s_and_b64 vcc, vcc, 0xffffffff
  s_cmp_eq_u64 vcc, 0
  s_cbranch_scc1 L_fw_f2_ok
  s_sleep 4
  s_branch L_fw_f2
L_fw_f2_ok:
  v_mov_b32 v244, 12840
  v_mov_b32 v245, 1
  s_mov_b64 exec, 1
  ds_add_u32 v244, v245
  s_mov_b64 exec, -1
  s_branch L_fw_f2_dn
L_fw_f2_np:
  v_mov_b32 v244, 12840
  s_mov_b32 s15, 0
L_fw_f2_l:
  s_add_u32 s15, s15, 1
  s_cmp_gt_u32 s15, 1000000
  s_cbranch_scc1 L_fw_f2_l_ok
  ds_read_b32 v245, v244
  s_waitcnt lgkmcnt(0)
  v_readfirstlane_b32 s10, v245
  s_nop 3
  s_cmp_ge_u32 s10, 1
  s_cbranch_scc1 L_fw_f2_l_ok
  s_sleep 1
  s_branch L_fw_f2_l
L_fw_f2_l_ok:
L_fw_f2_dn:
  s_add_u32 s10, s85, 0
  s_add_u32 s11, s10, 147456
  buffer_load_dwordx4 v[160:163], v243, s[68:71], s10 offen sc1
  buffer_load_dwordx4 v[164:167], v243, s[68:71], s11 offen sc1
  s_add_u32 s10, s85, 1024
  s_add_u32 s11, s10, 147456
  buffer_load_dwordx4 v[168:171], v243, s[68:71], s10 offen sc1
  buffer_load_dwordx4 v[172:175], v243, s[68:71], s11 offen sc1
  s_add_u32 s10, s85, 2048
  s_add_u32 s11, s10, 147456
  buffer_load_dwordx4 v[176:179], v243, s[68:71], s10 offen sc1
  buffer_load_dwordx4 v[180:183], v243, s[68:71], s11 offen sc1
  s_add_u32 s10, s85, 3072
  s_add_u32 s11, s10, 147456
  buffer_load_dwordx4 v[184:187], v243, s[68:71], s10 offen sc1
  buffer_load_dwordx4 v[188:191], v243, s[68:71], s11 offen sc1
  s_add_u32 s10, s85, 4096
  s_add_u32 s11, s10, 147456
  buffer_load_dwordx4 v[192:195], v243, s[68:71], s10 offen sc1
  buffer_load_dwordx4 v[196:199], v243, s[68:71], s11 offen sc1
  s_add_u32 s10, s85, 5120
  s_add_u32 s11, s10, 147456
  buffer_load_dwordx4 v[200:203], v243, s[68:71], s10 offen sc1
  buffer_load_dwordx4 v[204:207], v243, s[68:71], s11 offen sc1
  s_add_u32 s10, s85, 6144
  s_add_u32 s11, s10, 147456
  buffer_load_dwordx4 v[208:211], v243, s[68:71], s10 offen sc1
  buffer_load_dwordx4 v[212:215], v243, s[68:71], s11 offen sc1
  s_add_u32 s10, s85, 7168
  s_add_u32 s11, s10, 147456
  buffer_load_dwordx4 v[216:219], v243, s[68:71], s10 offen sc1
  buffer_load_dwordx4 v[220:223], v243, s[68:71], s11 offen sc1
  s_waitcnt vmcnt(14)
  ds_read_b64_tr_b16 v[224:225], v240 offset:8192
  ds_read_b64_tr_b16 v[226:227], v240 offset:9216
  ds_read_b64_tr_b16 v[228:229], v241 offset:8192
  ds_read_b64_tr_b16 v[230:231], v241 offset:9216
  s_waitcnt vmcnt(12)
  ds_read_b64_tr_b16 v[232:233], v240 offset:10240
  ds_read_b64_tr_b16 v[234:235], v240 offset:11264
  ds_read_b64_tr_b16 v[236:237], v241 offset:10240
  ds_read_b64_tr_b16 v[238:239], v241 offset:11264
  s_waitcnt lgkmcnt(4)
  v_mfma_f32_32x32x16_bf16 v[64:79], v[224:227], v[160:163], v[64:79]
  v_mfma_f32_32x32x16_bf16 v[80:95], v[228:231], v[160:163], v[80:95]
  v_mfma_f32_32x32x16_bf16 v[96:111], v[224:227], v[164:167], v[96:111]
  v_mfma_f32_32x32x16_bf16 v[112:127], v[228:231], v[164:167], v[112:127]
  s_waitcnt vmcnt(10)
  ds_read_b64_tr_b16 v[224:225], v240 offset:12288
  ds_read_b64_tr_b16 v[226:227], v240 offset:13312
  ds_read_b64_tr_b16 v[228:229], v241 offset:12288
  ds_read_b64_tr_b16 v[230:231], v241 offset:13312
  s_waitcnt lgkmcnt(4)
  v_mfma_f32_32x32x16_bf16 v[64:79], v[232:235], v[168:171], v[64:79]
  v_mfma_f32_32x32x16_bf16 v[80:95], v[236:239], v[168:171], v[80:95]
  v_mfma_f32_32x32x16_bf16 v[96:111], v[232:235], v[172:175], v[96:111]
  v_mfma_f32_32x32x16_bf16 v[112:127], v[236:239], v[172:175], v[112:127]
  s_waitcnt vmcnt(8)
  ds_read_b64_tr_b16 v[232:233], v240 offset:14336
  ds_read_b64_tr_b16 v[234:235], v240 offset:15360
  ds_read_b64_tr_b16 v[236:237], v241 offset:14336
  ds_read_b64_tr_b16 v[238:239], v241 offset:15360
  s_waitcnt lgkmcnt(4)
  v_mfma_f32_32x32x16_bf16 v[64:79], v[224:227], v[176:179], v[64:79]
  v_mfma_f32_32x32x16_bf16 v[80:95], v[228:231], v[176:179], v[80:95]
  v_mfma_f32_32x32x16_bf16 v[96:111], v[224:227], v[180:183], v[96:111]
  v_mfma_f32_32x32x16_bf16 v[112:127], v[228:231], v[180:183], v[112:127]
  s_waitcnt vmcnt(6)
  ds_read_b64_tr_b16 v[224:225], v240 offset:16384
  ds_read_b64_tr_b16 v[226:227], v240 offset:17408
  ds_read_b64_tr_b16 v[228:229], v241 offset:16384
  ds_read_b64_tr_b16 v[230:231], v241 offset:17408
  s_waitcnt lgkmcnt(4)
  v_mfma_f32_32x32x16_bf16 v[64:79], v[232:235], v[184:187], v[64:79]
  v_mfma_f32_32x32x16_bf16 v[80:95], v[236:239], v[184:187], v[80:95]
  v_mfma_f32_32x32x16_bf16 v[96:111], v[232:235], v[188:191], v[96:111]
  v_mfma_f32_32x32x16_bf16 v[112:127], v[236:239], v[188:191], v[112:127]
  s_waitcnt vmcnt(4)
  ds_read_b64_tr_b16 v[232:233], v240 offset:18432
  ds_read_b64_tr_b16 v[234:235], v240 offset:19456
  ds_read_b64_tr_b16 v[236:237], v241 offset:18432
  ds_read_b64_tr_b16 v[238:239], v241 offset:19456
  s_waitcnt lgkmcnt(4)
  v_mfma_f32_32x32x16_bf16 v[64:79], v[224:227], v[192:195], v[64:79]
  v_mfma_f32_32x32x16_bf16 v[80:95], v[228:231], v[192:195], v[80:95]
  v_mfma_f32_32x32x16_bf16 v[96:111], v[224:227], v[196:199], v[96:111]
  v_mfma_f32_32x32x16_bf16 v[112:127], v[228:231], v[196:199], v[112:127]
  s_waitcnt vmcnt(2)
  ds_read_b64_tr_b16 v[224:225], v240 offset:20480
  ds_read_b64_tr_b16 v[226:227], v240 offset:21504
  ds_read_b64_tr_b16 v[228:229], v241 offset:20480
  ds_read_b64_tr_b16 v[230:231], v241 offset:21504
  s_waitcnt lgkmcnt(4)
  v_mfma_f32_32x32x16_bf16 v[64:79], v[232:235], v[200:203], v[64:79]
  v_mfma_f32_32x32x16_bf16 v[80:95], v[236:239], v[200:203], v[80:95]
  v_mfma_f32_32x32x16_bf16 v[96:111], v[232:235], v[204:207], v[96:111]
  v_mfma_f32_32x32x16_bf16 v[112:127], v[236:239], v[204:207], v[112:127]
  s_waitcnt vmcnt(0)
  ds_read_b64_tr_b16 v[232:233], v240 offset:22528
  ds_read_b64_tr_b16 v[234:235], v240 offset:23552
  ds_read_b64_tr_b16 v[236:237], v241 offset:22528
  ds_read_b64_tr_b16 v[238:239], v241 offset:23552
  s_waitcnt lgkmcnt(4)
  v_mfma_f32_32x32x16_bf16 v[64:79], v[224:227], v[208:211], v[64:79]
  v_mfma_f32_32x32x16_bf16 v[80:95], v[228:231], v[208:211], v[80:95]
  v_mfma_f32_32x32x16_bf16 v[96:111], v[224:227], v[212:215], v[96:111]
  v_mfma_f32_32x32x16_bf16 v[112:127], v[228:231], v[212:215], v[112:127]
  s_waitcnt lgkmcnt(0)
  v_mfma_f32_32x32x16_bf16 v[64:79], v[232:235], v[216:219], v[64:79]
  v_mfma_f32_32x32x16_bf16 v[80:95], v[236:239], v[216:219], v[80:95]
  v_mfma_f32_32x32x16_bf16 v[96:111], v[232:235], v[220:223], v[96:111]
  v_mfma_f32_32x32x16_bf16 v[112:127], v[236:239], v[220:223], v[112:127]
  v_and_b32 v244, 31, v0
  s_movk_i32 s10, 272
  v_mul_lo_u32 v244, v244, s10
  v_lshrrev_b32 v245, 5, v0
  v_lshlrev_b32 v245, 4, v245
  v_add_u32 v244, v244, v245
  v_add_u32 v244, s88, v244
  v_lshrrev_b32 v2, 3, v0
  v_and_b32 v3, 7, v0
  v_lshlrev_b32 v4, 10, v2
  v_lshlrev_b32 v5, 4, v3
  v_add_u32 v4, v4, v5
  s_lshl_b32 s10, s86, 16
  s_lshl_b32 s11, s3, 14
  s_add_u32 s10, s10, s11
  s_lshl_b32 s11, s87, 7
  s_add_u32 s12, s10, s11
  s_add_u32 s13, s12, 8192
  buffer_load_dwordx4 v[8:11], v4, s[36:39], s12 offen
  buffer_load_dwordx4 v[12:15], v4, s[36:39], s13 offen
  ds_write_b128 v244, v[64:67] offset:0
  ds_write_b128 v244, v[68:71] offset:32
  ds_write_b128 v244, v[72:75] offset:64
  ds_write_b128 v244, v[76:79] offset:96
  ds_write_b128 v244, v[80:83] offset:128
  ds_write_b128 v244, v[84:87] offset:160
  ds_write_b128 v244, v[88:91] offset:192
  ds_write_b128 v244, v[92:95] offset:224
  ds_write_b128 v244, v[96:99] offset:8704
  ds_write_b128 v244, v[100:103] offset:8736
  ds_write_b128 v244, v[104:107] offset:8768
  ds_write_b128 v244, v[108:111] offset:8800
  ds_write_b128 v244, v[112:115] offset:8832
  ds_write_b128 v244, v[116:119] offset:8864
  ds_write_b128 v244, v[120:123] offset:8896
  ds_write_b128 v244, v[124:127] offset:8928
  s_waitcnt lgkmcnt(0)
  v_mov_b32 v6, 12812
  v_mov_b32 v7, 1
  s_mov_b64 exec, 1
  ds_add_u32 v6, v7
  s_mov_b64 exec, -1
  v_mov_b32 v6, 12812
  s_mov_b32 s15, 0
L_fr_bar:
  s_add_u32 s15, s15, 1
  s_cmp_gt_u32 s15, 1000000
  s_cbranch_scc1 L_fr_bar_ok
  ds_read_b32 v7, v6
  s_waitcnt lgkmcnt(0)
  v_readfirstlane_b32 s10, v7
  s_nop 3
  s_cmp_ge_u32 s10, 4
  s_cbranch_scc1 L_fr_bar_ok
  s_sleep 1
  s_branch L_fr_bar
L_fr_bar_ok:
  s_movk_i32 s10, 272
  v_mul_lo_u32 v6, v2, s10
  v_lshlrev_b32 v7, 5, v3
  v_add_u32 v6, v6, v7
  s_mul_i32 s10, s3, 4352
  s_add_u32 s10, s10, 16384
  v_add_u32 v6, s10, v6
  v_add_u32 v7, 49152, v6
  ds_read_b128 v[128:131], v6 offset:0
  ds_read_b128 v[132:135], v6 offset:16
  ds_read_b128 v[136:139], v6 offset:24576
  ds_read_b128 v[140:143], v6 offset:24592
  ds_read_b128 v[144:147], v7 offset:0
  ds_read_b128 v[148:151], v7 offset:16
  ds_read_b128 v[152:155], v7 offset:24576
  ds_read_b128 v[156:159], v7 offset:24592
  ds_read_b128 v[160:163], v6 offset:2176
  ds_read_b128 v[164:167], v6 offset:2192
  ds_read_b128 v[168:171], v6 offset:26752
  ds_read_b128 v[172:175], v6 offset:26768
  ds_read_b128 v[176:179], v7 offset:2176
  ds_read_b128 v[180:183], v7 offset:2192
  ds_read_b128 v[184:187], v7 offset:26752
  ds_read_b128 v[188:191], v7 offset:26768
  s_waitcnt vmcnt(0) lgkmcnt(0)
  v_add_f32 v128, v128, v136
  v_add_f32 v144, v144, v152
  v_add_f32 v129, v129, v137
  v_add_f32 v145, v145, v153
  v_add_f32 v130, v130, v138
  v_add_f32 v146, v146, v154
  v_add_f32 v131, v131, v139
  v_add_f32 v147, v147, v155
  v_add_f32 v132, v132, v140
  v_add_f32 v148, v148, v156
  v_add_f32 v133, v133, v141
  v_add_f32 v149, v149, v157
  v_add_f32 v134, v134, v142
  v_add_f32 v150, v150, v158
  v_add_f32 v135, v135, v143
  v_add_f32 v151, v151, v159
  v_add_f32 v128, v128, v144
  v_add_f32 v129, v129, v145
  v_add_f32 v130, v130, v146
  v_add_f32 v131, v131, v147
  v_add_f32 v132, v132, v148
  v_add_f32 v133, v133, v149
  v_add_f32 v134, v134, v150
  v_add_f32 v135, v135, v151
  v_lshlrev_b32 v136, 16, v8
  v_and_b32 v137, 0xffff0000, v8
  v_add_f32 v128, v128, v136
  v_add_f32 v129, v129, v137
  v_lshlrev_b32 v136, 16, v9
  v_and_b32 v137, 0xffff0000, v9
  v_add_f32 v130, v130, v136
  v_add_f32 v131, v131, v137
  v_lshlrev_b32 v136, 16, v10
  v_and_b32 v137, 0xffff0000, v10
  v_add_f32 v132, v132, v136
  v_add_f32 v133, v133, v137
  v_lshlrev_b32 v136, 16, v11
  v_and_b32 v137, 0xffff0000, v11
  v_add_f32 v134, v134, v136
  v_add_f32 v135, v135, v137
  v_cvt_pk_bf16_f32 v144, v128, v129
  v_cvt_pk_bf16_f32 v145, v130, v131
  v_cvt_pk_bf16_f32 v146, v132, v133
  v_cvt_pk_bf16_f32 v147, v134, v135
  buffer_store_dwordx4 v[144:147], v4, s[60:63], s12 offen
  v_add_f32 v160, v160, v168
  v_add_f32 v176, v176, v184
  v_add_f32 v161, v161, v169
  v_add_f32 v177, v177, v185
  v_add_f32 v162, v162, v170
  v_add_f32 v178, v178, v186
  v_add_f32 v163, v163, v171
  v_add_f32 v179, v179, v187
  v_add_f32 v164, v164, v172
  v_add_f32 v180, v180, v188
  v_add_f32 v165, v165, v173
  v_add_f32 v181, v181, v189
  v_add_f32 v166, v166, v174
  v_add_f32 v182, v182, v190
  v_add_f32 v167, v167, v175
  v_add_f32 v183, v183, v191
  v_add_f32 v160, v160, v176
  v_add_f32 v161, v161, v177
  v_add_f32 v162, v162, v178
  v_add_f32 v163, v163, v179
  v_add_f32 v164, v164, v180
  v_add_f32 v165, v165, v181
  v_add_f32 v166, v166, v182
  v_add_f32 v167, v167, v183
  v_lshlrev_b32 v168, 16, v12
  v_and_b32 v169, 0xffff0000, v12
  v_add_f32 v160, v160, v168
  v_add_f32 v161, v161, v169
  v_lshlrev_b32 v168, 16, v13
  v_and_b32 v169, 0xffff0000, v13
  v_add_f32 v162, v162, v168
  v_add_f32 v163, v163, v169
  v_lshlrev_b32 v168, 16, v14
  v_and_b32 v169, 0xffff0000, v14
  v_add_f32 v164, v164, v168
  v_add_f32 v165, v165, v169
  v_lshlrev_b32 v168, 16, v15
  v_and_b32 v169, 0xffff0000, v15
  v_add_f32 v166, v166, v168
  v_add_f32 v167, v167, v169
  v_cvt_pk_bf16_f32 v176, v160, v161
  v_cvt_pk_bf16_f32 v177, v162, v163
  v_cvt_pk_bf16_f32 v178, v164, v165
  v_cvt_pk_bf16_f32 v179, v166, v167
  buffer_store_dwordx4 v[176:179], v4, s[60:63], s13 offen
  s_waitcnt vmcnt(0)
  s_waitcnt vmcnt(0)
  s_endpgm
L_hwave:
  s_sub_u32 s80, s3, 4
  v_lshrrev_b32 v62, 3, v0
  v_and_b32 v63, 7, v0
  v_lshrrev_b32 v64, 4, v0
  v_xor_b32 v65, v63, v64
  v_lshlrev_b32 v65, 4, v65
  v_lshlrev_b32 v66, 10, v62
  v_add_u32 v1, v66, v65
  v_xor_b32 v2, 64, v1
  v_and_b32 v64, 1, v64
  v_lshlrev_b32 v64, 2, v64
  v_xor_b32 v63, v63, v64
  v_lshlrev_b32 v63, 4, v63
  s_movk_i32 s10, 3072
  v_mul_lo_u32 v64, v62, s10
  v_add_u32 v4, v64, v63
  s_movk_i32 s10, 3584
  v_mul_lo_u32 v64, v62, s10
  s_lshr_b32 s11, s80, 1
  s_lshl_b32 s12, s11, 5
  v_xor_b32 v65, s12, v63
  v_add_u32 v5, v64, v65
  s_cmp_eq_u32 s11, 0
  s_cselect_b32 s84, s48, s52
  s_cselect_b32 s85, s49, s53
  s_mov_b32 s86, 1835008
  s_mov_b32 s87, 0x20000
  s_and_b32 s15, s80, 1
  s_mul_i32 s12, s15, 32*3584
  s_lshl_b32 s14, s91, 7
  s_add_u32 s78, s14, s12
  s_lshl_b32 s10, s92, 7
  s_mul_i32 s12, s15, 32*3072
  s_add_u32 s77, s10, s12
  s_lshl_b32 s10, s6, 17
  s_lshl_b32 s12, s80, 15
  s_add_u32 s81, s10, s12
  s_lshl_b32 s82, s80, 12
  s_cmp_eq_u32 s9, 3
  s_cbranch_scc1 L_h_typeB
  v_mov_b32 v3, v5
  s_mov_b32 s72, s84
  s_mov_b32 s73, s85
  s_mov_b32 s74, 1835008
  s_lshl_b32 s13, s90, 7
  s_mul_i32 s12, s15, 32*3584
  s_add_u32 s76, s13, s12
  s_movk_i32 s79, 3584
  s_branch L_h_typeDone
L_h_typeB:
  v_mov_b32 v3, v4
  s_mov_b32 s72, s40
  s_mov_b32 s73, s41
  s_mov_b32 s74, 1572864
  s_lshl_b32 s11, s8, 2
  s_lshr_b32 s10, s80, 1
  s_add_u32 s10, s10, s11
  s_add_u32 s10, s10, 1
  s_lshl_b32 s10, s10, 7
  s_mul_i32 s12, s15, 32*3072
  s_add_u32 s76, s10, s12
  s_movk_i32 s79, 3072
L_h_typeDone:
  s_mov_b32 s75, 0x20000
  s_add_u32 s11, s95, 0
  s_and_b32 s11, s11, 7
  s_lshl_b32 s11, s11, 7
  s_add_u32 s11, s11, s81
  s_add_u32 s10, s11, 0
  s_add_u32 m0, s82, 16384
  s_nop 0
  buffer_load_dwordx4 v1, s[36:39], s10 offen lds
  s_add_u32 s10, s11, 8192
  s_add_u32 m0, s82, 17408
  s_nop 0
  buffer_load_dwordx4 v2, s[36:39], s10 offen lds
  s_add_u32 s10, s11, 16384
  s_add_u32 m0, s82, 18432
  s_nop 0
  buffer_load_dwordx4 v1, s[36:39], s10 offen lds
  s_add_u32 s10, s11, 24576
  s_add_u32 m0, s82, 19456
  s_nop 0
  buffer_load_dwordx4 v2, s[36:39], s10 offen lds
  s_add_u32 s11, s95, 0
  s_and_b32 s11, s11, 7
  s_lshl_b32 s11, s11, 6
  s_mul_i32 s11, s11, s79
  s_add_u32 s11, s11, s76
  s_lshl_b32 s12, s79, 3
  s_add_u32 m0, s82, 32768
  s_nop 0
  buffer_load_dwordx4 v3, s[72:75], s11 offen lds
  s_add_u32 s11, s11, s12
  s_add_u32 m0, s82, 33792
  s_nop 0
  buffer_load_dwordx4 v3, s[72:75], s11 offen lds
  s_add_u32 s11, s11, s12
  s_add_u32 m0, s82, 34816
  s_nop 0
  buffer_load_dwordx4 v3, s[72:75], s11 offen lds
  s_add_u32 s11, s11, s12
  s_add_u32 m0, s82, 35840
  s_nop 0
  buffer_load_dwordx4 v3, s[72:75], s11 offen lds
  s_waitcnt vmcnt(8)
  s_waitcnt lgkmcnt(0)
  s_add_u32 s33, s32, 1
  s_lshl_b32 s33, s33, 3
  s_add_u32 s11, s95, 1
  s_and_b32 s11, s11, 7
  s_lshl_b32 s11, s11, 7
  s_add_u32 s11, s11, s81
  s_add_u32 s10, s11, 0
  s_add_u32 m0, s82, 49152
  s_nop 0
  buffer_load_dwordx4 v1, s[36:39], s10 offen lds
  s_add_u32 s10, s11, 8192
  s_add_u32 m0, s82, 50176
  s_nop 0
  buffer_load_dwordx4 v2, s[36:39], s10 offen lds
  s_add_u32 s10, s11, 16384
  s_add_u32 m0, s82, 51200
  s_nop 0
  buffer_load_dwordx4 v1, s[36:39], s10 offen lds
  s_add_u32 s10, s11, 24576
  s_add_u32 m0, s82, 52224
  s_nop 0
  buffer_load_dwordx4 v2, s[36:39], s10 offen lds
  s_add_u32 s11, s95, 1
  s_and_b32 s11, s11, 7
  s_lshl_b32 s11, s11, 6
  s_mul_i32 s11, s11, s79
  s_add_u32 s11, s11, s76
  s_lshl_b32 s12, s79, 3
  s_add_u32 m0, s82, 65536
  s_nop 0
  buffer_load_dwordx4 v3, s[72:75], s11 offen lds
  s_add_u32 s11, s11, s12
  s_add_u32 m0, s82, 66560
  s_nop 0
  buffer_load_dwordx4 v3, s[72:75], s11 offen lds
  s_add_u32 s11, s11, s12
  s_add_u32 m0, s82, 67584
  s_nop 0
  buffer_load_dwordx4 v3, s[72:75], s11 offen lds
  s_add_u32 s11, s11, s12
  s_add_u32 m0, s82, 68608
  s_nop 0
  buffer_load_dwordx4 v3, s[72:75], s11 offen lds
  v_lshlrev_b32 v62, 2, v0
  v_mov_b32 v63, 0
  ds_write_b32 v62, v63 offset:12800
  v_and_b32 v62, 15, v0
  v_lshlrev_b32 v62, 2, v62
  s_lshl_b32 s10, s6, 7
  s_add_u32 s10, s10, 0
  v_add_u32 v63, s10, v62
  s_lshl_b32 s10, s7, 7
  s_add_u32 s10, s10, 2048
  v_add_u32 v64, s10, v62
  v_cmp_gt_u32 vcc, 16, v0
  s_nop 1
  v_cndmask_b32 v17, v64, v63, vcc
  s_waitcnt vmcnt(8)
  s_waitcnt lgkmcnt(0)
  s_barrier
  s_add_u32 s11, s95, 2
  s_and_b32 s11, s11, 7
  s_lshl_b32 s11, s11, 7
  s_add_u32 s11, s11, s81
  s_add_u32 s10, s11, 0
  s_add_u32 m0, s82, 81920
  s_nop 0
  buffer_load_dwordx4 v1, s[36:39], s10 offen lds
  s_add_u32 s10, s11, 8192
  s_add_u32 m0, s82, 82944
  s_nop 0
  buffer_load_dwordx4 v2, s[36:39], s10 offen lds
  s_add_u32 s10, s11, 16384
  s_add_u32 m0, s82, 83968
  s_nop 0
  buffer_load_dwordx4 v1, s[36:39], s10 offen lds
  s_add_u32 s10, s11, 24576
  s_add_u32 m0, s82, 84992
  s_nop 0
  buffer_load_dwordx4 v2, s[36:39], s10 offen lds
  s_add_u32 s11, s95, 2
  s_and_b32 s11, s11, 7
  s_lshl_b32 s11, s11, 6
  s_mul_i32 s11, s11, s79
  s_add_u32 s11, s11, s76
  s_lshl_b32 s12, s79, 3
  s_add_u32 m0, s82, 98304
  s_nop 0
  buffer_load_dwordx4 v3, s[72:75], s11 offen lds
  s_add_u32 s11, s11, s12
  s_add_u32 m0, s82, 99328
  s_nop 0
  buffer_load_dwordx4 v3, s[72:75], s11 offen lds
  s_add_u32 s11, s11, s12
  s_add_u32 m0, s82, 100352
  s_nop 0
  buffer_load_dwordx4 v3, s[72:75], s11 offen lds
  s_add_u32 s11, s11, s12
  s_add_u32 m0, s82, 101376
  s_nop 0
  buffer_load_dwordx4 v3, s[72:75], s11 offen lds
  s_add_u32 s11, s95, 3
  s_and_b32 s11, s11, 7
  s_lshl_b32 s11, s11, 7
  s_add_u32 s11, s11, s81
  s_add_u32 s10, s11, 0
  s_add_u32 m0, s82, 114688
  s_nop 0
  buffer_load_dwordx4 v1, s[36:39], s10 offen lds
  s_add_u32 s10, s11, 8192
  s_add_u32 m0, s82, 115712
  s_nop 0
  buffer_load_dwordx4 v2, s[36:39], s10 offen lds
  s_add_u32 s10, s11, 16384
  s_add_u32 m0, s82, 116736
  s_nop 0
  buffer_load_dwordx4 v1, s[36:39], s10 offen lds
  s_add_u32 s10, s11, 24576
  s_add_u32 m0, s82, 117760
  s_nop 0
  buffer_load_dwordx4 v2, s[36:39], s10 offen lds
  s_add_u32 s11, s95, 3
  s_and_b32 s11, s11, 7
  s_lshl_b32 s11, s11, 6
  s_mul_i32 s11, s11, s79
  s_add_u32 s11, s11, s76
  s_lshl_b32 s12, s79, 3
  s_add_u32 m0, s82, 131072
  s_nop 0
  buffer_load_dwordx4 v3, s[72:75], s11 offen lds
  s_add_u32 s11, s11, s12
  s_add_u32 m0, s82, 132096
  s_nop 0
  buffer_load_dwordx4 v3, s[72:75], s11 offen lds
  s_add_u32 s11, s11, s12
  s_add_u32 m0, s82, 133120
  s_nop 0
  buffer_load_dwordx4 v3, s[72:75], s11 offen lds
  s_add_u32 s11, s11, s12
  s_add_u32 m0, s82, 134144
  s_nop 0
  buffer_load_dwordx4 v3, s[72:75], s11 offen lds
  s_waitcnt vmcnt(16)
  s_barrier
  s_add_u32 s11, s95, 4
  s_and_b32 s11, s11, 7
  s_lshl_b32 s11, s11, 7
  s_add_u32 s11, s11, s81
  s_add_u32 s10, s11, 0
  s_add_u32 m0, s82, 147456
  s_nop 0
  buffer_load_dwordx4 v1, s[36:39], s10 offen lds
  s_add_u32 s10, s11, 8192
  s_add_u32 m0, s82, 148480
  s_nop 0
  buffer_load_dwordx4 v2, s[36:39], s10 offen lds
  s_add_u32 s10, s11, 16384
  s_add_u32 m0, s82, 149504
  s_nop 0
  buffer_load_dwordx4 v1, s[36:39], s10 offen lds
  s_add_u32 s10, s11, 24576
  s_add_u32 m0, s82, 150528
  s_nop 0
  buffer_load_dwordx4 v2, s[36:39], s10 offen lds
  s_add_u32 s11, s95, 4
  s_and_b32 s11, s11, 7
  s_lshl_b32 s11, s11, 6
  s_mul_i32 s11, s11, s79
  s_add_u32 s11, s11, s76
  s_lshl_b32 s12, s79, 3
  s_add_u32 m0, s82, 16384
  s_nop 0
  buffer_load_dwordx4 v3, s[72:75], s11 offen lds
  s_add_u32 s11, s11, s12
  s_add_u32 m0, s82, 17408
  s_nop 0
  buffer_load_dwordx4 v3, s[72:75], s11 offen lds
  s_add_u32 s11, s11, s12
  s_add_u32 m0, s82, 18432
  s_nop 0
  buffer_load_dwordx4 v3, s[72:75], s11 offen lds
  s_add_u32 s11, s11, s12
  s_add_u32 m0, s82, 19456
  s_nop 0
  buffer_load_dwordx4 v3, s[72:75], s11 offen lds
  s_waitcnt vmcnt(16)
  s_barrier
  s_add_u32 s11, s95, 5
  s_and_b32 s11, s11, 7
  s_lshl_b32 s11, s11, 7
  s_add_u32 s11, s11, s81
  s_add_u32 s10, s11, 0
  s_add_u32 m0, s82, 32768
  s_nop 0
  buffer_load_dwordx4 v1, s[36:39], s10 offen lds
  s_add_u32 s10, s11, 8192
  s_add_u32 m0, s82, 33792
  s_nop 0
  buffer_load_dwordx4 v2, s[36:39], s10 offen lds
  s_add_u32 s10, s11, 16384
  s_add_u32 m0, s82, 34816
  s_nop 0
  buffer_load_dwordx4 v1, s[36:39], s10 offen lds
  s_add_u32 s10, s11, 24576
  s_add_u32 m0, s82, 35840
  s_nop 0
  buffer_load_dwordx4 v2, s[36:39], s10 offen lds
  s_add_u32 s11, s95, 5
  s_and_b32 s11, s11, 7
  s_lshl_b32 s11, s11, 6
  s_mul_i32 s11, s11, s79
  s_add_u32 s11, s11, s76
  s_lshl_b32 s12, s79, 3
  s_add_u32 m0, s82, 49152
  s_nop 0
  buffer_load_dwordx4 v3, s[72:75], s11 offen lds
  s_add_u32 s11, s11, s12
  s_add_u32 m0, s82, 50176
  s_nop 0
  buffer_load_dwordx4 v3, s[72:75], s11 offen lds
  s_add_u32 s11, s11, s12
  s_add_u32 m0, s82, 51200
  s_nop 0
  buffer_load_dwordx4 v3, s[72:75], s11 offen lds
  s_add_u32 s11, s11, s12
  s_add_u32 m0, s82, 52224
  s_nop 0
  buffer_load_dwordx4 v3, s[72:75], s11 offen lds
  s_waitcnt vmcnt(16)
  s_barrier
  s_add_u32 s11, s95, 6
  s_and_b32 s11, s11, 7
  s_lshl_b32 s11, s11, 7
  s_add_u32 s11, s11, s81
  s_add_u32 s10, s11, 0
  s_add_u32 m0, s82, 65536
  s_nop 0
  buffer_load_dwordx4 v1, s[36:39], s10 offen lds
  s_add_u32 s10, s11, 8192
  s_add_u32 m0, s82, 66560
  s_nop 0
  buffer_load_dwordx4 v2, s[36:39], s10 offen lds
  s_add_u32 s10, s11, 16384
  s_add_u32 m0, s82, 67584
  s_nop 0
  buffer_load_dwordx4 v1, s[36:39], s10 offen lds
  s_add_u32 s10, s11, 24576
  s_add_u32 m0, s82, 68608
  s_nop 0
  buffer_load_dwordx4 v2, s[36:39], s10 offen lds
  s_add_u32 s11, s95, 6
  s_and_b32 s11, s11, 7
  s_lshl_b32 s11, s11, 6
  s_mul_i32 s11, s11, s79
  s_add_u32 s11, s11, s76
  s_lshl_b32 s12, s79, 3
  s_add_u32 m0, s82, 81920
  s_nop 0
  buffer_load_dwordx4 v3, s[72:75], s11 offen lds
  s_add_u32 s11, s11, s12
  s_add_u32 m0, s82, 82944
  s_nop 0
  buffer_load_dwordx4 v3, s[72:75], s11 offen lds
  s_add_u32 s11, s11, s12
  s_add_u32 m0, s82, 83968
  s_nop 0
  buffer_load_dwordx4 v3, s[72:75], s11 offen lds
  s_add_u32 s11, s11, s12
  s_add_u32 m0, s82, 84992
  s_nop 0
  buffer_load_dwordx4 v3, s[72:75], s11 offen lds
  s_waitcnt vmcnt(16)
  s_barrier
  s_add_u32 s11, s95, 7
  s_and_b32 s11, s11, 7
  s_lshl_b32 s11, s11, 7
  s_add_u32 s11, s11, s81
  s_add_u32 s10, s11, 0
  s_add_u32 m0, s82, 98304
  s_nop 0
  buffer_load_dwordx4 v1, s[36:39], s10 offen lds
  s_add_u32 s10, s11, 8192
  s_add_u32 m0, s82, 99328
  s_nop 0
  buffer_load_dwordx4 v2, s[36:39], s10 offen lds
  s_add_u32 s10, s11, 16384
  s_add_u32 m0, s82, 100352
  s_nop 0
  buffer_load_dwordx4 v1, s[36:39], s10 offen lds
  s_add_u32 s10, s11, 24576
  s_add_u32 m0, s82, 101376
  s_nop 0
  buffer_load_dwordx4 v2, s[36:39], s10 offen lds
  s_add_u32 s11, s95, 7
  s_and_b32 s11, s11, 7
  s_lshl_b32 s11, s11, 6
  s_mul_i32 s11, s11, s79
  s_add_u32 s11, s11, s76
  s_lshl_b32 s12, s79, 3
  s_add_u32 m0, s82, 114688
  s_nop 0
  buffer_load_dwordx4 v3, s[72:75], s11 offen lds
  s_add_u32 s11, s11, s12
  s_add_u32 m0, s82, 115712
  s_nop 0
  buffer_load_dwordx4 v3, s[72:75], s11 offen lds
  s_add_u32 s11, s11, s12
  s_add_u32 m0, s82, 116736
  s_nop 0
  buffer_load_dwordx4 v3, s[72:75], s11 offen lds
  s_add_u32 s11, s11, s12
  s_add_u32 m0, s82, 117760
  s_nop 0
  buffer_load_dwordx4 v3, s[72:75], s11 offen lds
  s_waitcnt vmcnt(16)
  s_barrier
  s_lshr_b32 s11, s80, 1
  s_add_u32 s11, s11, s95
  s_add_u32 s11, s11, 0
  s_and_b32 s11, s11, 7
  s_mul_i32 s11, s11, 64*3072
  s_add_u32 s11, s11, s77
  s_add_u32 s10, s11, 0
  s_add_u32 m0, s82, 131072
  s_nop 0
  buffer_load_dwordx4 v4, s[40:43], s10 offen lds
  s_add_u32 s10, s11, 24576
  s_add_u32 m0, s82, 132096
  s_nop 0
  buffer_load_dwordx4 v4, s[40:43], s10 offen lds
  s_add_u32 s10, s11, 49152
  s_add_u32 m0, s82, 133120
  s_nop 0
  buffer_load_dwordx4 v4, s[40:43], s10 offen lds
  s_add_u32 s10, s11, 73728
  s_add_u32 m0, s82, 134144
  s_nop 0
  buffer_load_dwordx4 v4, s[40:43], s10 offen lds
  s_lshr_b32 s11, s80, 1
  s_add_u32 s11, s11, s95
  s_add_u32 s11, s11, 2
  s_and_b32 s11, s11, 7
  s_mul_i32 s11, s11, 64*3072
  s_add_u32 s11, s11, s77
  s_add_u32 s10, s11, 0
  s_add_u32 m0, s82, 147456
  s_nop 0
  buffer_load_dwordx4 v4, s[40:43], s10 offen lds
  s_add_u32 s10, s11, 24576
  s_add_u32 m0, s82, 148480
  s_nop 0
  buffer_load_dwordx4 v4, s[40:43], s10 offen lds
  s_add_u32 s10, s11, 49152
  s_add_u32 m0, s82, 149504
  s_nop 0
  buffer_load_dwordx4 v4, s[40:43], s10 offen lds
  s_add_u32 s10, s11, 73728
  s_add_u32 m0, s82, 150528
  s_nop 0
  buffer_load_dwordx4 v4, s[40:43], s10 offen lds
  s_waitcnt vmcnt(16)
  s_barrier
  s_lshr_b32 s11, s80, 1
  s_add_u32 s11, s11, s95
  s_add_u32 s11, s11, 4
  s_and_b32 s11, s11, 7
  s_mul_i32 s11, s11, 64*3072
  s_add_u32 s11, s11, s77
  s_add_u32 s10, s11, 0
  s_add_u32 m0, s82, 16384
  s_nop 0
  buffer_load_dwordx4 v4, s[40:43], s10 offen lds
  s_add_u32 s10, s11, 24576
  s_add_u32 m0, s82, 17408
  s_nop 0
  buffer_load_dwordx4 v4, s[40:43], s10 offen lds
  s_add_u32 s10, s11, 49152
  s_add_u32 m0, s82, 18432
  s_nop 0
  buffer_load_dwordx4 v4, s[40:43], s10 offen lds
  s_add_u32 s10, s11, 73728
  s_add_u32 m0, s82, 19456
  s_nop 0
  buffer_load_dwordx4 v4, s[40:43], s10 offen lds
  s_lshr_b32 s11, s80, 1
  s_add_u32 s11, s11, s95
  s_add_u32 s11, s11, 6
  s_and_b32 s11, s11, 7
  s_mul_i32 s11, s11, 64*3072
  s_add_u32 s11, s11, s77
  s_add_u32 s10, s11, 0
  s_add_u32 m0, s82, 32768
  s_nop 0
  buffer_load_dwordx4 v4, s[40:43], s10 offen lds
  s_add_u32 s10, s11, 24576
  s_add_u32 m0, s82, 33792
  s_nop 0
  buffer_load_dwordx4 v4, s[40:43], s10 offen lds
  s_add_u32 s10, s11, 49152
  s_add_u32 m0, s82, 34816
  s_nop 0
  buffer_load_dwordx4 v4, s[40:43], s10 offen lds
  s_add_u32 s10, s11, 73728
  s_add_u32 m0, s82, 35840
  s_nop 0
  buffer_load_dwordx4 v4, s[40:43], s10 offen lds
  s_waitcnt vmcnt(16)
  s_barrier
  s_mov_b32 s14, 16777216
  buffer_load_dword v16, v17, s[68:71], s14 offen sc1
  s_add_u32 s11, s95, 0
  s_and_b32 s11, s11, 7
  s_mul_i32 s11, s11, 64*3584
  s_add_u32 s11, s11, s78
  s_add_u32 s10, s11, 0
  s_add_u32 m0, s82, 49152
  s_nop 0
  buffer_load_dwordx4 v5, s[84:87], s10 offen lds
  s_add_u32 s10, s11, 28672
  s_add_u32 m0, s82, 50176
  s_nop 0
  buffer_load_dwordx4 v5, s[84:87], s10 offen lds
  s_add_u32 s10, s11, 57344
  s_add_u32 m0, s82, 51200
  s_nop 0
  buffer_load_dwordx4 v5, s[84:87], s10 offen lds
  s_add_u32 s10, s11, 86016
  s_add_u32 m0, s82, 52224
  s_nop 0
  buffer_load_dwordx4 v5, s[84:87], s10 offen lds
  s_add_u32 s11, s95, 1
  s_and_b32 s11, s11, 7
  s_mul_i32 s11, s11, 64*3584
  s_add_u32 s11, s11, s78
  s_add_u32 s10, s11, 0
  s_add_u32 m0, s82, 65536
  s_nop 0
  buffer_load_dwordx4 v5, s[84:87], s10 offen lds
  s_add_u32 s10, s11, 28672
  s_add_u32 m0, s82, 66560
  s_nop 0
  buffer_load_dwordx4 v5, s[84:87], s10 offen lds
  s_add_u32 s10, s11, 57344
  s_add_u32 m0, s82, 67584
  s_nop 0
  buffer_load_dwordx4 v5, s[84:87], s10 offen lds
  s_add_u32 s10, s11, 86016
  s_add_u32 m0, s82, 68608
  s_nop 0
  buffer_load_dwordx4 v5, s[84:87], s10 offen lds
  s_waitcnt vmcnt(21)
  s_barrier
  s_add_u32 s11, s95, 2
  s_and_b32 s11, s11, 7
  s_mul_i32 s11, s11, 64*3584
  s_add_u32 s11, s11, s78
  s_add_u32 s10, s11, 0
  s_add_u32 m0, s82, 81920
  s_nop 0
  buffer_load_dwordx4 v5, s[84:87], s10 offen lds
  s_add_u32 s10, s11, 28672
  s_add_u32 m0, s82, 82944
  s_nop 0
  buffer_load_dwordx4 v5, s[84:87], s10 offen lds
  s_add_u32 s10, s11, 57344
  s_add_u32 m0, s82, 83968
  s_nop 0
  buffer_load_dwordx4 v5, s[84:87], s10 offen lds
  s_add_u32 s10, s11, 86016
  s_add_u32 m0, s82, 84992
  s_nop 0
  buffer_load_dwordx4 v5, s[84:87], s10 offen lds
  s_add_u32 s11, s95, 3
  s_and_b32 s11, s11, 7
  s_mul_i32 s11, s11, 64*3584
  s_add_u32 s11, s11, s78
  s_add_u32 s10, s11, 0
  s_add_u32 m0, s82, 98304
  s_nop 0
  buffer_load_dwordx4 v5, s[84:87], s10 offen lds
  s_add_u32 s10, s11, 28672
  s_add_u32 m0, s82, 99328
  s_nop 0
  buffer_load_dwordx4 v5, s[84:87], s10 offen lds
  s_add_u32 s10, s11, 57344
  s_add_u32 m0, s82, 100352
  s_nop 0
  buffer_load_dwordx4 v5, s[84:87], s10 offen lds
  s_add_u32 s10, s11, 86016
  s_add_u32 m0, s82, 101376
  s_nop 0
  buffer_load_dwordx4 v5, s[84:87], s10 offen lds
  s_waitcnt vmcnt(25)
  s_barrier
  s_waitcnt vmcnt(16)
  s_add_u32 s13, s33, 1
  v_cmp_ne_u32 vcc, s13, v16
  s_nop 3
  s_and_b64 vcc, vcc, 0xffffffff
  s_cmp_eq_u64 vcc, 0
  s_cbranch_scc1 L_h_pok
  s_add_u32 s13, s33, 1
  s_mov_b32 s14, 16777216
  s_mov_b32 s15, 0
L_fw_prep:
  s_add_u32 s15, s15, 1
  s_cmp_gt_u32 s15, 100000
  s_cbranch_scc1 L_fw_prep_ok
  buffer_load_dword v16, v17, s[68:71], s14 offen sc1
  s_waitcnt vmcnt(0)
  v_cmp_ne_u32 vcc, s13, v16
  s_nop 3
  s_and_b64 vcc, vcc, 0xffffffff
  s_cmp_eq_u64 vcc, 0
  s_cbranch_scc1 L_fw_prep_ok
  s_sleep 4
  s_branch L_fw_prep
L_fw_prep_ok:
L_h_pok:
  v_and_b32 v62, 31, v0
  s_lshl_b32 s10, s6, 7
  s_lshl_b32 s11, s80, 5
  s_add_u32 s10, s10, s11
  v_add_u32 v62, s10, v62
  v_lshlrev_b32 v62, 4, v62
  s_mov_b32 s10, 15728640
  buffer_load_dwordx4 v[20:23], v62, s[68:71], s10 offen sc1
  v_lshlrev_b32 v63, 4, v0
  s_mul_i32 s10, s7, 10240
  s_add_u32 s10, s10, 15794176
  s_lshl_b32 s11, s80, 10
  s_add_u32 s10, s10, s11
  buffer_load_dwordx4 v[24:27], v63, s[68:71], s10 offen sc1
  s_add_u32 s10, s10, 4096
  buffer_load_dwordx4 v[28:31], v63, s[68:71], s10 offen sc1
  s_cmp_lt_u32 s80, 2
  s_cselect_b32 s11, 4096, 0
  s_add_u32 s10, s10, s11
  buffer_load_dwordx4 v[32:35], v63, s[68:71], s10 offen sc1
  s_add_u32 s11, s95, 4
  s_and_b32 s11, s11, 7
  s_mul_i32 s11, s11, 64*3584
  s_add_u32 s11, s11, s78
  s_add_u32 s10, s11, 0
  s_add_u32 m0, s82, 114688
  s_nop 0
  buffer_load_dwordx4 v5, s[84:87], s10 offen lds
  s_add_u32 s10, s11, 28672
  s_add_u32 m0, s82, 115712
  s_nop 0
  buffer_load_dwordx4 v5, s[84:87], s10 offen lds
  s_add_u32 s10, s11, 57344
  s_add_u32 m0, s82, 116736
  s_nop 0
  buffer_load_dwordx4 v5, s[84:87], s10 offen lds
  s_add_u32 s10, s11, 86016
  s_add_u32 m0, s82, 117760
  s_nop 0
  buffer_load_dwordx4 v5, s[84:87], s10 offen lds
  s_add_u32 s11, s95, 5
  s_and_b32 s11, s11, 7
  s_mul_i32 s11, s11, 64*3584
  s_add_u32 s11, s11, s78
  s_add_u32 s10, s11, 0
  s_add_u32 m0, s82, 131072
  s_nop 0
  buffer_load_dwordx4 v5, s[84:87], s10 offen lds
  s_add_u32 s10, s11, 28672
  s_add_u32 m0, s82, 132096
  s_nop 0
  buffer_load_dwordx4 v5, s[84:87], s10 offen lds
  s_add_u32 s10, s11, 57344
  s_add_u32 m0, s82, 133120
  s_nop 0
  buffer_load_dwordx4 v5, s[84:87], s10 offen lds
  s_add_u32 s10, s11, 86016
  s_add_u32 m0, s82, 134144
  s_nop 0
  buffer_load_dwordx4 v5, s[84:87], s10 offen lds
  s_barrier
  s_add_u32 s11, s95, 6
  s_and_b32 s11, s11, 7
  s_mul_i32 s11, s11, 64*3584
  s_add_u32 s11, s11, s78
  s_add_u32 s10, s11, 0
  s_add_u32 m0, s82, 147456
  s_nop 0
  buffer_load_dwordx4 v5, s[84:87], s10 offen lds
  s_add_u32 s10, s11, 28672
  s_add_u32 m0, s82, 148480
  s_nop 0
  buffer_load_dwordx4 v5, s[84:87], s10 offen lds
  s_add_u32 s10, s11, 57344
  s_add_u32 m0, s82, 149504
  s_nop 0
  buffer_load_dwordx4 v5, s[84:87], s10 offen lds
  s_add_u32 s10, s11, 86016
  s_add_u32 m0, s82, 150528
  s_nop 0
  buffer_load_dwordx4 v5, s[84:87], s10 offen lds
  s_barrier
  s_add_u32 s11, s95, 7
  s_and_b32 s11, s11, 7
  s_mul_i32 s11, s11, 64*3584
  s_add_u32 s11, s11, s78
  s_add_u32 s10, s11, 0
  s_add_u32 m0, s82, 16384
  s_nop 0
  buffer_load_dwordx4 v5, s[84:87], s10 offen lds
  s_add_u32 s10, s11, 28672
  s_add_u32 m0, s82, 17408
  s_nop 0
  buffer_load_dwordx4 v5, s[84:87], s10 offen lds
  s_add_u32 s10, s11, 57344
  s_add_u32 m0, s82, 18432
  s_nop 0
  buffer_load_dwordx4 v5, s[84:87], s10 offen lds
  s_add_u32 s10, s11, 86016
  s_add_u32 m0, s82, 19456
  s_nop 0
  buffer_load_dwordx4 v5, s[84:87], s10 offen lds
  s_waitcnt vmcnt(16)
  v_and_b32 v62, 31, v0
  s_lshl_b32 s10, s80, 5
  v_add_u32 v62, s10, v62
  v_lshlrev_b32 v63, 4, v62
  v_lshlrev_b32 v62, 2, v62
  s_mov_b64 exec, 0xffffffff
  ds_write_b128 v63, v[20:23] offset:10240
  ds_write_b32 v62, v21 offset:12288
  s_mov_b64 exec, -1
  v_lshlrev_b32 v62, 4, v0
  s_lshl_b32 s10, s80, 10
  v_add_u32 v62, s10, v62
  ds_write_b128 v62, v[24:27] offset:0
  ds_write_b128 v62, v[28:31] offset:4096
  s_cmp_lt_u32 s80, 2
  s_cbranch_scc0 L_h_nog3
  ds_write_b128 v62, v[32:35] offset:8192
L_h_nog3:
  s_waitcnt lgkmcnt(0)
  s_barrier
  s_barrier
  s_waitcnt vmcnt(0)
  s_barrier
  s_and_b32 s10, s6, 1
  s_lshl_b32 s10, s10, 4
  s_add_u32 s94, s10, s7
  s_lshr_b32 s10, s6, 1
  s_lshl_b32 s10, s10, 3
  s_lshl_b32 s11, s80, 1
  s_add_u32 s93, s10, s11
  v_and_b32 v2, 31, v0
  v_lshrrev_b32 v4, 5, v0
  v_lshlrev_b32 v5, 4, v4
  v_lshlrev_b32 v3, 5, v2
  v_add_u32 v1, v3, v5
  v_lshlrev_b32 v4, 2, v4
  v_sub_u32 v4, v2, v4
  v_mov_b32 v5, 0xf149f2ca
  v_cmp_le_i32 vcc, 0, v4
  s_nop 1
  v_cndmask_b32_e64 v204, v5, 0, vcc
  v_cndmask_b32_e64 v220, 0, v5, vcc
  v_cmp_le_i32 vcc, 1, v4
  s_nop 1
  v_cndmask_b32_e64 v205, v5, 0, vcc
  v_cndmask_b32_e64 v221, 0, v5, vcc
  v_cmp_le_i32 vcc, 2, v4
  s_nop 1
  v_cndmask_b32_e64 v206, v5, 0, vcc
  v_cndmask_b32_e64 v222, 0, v5, vcc
  v_cmp_le_i32 vcc, 3, v4
  s_nop 1
  v_cndmask_b32_e64 v207, v5, 0, vcc
  v_cndmask_b32_e64 v223, 0, v5, vcc
  v_cmp_le_i32 vcc, 8, v4
  s_nop 1
  v_cndmask_b32_e64 v208, v5, 0, vcc
  v_cndmask_b32_e64 v224, 0, v5, vcc
  v_cmp_le_i32 vcc, 9, v4
  s_nop 1
  v_cndmask_b32_e64 v209, v5, 0, vcc
  v_cndmask_b32_e64 v225, 0, v5, vcc
  v_cmp_le_i32 vcc, 10, v4
  s_nop 1
  v_cndmask_b32_e64 v210, v5, 0, vcc
  v_cndmask_b32_e64 v226, 0, v5, vcc
  v_cmp_le_i32 vcc, 11, v4
  s_nop 1
  v_cndmask_b32_e64 v211, v5, 0, vcc
  v_cndmask_b32_e64 v227, 0, v5, vcc
  v_cmp_le_i32 vcc, 16, v4
  s_nop 1
  v_cndmask_b32_e64 v212, v5, 0, vcc
  v_cndmask_b32_e64 v228, 0, v5, vcc
  v_cmp_le_i32 vcc, 17, v4
  s_nop 1
  v_cndmask_b32_e64 v213, v5, 0, vcc
  v_cndmask_b32_e64 v229, 0, v5, vcc
  v_cmp_le_i32 vcc, 18, v4
  s_nop 1
  v_cndmask_b32_e64 v214, v5, 0, vcc
  v_cndmask_b32_e64 v230, 0, v5, vcc
  v_cmp_le_i32 vcc, 19, v4
  s_nop 1
  v_cndmask_b32_e64 v215, v5, 0, vcc
  v_cndmask_b32_e64 v231, 0, v5, vcc
  v_cmp_le_i32 vcc, 24, v4
  s_nop 1
  v_cndmask_b32_e64 v216, v5, 0, vcc
  v_cndmask_b32_e64 v232, 0, v5, vcc
  v_cmp_le_i32 vcc, 25, v4
  s_nop 1
  v_cndmask_b32_e64 v217, v5, 0, vcc
  v_cndmask_b32_e64 v233, 0, v5, vcc
  v_cmp_le_i32 vcc, 26, v4
  s_nop 1
  v_cndmask_b32_e64 v218, v5, 0, vcc
  v_cndmask_b32_e64 v234, 0, v5, vcc
  v_cmp_le_i32 vcc, 27, v4
  s_nop 1
  v_cndmask_b32_e64 v219, v5, 0, vcc
  v_cndmask_b32_e64 v235, 0, v5, vcc
  v_mov_b32 v52, 0x3f803f80
  v_mov_b32 v53, 0x3f803f80
  v_mov_b32 v54, 0x3f803f80
  v_mov_b32 v55, 0x3f803f80
  v_mov_b32 v56, 0x3f803f80
  v_mov_b32 v57, 0x3f803f80
  v_mov_b32 v58, 0x3f803f80
  v_mov_b32 v59, 0x3f803f80
  v_mov_b32 v60, 0x3f803f80
  v_mov_b32 v61, 0x3f803f80
  v_mov_b32 v62, 0x3f803f80
  v_mov_b32 v63, 0x3f803f80
  v_mov_b32 v64, 0x3f803f80
  v_mov_b32 v65, 0x3f803f80
  v_mov_b32 v66, 0x3f803f80
  v_mov_b32 v67, 0x3f803f80
  v_mov_b32 v68, 0x3f803f80
  v_mov_b32 v69, 0x3f803f80
  v_mov_b32 v70, 0x3f803f80
  v_mov_b32 v71, 0x3f803f80
  v_mov_b32 v72, 0x3f803f80
  v_mov_b32 v73, 0x3f803f80
  v_mov_b32 v74, 0x3f803f80
  v_mov_b32 v75, 0x3f803f80
  v_mov_b32 v76, 0x3f803f80
  v_mov_b32 v77, 0x3f803f80
  v_mov_b32 v78, 0x3f803f80
  v_mov_b32 v79, 0x3f803f80
  v_mov_b32 v80, 0x3f803f80
  v_mov_b32 v81, 0x3f803f80
  v_mov_b32 v82, 0x3f803f80
  v_mov_b32 v83, 0x3f803f80
  v_mov_b32 v84, 0x3f803f80
  v_mov_b32 v85, 0x3f803f80
  v_mov_b32 v86, 0x3f803f80
  v_mov_b32 v87, 0x3f803f80
  v_mov_b32 v88, 0x3f803f80
  v_mov_b32 v89, 0x3f803f80
  v_mov_b32 v90, 0x3f803f80
  v_mov_b32 v91, 0x3f803f80
  v_mov_b32 v92, 0x3f803f80
  v_mov_b32 v93, 0x3f803f80
  v_mov_b32 v94, 0x3f803f80
  v_mov_b32 v95, 0x3f803f80
  v_mov_b32 v96, 0x3f803f80
  v_mov_b32 v97, 0x3f803f80
  v_mov_b32 v98, 0x3f803f80
  v_mov_b32 v99, 0x3f803f80
  v_mov_b32 v100, 0x3f803f80
  v_mov_b32 v101, 0x3f803f80
  v_mov_b32 v102, 0x3f803f80
  v_mov_b32 v103, 0x3f803f80
  v_mov_b32 v104, 0x3f803f80
  v_mov_b32 v105, 0x3f803f80
  v_mov_b32 v106, 0x3f803f80
  v_mov_b32 v107, 0x3f803f80
  v_mov_b32 v108, 0x3f803f80
  v_mov_b32 v109, 0x3f803f80
  v_mov_b32 v110, 0x3f803f80
  v_mov_b32 v111, 0x3f803f80
  v_mov_b32 v112, 0x3f803f80
  v_mov_b32 v113, 0x3f803f80
  v_mov_b32 v114, 0x3f803f80
  v_mov_b32 v115, 0x3f803f80
  v_mov_b32 v116, 0x3f803f80
  v_mov_b32 v117, 0x3f803f80
  v_mov_b32 v118, 0x3f803f80
  v_mov_b32 v119, 0x3f803f80
  v_mov_b32 v120, 0x3f803f80
  v_mov_b32 v121, 0x3f803f80
  v_mov_b32 v122, 0x3f803f80
  v_mov_b32 v123, 0x3f803f80
  s_mov_b32 s96, 0x0000ffff
  s_mov_b32 s97, 0x0000ffff
L_at_dry_ret:
  s_nop 15
  s_cmp_eq_u32 s80, 2
  s_cbranch_scc0 L_fw_at_np
  s_and_b32 s10, s6, 0xfffffffe
  s_sub_i32 s10, s10, 2
  s_max_i32 s10, s10, 0
  s_add_u32 s10, s10, 32
  s_lshl_b32 s10, s10, 7
  v_lshrrev_b32 v7, 4, v0
  v_lshlrev_b32 v7, 7, v7
  v_and_b32 v6, 15, v0
  v_lshlrev_b32 v6, 2, v6
  v_add_u32 v7, v7, v6
  v_add_u32 v7, s10, v7
  s_add_u32 s13, s33, 2
  s_mov_b32 s14, 16777216
  s_mov_b32 s15, 0
L_fw_at:
  s_add_u32 s15, s15, 1
  s_cmp_gt_u32 s15, 100000
  s_cbranch_scc1 L_fw_at_ok
  buffer_load_dword v6, v7, s[68:71], s14 offen sc1
  s_waitcnt vmcnt(0)
  v_cmp_ne_u32 vcc, s13, v6
  s_nop 3
  s_cmp_eq_u64 vcc, 0
  s_cbranch_scc1 L_fw_at_ok
  s_sleep 4
  s_branch L_fw_at
L_fw_at_ok:
  v_mov_b32 v6, 12828
  v_mov_b32 v7, 1
  s_mov_b64 exec, 1
  ds_add_u32 v6, v7
  s_mov_b64 exec, -1
  s_branch L_fw_at_dn
L_fw_at_np:
  v_mov_b32 v6, 12828
  s_mov_b32 s15, 0
L_fw_at_l:
  s_add_u32 s15, s15, 1
  s_cmp_gt_u32 s15, 1000000
  s_cbranch_scc1 L_fw_at_l_ok
  ds_read_b32 v7, v6
  s_waitcnt lgkmcnt(0)
  v_readfirstlane_b32 s10, v7
  s_nop 3
  s_cmp_ge_u32 s10, 1
  s_cbranch_scc1 L_fw_at_l_ok
  s_sleep 1
  s_branch L_fw_at_l
L_fw_at_l_ok:
L_fw_at_dn:
  s_lshl_b32 s11, s94, 16
  s_lshl_b32 s10, s93, 10
  s_add_u32 s12, s10, s11
  buffer_load_dwordx4 v[8:11], v1, s[68:71], s12 offen sc1
  s_add_i32 s10, s93, -8
  s_max_i32 s10, s10, 0
  s_lshl_b32 s10, s10, 10
  s_lshl_b32 s11, s94, 16
  s_add_u32 s10, s10, s11
  s_add_u32 s11, s10, 2097152
  buffer_load_dwordx4 v[16:19], v1, s[68:71], s11 offen sc1
  s_add_i32 s10, s93, -7
  s_max_i32 s10, s10, 0
  s_lshl_b32 s10, s10, 10
  s_lshl_b32 s11, s94, 16
  s_add_u32 s10, s10, s11
  s_add_u32 s11, s10, 2097152
  buffer_load_dwordx4 v[20:23], v1, s[68:71], s11 offen sc1
  s_add_i32 s10, s93, -6
  s_max_i32 s10, s10, 0
  s_lshl_b32 s10, s10, 10
  s_lshl_b32 s11, s94, 16
  s_add_u32 s10, s10, s11
  s_add_u32 s11, s10, 2097152
  buffer_load_dwordx4 v[24:27], v1, s[68:71], s11 offen sc1
  s_add_i32 s10, s93, -5
  s_max_i32 s10, s10, 0
  s_lshl_b32 s10, s10, 10
  s_lshl_b32 s11, s94, 16
  s_add_u32 s10, s10, s11
  s_add_u32 s11, s10, 2097152
  buffer_load_dwordx4 v[28:31], v1, s[68:71], s11 offen sc1
  s_add_i32 s10, s93, -4
  s_max_i32 s10, s10, 0
  s_lshl_b32 s10, s10, 10
  s_lshl_b32 s11, s94, 16
  s_add_u32 s10, s10, s11
  s_add_u32 s11, s10, 2097152
  buffer_load_dwordx4 v[32:35], v1, s[68:71], s11 offen sc1
  s_add_i32 s10, s93, -3
  s_max_i32 s10, s10, 0
  s_lshl_b32 s10, s10, 10
  s_lshl_b32 s11, s94, 16
  s_add_u32 s10, s10, s11
  s_add_u32 s11, s10, 2097152
  buffer_load_dwordx4 v[36:39], v1, s[68:71], s11 offen sc1
  s_add_i32 s10, s93, -2
  s_max_i32 s10, s10, 0
  s_lshl_b32 s10, s10, 10
  s_lshl_b32 s11, s94, 16
  s_add_u32 s10, s10, s11
  s_add_u32 s11, s10, 2097152
  buffer_load_dwordx4 v[40:43], v1, s[68:71], s11 offen sc1
  s_add_i32 s10, s93, -1
  s_max_i32 s10, s10, 0
  s_lshl_b32 s10, s10, 10
  s_lshl_b32 s11, s94, 16
  s_add_u32 s10, s10, s11
  s_add_u32 s11, s10, 2097152
  buffer_load_dwordx4 v[44:47], v1, s[68:71], s11 offen sc1
  s_add_i32 s10, s93, 0
  s_max_i32 s10, s10, 0
  s_lshl_b32 s10, s10, 10
  s_lshl_b32 s11, s94, 16
  s_add_u32 s10, s10, s11
  s_add_u32 s11, s10, 2097152
  buffer_load_dwordx4 v[48:51], v1, s[68:71], s11 offen sc1
  s_add_i32 s10, s93, -8
  s_max_i32 s10, s10, 0
  s_lshl_b32 s10, s10, 10
  s_lshl_b32 s11, s94, 16
  s_add_u32 s10, s10, s11
  s_add_u32 s11, s10, 4194304
  s_mov_b64 exec, s[96:97]
  buffer_load_dwordx4 v[52:55], v1, s[68:71], s11 offen sc1
  buffer_load_dwordx4 v[56:59], v1, s[68:71], s11 offen offset:512 sc1
  s_mov_b64 exec, -1
  s_add_i32 s10, s93, -7
  s_max_i32 s10, s10, 0
  s_lshl_b32 s10, s10, 10
  s_lshl_b32 s11, s94, 16
  s_add_u32 s10, s10, s11
  s_add_u32 s11, s10, 4194304
  s_mov_b64 exec, s[96:97]
  buffer_load_dwordx4 v[60:63], v1, s[68:71], s11 offen sc1
  buffer_load_dwordx4 v[64:67], v1, s[68:71], s11 offen offset:512 sc1
  s_mov_b64 exec, -1
  s_add_i32 s10, s93, -6
  s_max_i32 s10, s10, 0
  s_lshl_b32 s10, s10, 10
  s_lshl_b32 s11, s94, 16
  s_add_u32 s10, s10, s11
  s_add_u32 s11, s10, 4194304
  s_mov_b64 exec, s[96:97]
  buffer_load_dwordx4 v[68:71], v1, s[68:71], s11 offen sc1
  buffer_load_dwordx4 v[72:75], v1, s[68:71], s11 offen offset:512 sc1
  s_mov_b64 exec, -1
  s_add_i32 s10, s93, -5
  s_max_i32 s10, s10, 0
  s_lshl_b32 s10, s10, 10
  s_lshl_b32 s11, s94, 16
  s_add_u32 s10, s10, s11
  s_add_u32 s11, s10, 4194304
  s_mov_b64 exec, s[96:97]
  buffer_load_dwordx4 v[76:79], v1, s[68:71], s11 offen sc1
  buffer_load_dwordx4 v[80:83], v1, s[68:71], s11 offen offset:512 sc1
  s_mov_b64 exec, -1
  s_add_i32 s10, s93, -4
  s_max_i32 s10, s10, 0
  s_lshl_b32 s10, s10, 10
  s_lshl_b32 s11, s94, 16
  s_add_u32 s10, s10, s11
  s_add_u32 s11, s10, 4194304
  s_mov_b64 exec, s[96:97]
  buffer_load_dwordx4 v[84:87], v1, s[68:71], s11 offen sc1
  buffer_load_dwordx4 v[88:91], v1, s[68:71], s11 offen offset:512 sc1
  s_mov_b64 exec, -1
  s_add_i32 s10, s93, -3
  s_max_i32 s10, s10, 0
  s_lshl_b32 s10, s10, 10
  s_lshl_b32 s11, s94, 16
  s_add_u32 s10, s10, s11
  s_add_u32 s11, s10, 4194304
  s_mov_b64 exec, s[96:97]
  buffer_load_dwordx4 v[92:95], v1, s[68:71], s11 offen sc1
  buffer_load_dwordx4 v[96:99], v1, s[68:71], s11 offen offset:512 sc1
  s_mov_b64 exec, -1
  s_add_i32 s10, s93, -2
  s_max_i32 s10, s10, 0
  s_lshl_b32 s10, s10, 10
  s_lshl_b32 s11, s94, 16
  s_add_u32 s10, s10, s11
  s_add_u32 s11, s10, 4194304
  s_mov_b64 exec, s[96:97]
  buffer_load_dwordx4 v[100:103], v1, s[68:71], s11 offen sc1
  buffer_load_dwordx4 v[104:107], v1, s[68:71], s11 offen offset:512 sc1
  s_mov_b64 exec, -1
  s_add_i32 s10, s93, -1
  s_max_i32 s10, s10, 0
  s_lshl_b32 s10, s10, 10
  s_lshl_b32 s11, s94, 16
  s_add_u32 s10, s10, s11
  s_add_u32 s11, s10, 4194304
  s_mov_b64 exec, s[96:97]
  buffer_load_dwordx4 v[108:111], v1, s[68:71], s11 offen sc1
  buffer_load_dwordx4 v[112:115], v1, s[68:71], s11 offen offset:512 sc1
  s_mov_b64 exec, -1
  s_add_i32 s10, s93, 0
  s_max_i32 s10, s10, 0
  s_lshl_b32 s10, s10, 10
  s_lshl_b32 s11, s94, 16
  s_add_u32 s10, s10, s11
  s_add_u32 s11, s10, 4194304
  s_mov_b64 exec, s[96:97]
  buffer_load_dwordx4 v[116:119], v1, s[68:71], s11 offen sc1
  buffer_load_dwordx4 v[120:123], v1, s[68:71], s11 offen offset:512 sc1
  s_mov_b64 exec, -1
  buffer_load_dwordx4 v[12:15], v1, s[68:71], s12 offen offset:1024 sc1
  v_mov_b32 v6, 12852
  v_mov_b32 v7, 1
  s_mov_b64 exec, 1
  ds_add_u32 v6, v7
  s_mov_b64 exec, -1
  s_waitcnt vmcnt(19)
  v_mov_b32 v2, 0xf149f2ca
  v_mov_b32 v3, 0xf149f2ca
  v_mov_b32 v4, 0xf149f2ca
  v_mov_b32 v5, 0xf149f2ca
  s_add_u32 s10, s93, 0
  s_sub_i32 s95, 8, s10
  s_max_i32 s95, s95, 0
  s_cmp_eq_u32 s95, 0
  s_cbranch_scc0 L_f0_d1
  v_mfma_f32_32x32x16_bf16 v[124:139], v[16:19], v[8:11], v[220:235]
  v_mfma_f32_32x32x16_bf16 v[140:155], v[20:23], v[8:11], 0
L_f0_e1_0:
  v_mfma_f32_32x32x16_bf16 v[156:171], v[24:27], v[8:11], 0
  s_nop 9
  v_max3_f32 v2, v124, v125, v2
  v_max3_f32 v3, v126, v127, v3
  v_max3_f32 v4, v128, v129, v4
  v_max3_f32 v5, v130, v131, v5
  v_max3_f32 v2, v132, v133, v2
  v_max3_f32 v3, v134, v135, v3
  v_max3_f32 v4, v136, v137, v4
  v_max3_f32 v5, v138, v139, v5
L_f0_e1_1:
  v_mfma_f32_32x32x16_bf16 v[124:139], v[28:31], v[8:11], 0
  v_max3_f32 v2, v140, v141, v2
  v_max3_f32 v3, v142, v143, v3
  v_max3_f32 v4, v144, v145, v4
  v_max3_f32 v5, v146, v147, v5
  v_max3_f32 v2, v148, v149, v2
  v_max3_f32 v3, v150, v151, v3
  v_max3_f32 v4, v152, v153, v4
  v_max3_f32 v5, v154, v155, v5
L_f0_e1_2:
  v_mfma_f32_32x32x16_bf16 v[140:155], v[32:35], v[8:11], 0
  v_max3_f32 v2, v156, v157, v2
  v_max3_f32 v3, v158, v159, v3
  v_max3_f32 v4, v160, v161, v4
  v_max3_f32 v5, v162, v163, v5
  v_max3_f32 v2, v164, v165, v2
  v_max3_f32 v3, v166, v167, v3
  v_max3_f32 v4, v168, v169, v4
  v_max3_f32 v5, v170, v171, v5
L_f0_e1_3:
  v_mfma_f32_32x32x16_bf16 v[156:171], v[36:39], v[8:11], 0
  v_max3_f32 v2, v124, v125, v2
  v_max3_f32 v3, v126, v127, v3
  v_max3_f32 v4, v128, v129, v4
  v_max3_f32 v5, v130, v131, v5
  v_max3_f32 v2, v132, v133, v2
  v_max3_f32 v3, v134, v135, v3
  v_max3_f32 v4, v136, v137, v4
  v_max3_f32 v5, v138, v139, v5
L_f0_e1_4:
  v_mfma_f32_32x32x16_bf16 v[124:139], v[40:43], v[8:11], 0
  v_max3_f32 v2, v140, v141, v2
  v_max3_f32 v3, v142, v143, v3
  v_max3_f32 v4, v144, v145, v4
  v_max3_f32 v5, v146, v147, v5
  v_max3_f32 v2, v148, v149, v2
  v_max3_f32 v3, v150, v151, v3
  v_max3_f32 v4, v152, v153, v4
  v_max3_f32 v5, v154, v155, v5
L_f0_e1_5:
  v_mfma_f32_32x32x16_bf16 v[140:155], v[44:47], v[8:11], 0
  v_max3_f32 v2, v156, v157, v2
  v_max3_f32 v3, v158, v159, v3
  v_max3_f32 v4, v160, v161, v4
  v_max3_f32 v5, v162, v163, v5
  v_max3_f32 v2, v164, v165, v2
  v_max3_f32 v3, v166, v167, v3
  v_max3_f32 v4, v168, v169, v4
  v_max3_f32 v5, v170, v171, v5
L_f0_e1_6:
  v_mfma_f32_32x32x16_bf16 v[156:171], v[48:51], v[8:11], v[204:219]
  v_max3_f32 v2, v124, v125, v2
  v_max3_f32 v3, v126, v127, v3
  v_max3_f32 v4, v128, v129, v4
  v_max3_f32 v5, v130, v131, v5
  v_max3_f32 v2, v132, v133, v2
  v_max3_f32 v3, v134, v135, v3
  v_max3_f32 v4, v136, v137, v4
  v_max3_f32 v5, v138, v139, v5
L_f0_e1_7:
  v_max3_f32 v2, v140, v141, v2
  v_max3_f32 v3, v142, v143, v3
  v_max3_f32 v4, v144, v145, v4
  v_max3_f32 v5, v146, v147, v5
  v_max3_f32 v2, v148, v149, v2
  v_max3_f32 v3, v150, v151, v3
  v_max3_f32 v4, v152, v153, v4
  v_max3_f32 v5, v154, v155, v5
L_f0_e1_8:
  v_max3_f32 v2, v156, v157, v2
  v_max3_f32 v3, v158, v159, v3
  v_max3_f32 v4, v160, v161, v4
  v_max3_f32 v5, v162, v163, v5
  v_max3_f32 v2, v164, v165, v2
  v_max3_f32 v3, v166, v167, v3
  v_max3_f32 v4, v168, v169, v4
  v_max3_f32 v5, v170, v171, v5
  s_waitcnt vmcnt(0)
  v_max_f32 v2, v2, v3
  v_max_f32 v4, v4, v5
  v_max_f32 v2, v2, v4
  v_mov_b32 v3, v2
  s_nop 1
  v_permlane32_swap_b32 v2, v3
  v_max_f32 v2, v2, v3
  v_sub_f32 v2, 0, v2
  v_mov_b32 v188, v2
  v_mov_b32 v189, v2
  v_mov_b32 v190, v2
  v_mov_b32 v191, v2
  v_mov_b32 v192, v2
  v_mov_b32 v193, v2
  v_mov_b32 v194, v2
  v_mov_b32 v195, v2
  v_mov_b32 v196, v2
  v_mov_b32 v197, v2
  v_mov_b32 v198, v2
  v_mov_b32 v199, v2
  v_mov_b32 v200, v2
  v_mov_b32 v201, v2
  v_mov_b32 v202, v2
  v_mov_b32 v203, v2
  v_mov_b32 v172, 0
  v_mov_b32 v173, 0
  v_mov_b32 v174, 0
  v_mov_b32 v175, 0
  v_mov_b32 v176, 0
  v_mov_b32 v177, 0
  v_mov_b32 v178, 0
  v_mov_b32 v179, 0
  v_mov_b32 v180, 0
  v_mov_b32 v181, 0
  v_mov_b32 v182, 0
  v_mov_b32 v183, 0
  v_mov_b32 v184, 0
  v_mov_b32 v185, 0
  v_mov_b32 v186, 0
  v_mov_b32 v187, 0
  v_mov_b32 v236, 0
  v_mov_b32 v237, 0
  v_mov_b32 v238, 0
  v_mov_b32 v239, 0
  v_mov_b32 v240, 0
  v_mov_b32 v241, 0
  v_mov_b32 v242, 0
  v_mov_b32 v243, 0
  v_mov_b32 v244, 0
  v_mov_b32 v245, 0
  v_mov_b32 v246, 0
  v_mov_b32 v247, 0
  v_mov_b32 v248, 0
  v_mov_b32 v249, 0
  v_mov_b32 v250, 0
  v_mov_b32 v251, 0
  s_cmp_eq_u32 s95, 0
  s_cbranch_scc0 L_f0_d2
  v_add_f32 v124, v220, v2
  v_add_f32 v125, v221, v2
  v_add_f32 v126, v222, v2
  v_add_f32 v127, v223, v2
  v_add_f32 v128, v224, v2
  v_add_f32 v129, v225, v2
  v_add_f32 v130, v226, v2
  v_add_f32 v131, v227, v2
  v_add_f32 v132, v228, v2
  v_add_f32 v133, v229, v2
  v_add_f32 v134, v230, v2
  v_add_f32 v135, v231, v2
  v_add_f32 v136, v232, v2
  v_add_f32 v137, v233, v2
  v_add_f32 v138, v234, v2
  v_add_f32 v139, v235, v2
  s_nop 1
  v_mfma_f32_32x32x16_bf16 v[124:139], v[16:19], v[8:11], v[124:139]
  v_mfma_f32_32x32x16_bf16 v[140:155], v[20:23], v[8:11], v[188:203]
L_f0_e2_0:
  s_nop 10
  v_exp_f32 v124, v124
  v_exp_f32 v125, v125
  v_exp_f32 v126, v126
  v_exp_f32 v127, v127
  v_exp_f32 v128, v128
  v_exp_f32 v129, v129
  v_exp_f32 v130, v130
  v_exp_f32 v131, v131
  v_exp_f32 v132, v132
  v_exp_f32 v133, v133
  v_exp_f32 v134, v134
  v_exp_f32 v135, v135
  v_exp_f32 v136, v136
  v_exp_f32 v137, v137
  v_mfma_f32_32x32x16_bf16 v[156:171], v[24:27], v[8:11], v[188:203]
  v_exp_f32 v138, v138
  v_exp_f32 v139, v139
  v_cvt_pk_bf16_f32 v236, v124, v125
  v_cvt_pk_bf16_f32 v237, v126, v127
  v_cvt_pk_bf16_f32 v238, v128, v129
  v_cvt_pk_bf16_f32 v239, v130, v131
  v_cvt_pk_bf16_f32 v240, v132, v133
  v_cvt_pk_bf16_f32 v241, v134, v135
  v_cvt_pk_bf16_f32 v242, v136, v137
  v_cvt_pk_bf16_f32 v243, v138, v139
L_f0_e2_1:
  v_exp_f32 v140, v140
  v_exp_f32 v141, v141
  v_exp_f32 v142, v142
  v_exp_f32 v143, v143
  v_mfma_f32_32x32x16_bf16 v[172:187], v[52:55], v[236:239], v[172:187]
  v_exp_f32 v144, v144
  v_exp_f32 v145, v145
  v_exp_f32 v146, v146
  v_exp_f32 v147, v147
  v_exp_f32 v148, v148
  v_mfma_f32_32x32x16_bf16 v[172:187], v[56:59], v[240:243], v[172:187]
  v_exp_f32 v149, v149
  v_exp_f32 v150, v150
  v_exp_f32 v151, v151
  v_exp_f32 v152, v152
  v_exp_f32 v153, v153
  v_mfma_f32_32x32x16_bf16 v[124:139], v[28:31], v[8:11], v[188:203]
  v_exp_f32 v154, v154
  v_exp_f32 v155, v155
  v_cvt_pk_bf16_f32 v244, v140, v141
  v_cvt_pk_bf16_f32 v245, v142, v143
  v_cvt_pk_bf16_f32 v246, v144, v145
  v_cvt_pk_bf16_f32 v247, v146, v147
  v_cvt_pk_bf16_f32 v248, v148, v149
  v_cvt_pk_bf16_f32 v249, v150, v151
  v_cvt_pk_bf16_f32 v250, v152, v153
  v_cvt_pk_bf16_f32 v251, v154, v155
L_f0_e2_2:
  v_exp_f32 v156, v156
  v_exp_f32 v157, v157
  v_exp_f32 v158, v158
  v_exp_f32 v159, v159
  v_mfma_f32_32x32x16_bf16 v[172:187], v[60:63], v[244:247], v[172:187]
  v_exp_f32 v160, v160
  v_exp_f32 v161, v161
  v_exp_f32 v162, v162
  v_exp_f32 v163, v163
  v_exp_f32 v164, v164
  v_mfma_f32_32x32x16_bf16 v[172:187], v[64:67], v[248:251], v[172:187]
  v_exp_f32 v165, v165
  v_exp_f32 v166, v166
  v_exp_f32 v167, v167
  v_exp_f32 v168, v168
  v_exp_f32 v169, v169
  v_mfma_f32_32x32x16_bf16 v[140:155], v[32:35], v[8:11], v[188:203]
  v_exp_f32 v170, v170
  v_exp_f32 v171, v171
  v_cvt_pk_bf16_f32 v236, v156, v157
  v_cvt_pk_bf16_f32 v237, v158, v159
  v_cvt_pk_bf16_f32 v238, v160, v161
  v_cvt_pk_bf16_f32 v239, v162, v163
  v_cvt_pk_bf16_f32 v240, v164, v165
  v_cvt_pk_bf16_f32 v241, v166, v167
  v_cvt_pk_bf16_f32 v242, v168, v169
  v_cvt_pk_bf16_f32 v243, v170, v171
L_f0_e2_3:
  v_exp_f32 v124, v124
  v_exp_f32 v125, v125
  v_exp_f32 v126, v126
  v_exp_f32 v127, v127
  v_mfma_f32_32x32x16_bf16 v[172:187], v[68:71], v[236:239], v[172:187]
  v_exp_f32 v128, v128
  v_exp_f32 v129, v129
  v_exp_f32 v130, v130
  v_exp_f32 v131, v131
  v_exp_f32 v132, v132
  v_mfma_f32_32x32x16_bf16 v[172:187], v[72:75], v[240:243], v[172:187]
  v_exp_f32 v133, v133
  v_exp_f32 v134, v134
  v_exp_f32 v135, v135
  v_exp_f32 v136, v136
  v_exp_f32 v137, v137
  v_mfma_f32_32x32x16_bf16 v[156:171], v[36:39], v[8:11], v[188:203]
  v_exp_f32 v138, v138
  v_exp_f32 v139, v139
  v_cvt_pk_bf16_f32 v244, v124, v125
  v_cvt_pk_bf16_f32 v245, v126, v127
  v_cvt_pk_bf16_f32 v246, v128, v129
  v_cvt_pk_bf16_f32 v247, v130, v131
  v_cvt_pk_bf16_f32 v248, v132, v133
  v_cvt_pk_bf16_f32 v249, v134, v135
  v_cvt_pk_bf16_f32 v250, v136, v137
  v_cvt_pk_bf16_f32 v251, v138, v139
L_f0_e2_4:
  v_exp_f32 v140, v140
  v_exp_f32 v141, v141
  v_exp_f32 v142, v142
  v_exp_f32 v143, v143
  v_mfma_f32_32x32x16_bf16 v[172:187], v[76:79], v[244:247], v[172:187]
  v_exp_f32 v144, v144
  v_exp_f32 v145, v145
  v_exp_f32 v146, v146
  v_exp_f32 v147, v147
  v_exp_f32 v148, v148
  v_mfma_f32_32x32x16_bf16 v[172:187], v[80:83], v[248:251], v[172:187]
  v_exp_f32 v149, v149
  v_exp_f32 v150, v150
  v_exp_f32 v151, v151
  v_exp_f32 v152, v152
  v_exp_f32 v153, v153
  v_mfma_f32_32x32x16_bf16 v[124:139], v[40:43], v[8:11], v[188:203]
  v_exp_f32 v154, v154
  v_exp_f32 v155, v155
  v_cvt_pk_bf16_f32 v236, v140, v141
  v_cvt_pk_bf16_f32 v237, v142, v143
  v_cvt_pk_bf16_f32 v238, v144, v145
  v_cvt_pk_bf16_f32 v239, v146, v147
  v_cvt_pk_bf16_f32 v240, v148, v149
  v_cvt_pk_bf16_f32 v241, v150, v151
  v_cvt_pk_bf16_f32 v242, v152, v153
  v_cvt_pk_bf16_f32 v243, v154, v155
L_f0_e2_5:
  v_exp_f32 v156, v156
  v_exp_f32 v157, v157
  v_exp_f32 v158, v158
  v_exp_f32 v159, v159
  v_mfma_f32_32x32x16_bf16 v[172:187], v[84:87], v[236:239], v[172:187]
  v_exp_f32 v160, v160
  v_exp_f32 v161, v161
  v_exp_f32 v162, v162
  v_exp_f32 v163, v163
  v_exp_f32 v164, v164
  v_mfma_f32_32x32x16_bf16 v[172:187], v[88:91], v[240:243], v[172:187]
  v_exp_f32 v165, v165
  v_exp_f32 v166, v166
  v_exp_f32 v167, v167
  v_exp_f32 v168, v168
  v_exp_f32 v169, v169
  v_mfma_f32_32x32x16_bf16 v[140:155], v[44:47], v[8:11], v[188:203]
  v_exp_f32 v170, v170
  v_exp_f32 v171, v171
  v_cvt_pk_bf16_f32 v244, v156, v157
  v_cvt_pk_bf16_f32 v245, v158, v159
  v_cvt_pk_bf16_f32 v246, v160, v161
  v_cvt_pk_bf16_f32 v247, v162, v163
  v_cvt_pk_bf16_f32 v248, v164, v165
  v_cvt_pk_bf16_f32 v249, v166, v167
  v_cvt_pk_bf16_f32 v250, v168, v169
  v_cvt_pk_bf16_f32 v251, v170, v171
L_f0_e2_6:
  v_exp_f32 v124, v124
  v_exp_f32 v125, v125
  v_exp_f32 v126, v126
  v_exp_f32 v127, v127
  v_mfma_f32_32x32x16_bf16 v[172:187], v[92:95], v[244:247], v[172:187]
  v_exp_f32 v128, v128
  v_exp_f32 v129, v129
  v_exp_f32 v130, v130
  v_exp_f32 v131, v131
  v_exp_f32 v132, v132
  v_mfma_f32_32x32x16_bf16 v[172:187], v[96:99], v[248:251], v[172:187]
  v_exp_f32 v133, v133
  v_exp_f32 v134, v134
  v_exp_f32 v135, v135
  v_exp_f32 v136, v136
  v_exp_f32 v137, v137
  v_exp_f32 v138, v138
  v_exp_f32 v139, v139
  v_cvt_pk_bf16_f32 v236, v124, v125
  v_cvt_pk_bf16_f32 v237, v126, v127
  v_cvt_pk_bf16_f32 v238, v128, v129
  v_cvt_pk_bf16_f32 v239, v130, v131
  v_cvt_pk_bf16_f32 v240, v132, v133
  v_cvt_pk_bf16_f32 v241, v134, v135
  v_cvt_pk_bf16_f32 v242, v136, v137
  v_cvt_pk_bf16_f32 v243, v138, v139
  v_add_f32 v156, v204, v2
  v_add_f32 v157, v205, v2
  v_add_f32 v158, v206, v2
  v_add_f32 v159, v207, v2
  v_add_f32 v160, v208, v2
  v_add_f32 v161, v209, v2
  v_add_f32 v162, v210, v2
  v_add_f32 v163, v211, v2
  v_add_f32 v164, v212, v2
  v_add_f32 v165, v213, v2
  v_add_f32 v166, v214, v2
  v_add_f32 v167, v215, v2
  v_add_f32 v168, v216, v2
  v_add_f32 v169, v217, v2
  v_add_f32 v170, v218, v2
  v_add_f32 v171, v219, v2
  s_nop 1
  v_mfma_f32_32x32x16_bf16 v[156:171], v[48:51], v[8:11], v[156:171]
L_f0_e2_7:
  v_exp_f32 v140, v140
  v_exp_f32 v141, v141
  v_exp_f32 v142, v142
  v_exp_f32 v143, v143
  v_mfma_f32_32x32x16_bf16 v[172:187], v[100:103], v[236:239], v[172:187]
  v_exp_f32 v144, v144
  v_exp_f32 v145, v145
  v_exp_f32 v146, v146
  v_exp_f32 v147, v147
  v_exp_f32 v148, v148
  v_mfma_f32_32x32x16_bf16 v[172:187], v[104:107], v[240:243], v[172:187]
  v_exp_f32 v149, v149
  v_exp_f32 v150, v150
  v_exp_f32 v151, v151
  v_exp_f32 v152, v152
  v_exp_f32 v153, v153
  v_exp_f32 v154, v154
  v_exp_f32 v155, v155
  v_cvt_pk_bf16_f32 v244, v140, v141
  v_cvt_pk_bf16_f32 v245, v142, v143
  v_cvt_pk_bf16_f32 v246, v144, v145
  v_cvt_pk_bf16_f32 v247, v146, v147
  v_cvt_pk_bf16_f32 v248, v148, v149
  v_cvt_pk_bf16_f32 v249, v150, v151
  v_cvt_pk_bf16_f32 v250, v152, v153
  v_cvt_pk_bf16_f32 v251, v154, v155
L_f0_e2_8:
  s_add_i32 s10, s93, 1
  s_max_i32 s10, s10, 0
  s_lshl_b32 s10, s10, 10
  s_lshl_b32 s11, s94, 16
  s_add_u32 s10, s10, s11
  s_add_u32 s11, s10, 2097152
  buffer_load_dwordx4 v[16:19], v1, s[68:71], s11 offen sc1
  s_add_u32 s11, s10, 4194304
  s_mov_b64 exec, s[96:97]
  buffer_load_dwordx4 v[52:55], v1, s[68:71], s11 offen sc1
  buffer_load_dwordx4 v[56:59], v1, s[68:71], s11 offen offset:512 sc1
  s_mov_b64 exec, -1
  v_exp_f32 v156, v156
  v_exp_f32 v157, v157
  v_exp_f32 v158, v158
  v_exp_f32 v159, v159
  v_mfma_f32_32x32x16_bf16 v[172:187], v[108:111], v[244:247], v[172:187]
  v_exp_f32 v160, v160
  v_exp_f32 v161, v161
  v_exp_f32 v162, v162
  v_exp_f32 v163, v163
  v_exp_f32 v164, v164
  v_mfma_f32_32x32x16_bf16 v[172:187], v[112:115], v[248:251], v[172:187]
  v_exp_f32 v165, v165
  v_exp_f32 v166, v166
  v_exp_f32 v167, v167
  v_exp_f32 v168, v168
  v_exp_f32 v169, v169
  v_exp_f32 v170, v170
  v_exp_f32 v171, v171
  v_cvt_pk_bf16_f32 v236, v156, v157
  v_cvt_pk_bf16_f32 v237, v158, v159
  v_cvt_pk_bf16_f32 v238, v160, v161
  v_cvt_pk_bf16_f32 v239, v162, v163
  v_cvt_pk_bf16_f32 v240, v164, v165
  v_cvt_pk_bf16_f32 v241, v166, v167
  v_cvt_pk_bf16_f32 v242, v168, v169
  v_cvt_pk_bf16_f32 v243, v170, v171
  v_mfma_f32_32x32x16_bf16 v[172:187], v[116:119], v[236:239], v[172:187]
  s_nop 0
  v_mfma_f32_32x32x16_bf16 v[172:187], v[120:123], v[240:243], v[172:187]
  s_nop 11
  v_rcp_f32 v2, v180
  s_nop 0
  v_mul_f32 v172, v172, v2
  v_mul_f32 v173, v173, v2
  v_mul_f32 v174, v174, v2
  v_mul_f32 v175, v175, v2
  v_mul_f32 v176, v176, v2
  v_mul_f32 v177, v177, v2
  v_mul_f32 v178, v178, v2
  v_mul_f32 v179, v179, v2
  v_cvt_pk_bf16_f32 v236, v172, v173
  v_cvt_pk_bf16_f32 v237, v174, v175
  v_cvt_pk_bf16_f32 v238, v176, v177
  v_cvt_pk_bf16_f32 v239, v178, v179
  s_branch L_f0_end
L_f0_d1:
  s_cmp_eq_u32 s95, 1
  s_cbranch_scc1 L_f0_s1_1
  s_cmp_eq_u32 s95, 2
  s_cbranch_scc1 L_f0_s1_2
  s_cmp_eq_u32 s95, 3
  s_cbranch_scc1 L_f0_s1_3
  s_cmp_eq_u32 s95, 4
  s_cbranch_scc1 L_f0_s1_4
  s_cmp_eq_u32 s95, 5
  s_cbranch_scc1 L_f0_s1_5
  s_cmp_eq_u32 s95, 6
  s_cbranch_scc1 L_f0_s1_6
  s_cmp_eq_u32 s95, 7
  s_cbranch_scc1 L_f0_s1_7
  s_cmp_eq_u32 s95, 8
  s_cbranch_scc1 L_f0_s1_8
L_f0_s1_1:
  v_mfma_f32_32x32x16_bf16 v[140:155], v[20:23], v[8:11], 0
  v_mfma_f32_32x32x16_bf16 v[156:171], v[24:27], v[8:11], 0
  s_nop 15
  s_branch L_f0_e1_1
L_f0_s1_2:
  v_mfma_f32_32x32x16_bf16 v[156:171], v[24:27], v[8:11], 0
  v_mfma_f32_32x32x16_bf16 v[124:139], v[28:31], v[8:11], 0
  s_nop 15
  s_branch L_f0_e1_2
L_f0_s1_3:
  v_mfma_f32_32x32x16_bf16 v[124:139], v[28:31], v[8:11], 0
  v_mfma_f32_32x32x16_bf16 v[140:155], v[32:35], v[8:11], 0
  s_nop 15
  s_branch L_f0_e1_3
L_f0_s1_4:
  v_mfma_f32_32x32x16_bf16 v[140:155], v[32:35], v[8:11], 0
  v_mfma_f32_32x32x16_bf16 v[156:171], v[36:39], v[8:11], 0
  s_nop 15
  s_branch L_f0_e1_4
L_f0_s1_5:
  v_mfma_f32_32x32x16_bf16 v[156:171], v[36:39], v[8:11], 0
  v_mfma_f32_32x32x16_bf16 v[124:139], v[40:43], v[8:11], 0
  s_nop 15
  s_branch L_f0_e1_5
L_f0_s1_6:
  v_mfma_f32_32x32x16_bf16 v[124:139], v[40:43], v[8:11], 0
  v_mfma_f32_32x32x16_bf16 v[140:155], v[44:47], v[8:11], 0
  s_nop 15
  s_branch L_f0_e1_6
L_f0_s1_7:
  v_mfma_f32_32x32x16_bf16 v[140:155], v[44:47], v[8:11], 0
  v_mfma_f32_32x32x16_bf16 v[156:171], v[48:51], v[8:11], v[204:219]
  s_nop 15
  s_branch L_f0_e1_7
L_f0_s1_8:
  v_mfma_f32_32x32x16_bf16 v[156:171], v[48:51], v[8:11], v[204:219]
  s_nop 15
  s_branch L_f0_e1_8
L_f0_d2:
  s_cmp_eq_u32 s95, 1
  s_cbranch_scc1 L_f0_s2_1
  s_cmp_eq_u32 s95, 2
  s_cbranch_scc1 L_f0_s2_2
  s_cmp_eq_u32 s95, 3
  s_cbranch_scc1 L_f0_s2_3
  s_cmp_eq_u32 s95, 4
  s_cbranch_scc1 L_f0_s2_4
  s_cmp_eq_u32 s95, 5
  s_cbranch_scc1 L_f0_s2_5
  s_cmp_eq_u32 s95, 6
  s_cbranch_scc1 L_f0_s2_6
  s_cmp_eq_u32 s95, 7
  s_cbranch_scc1 L_f0_s2_7
  s_cmp_eq_u32 s95, 8
  s_cbranch_scc1 L_f0_s2_8
L_f0_s2_1:
  s_nop 7
  v_mfma_f32_32x32x16_bf16 v[140:155], v[20:23], v[8:11], v[188:203]
  v_mfma_f32_32x32x16_bf16 v[156:171], v[24:27], v[8:11], v[188:203]
  s_nop 15
  s_branch L_f0_e2_1
L_f0_s2_2:
  s_nop 7
  v_mfma_f32_32x32x16_bf16 v[156:171], v[24:27], v[8:11], v[188:203]
  v_mfma_f32_32x32x16_bf16 v[124:139], v[28:31], v[8:11], v[188:203]
  s_nop 15
  s_branch L_f0_e2_2
L_f0_s2_3:
  s_nop 7
  v_mfma_f32_32x32x16_bf16 v[124:139], v[28:31], v[8:11], v[188:203]
  v_mfma_f32_32x32x16_bf16 v[140:155], v[32:35], v[8:11], v[188:203]
  s_nop 15
  s_branch L_f0_e2_3
L_f0_s2_4:
  s_nop 7
  v_mfma_f32_32x32x16_bf16 v[140:155], v[32:35], v[8:11], v[188:203]
  v_mfma_f32_32x32x16_bf16 v[156:171], v[36:39], v[8:11], v[188:203]
  s_nop 15
  s_branch L_f0_e2_4
L_f0_s2_5:
  s_nop 7
  v_mfma_f32_32x32x16_bf16 v[156:171], v[36:39], v[8:11], v[188:203]
  v_mfma_f32_32x32x16_bf16 v[124:139], v[40:43], v[8:11], v[188:203]
  s_nop 15
  s_branch L_f0_e2_5
L_f0_s2_6:
  s_nop 7
  v_mfma_f32_32x32x16_bf16 v[124:139], v[40:43], v[8:11], v[188:203]
  v_mfma_f32_32x32x16_bf16 v[140:155], v[44:47], v[8:11], v[188:203]
  s_nop 15
  s_branch L_f0_e2_6
L_f0_s2_7:
  s_nop 7
  v_mfma_f32_32x32x16_bf16 v[140:155], v[44:47], v[8:11], v[188:203]
  v_add_f32 v156, v204, v2
  v_add_f32 v157, v205, v2
  v_add_f32 v158, v206, v2
  v_add_f32 v159, v207, v2
  v_add_f32 v160, v208, v2
  v_add_f32 v161, v209, v2
  v_add_f32 v162, v210, v2
  v_add_f32 v163, v211, v2
  v_add_f32 v164, v212, v2
  v_add_f32 v165, v213, v2
  v_add_f32 v166, v214, v2
  v_add_f32 v167, v215, v2
  v_add_f32 v168, v216, v2
  v_add_f32 v169, v217, v2
  v_add_f32 v170, v218, v2
  v_add_f32 v171, v219, v2
  s_nop 1
  v_mfma_f32_32x32x16_bf16 v[156:171], v[48:51], v[8:11], v[156:171]
  s_nop 15
  s_branch L_f0_e2_7
L_f0_s2_8:
  s_nop 7
  v_add_f32 v156, v204, v2
  v_add_f32 v157, v205, v2
  v_add_f32 v158, v206, v2
  v_add_f32 v159, v207, v2
  v_add_f32 v160, v208, v2
  v_add_f32 v161, v209, v2
  v_add_f32 v162, v210, v2
  v_add_f32 v163, v211, v2
  v_add_f32 v164, v212, v2
  v_add_f32 v165, v213, v2
  v_add_f32 v166, v214, v2
  v_add_f32 v167, v215, v2
  v_add_f32 v168, v216, v2
  v_add_f32 v169, v217, v2
  v_add_f32 v170, v218, v2
  v_add_f32 v171, v219, v2
  s_nop 1
  v_mfma_f32_32x32x16_bf16 v[156:171], v[48:51], v[8:11], v[156:171]
  s_nop 15
  s_branch L_f0_e2_8
L_f0_end:
  s_nop 3
  s_add_u32 s10, s93, 0
  s_mul_i32 s10, s10, 147456
  s_add_u32 s11, s94, 112
  s_lshl_b32 s11, s11, 10
  s_add_u32 s10, s10, s11
  s_add_u32 s10, s10, 6291456
  v_lshlrev_b32 v3, 4, v0
  buffer_store_dwordx4 v[236:239], v3, s[68:71], s10 offen sc1
  v_mov_b32 v2, 0xf149f2ca
  v_mov_b32 v3, 0xf149f2ca
  v_mov_b32 v4, 0xf149f2ca
  v_mov_b32 v5, 0xf149f2ca
  s_add_u32 s10, s93, 1
  s_sub_i32 s95, 8, s10
  s_max_i32 s95, s95, 0
  s_cmp_eq_u32 s95, 0
  s_cbranch_scc0 L_f1_d1
  v_mfma_f32_32x32x16_bf16 v[124:139], v[20:23], v[12:15], v[220:235]
  v_mfma_f32_32x32x16_bf16 v[140:155], v[24:27], v[12:15], 0
L_f1_e1_0:
  v_mfma_f32_32x32x16_bf16 v[156:171], v[28:31], v[12:15], 0
  s_nop 9
  v_max3_f32 v2, v124, v125, v2
  v_max3_f32 v3, v126, v127, v3
  v_max3_f32 v4, v128, v129, v4
  v_max3_f32 v5, v130, v131, v5
  v_max3_f32 v2, v132, v133, v2
  v_max3_f32 v3, v134, v135, v3
  v_max3_f32 v4, v136, v137, v4
  v_max3_f32 v5, v138, v139, v5
L_f1_e1_1:
  v_mfma_f32_32x32x16_bf16 v[124:139], v[32:35], v[12:15], 0
  v_max3_f32 v2, v140, v141, v2
  v_max3_f32 v3, v142, v143, v3
  v_max3_f32 v4, v144, v145, v4
  v_max3_f32 v5, v146, v147, v5
  v_max3_f32 v2, v148, v149, v2
  v_max3_f32 v3, v150, v151, v3
  v_max3_f32 v4, v152, v153, v4
  v_max3_f32 v5, v154, v155, v5
L_f1_e1_2:
  v_mfma_f32_32x32x16_bf16 v[140:155], v[36:39], v[12:15], 0
  v_max3_f32 v2, v156, v157, v2
  v_max3_f32 v3, v158, v159, v3
  v_max3_f32 v4, v160, v161, v4
  v_max3_f32 v5, v162, v163, v5
  v_max3_f32 v2, v164, v165, v2
  v_max3_f32 v3, v166, v167, v3
  v_max3_f32 v4, v168, v169, v4
  v_max3_f32 v5, v170, v171, v5
L_f1_e1_3:
  v_mfma_f32_32x32x16_bf16 v[156:171], v[40:43], v[12:15], 0
  v_max3_f32 v2, v124, v125, v2
  v_max3_f32 v3, v126, v127, v3
  v_max3_f32 v4, v128, v129, v4
  v_max3_f32 v5, v130, v131, v5
  v_max3_f32 v2, v132, v133, v2
  v_max3_f32 v3, v134, v135, v3
  v_max3_f32 v4, v136, v137, v4
  v_max3_f32 v5, v138, v139, v5
L_f1_e1_4:
  v_mfma_f32_32x32x16_bf16 v[124:139], v[44:47], v[12:15], 0
  v_max3_f32 v2, v140, v141, v2
  v_max3_f32 v3, v142, v143, v3
  v_max3_f32 v4, v144, v145, v4
  v_max3_f32 v5, v146, v147, v5
  v_max3_f32 v2, v148, v149, v2
  v_max3_f32 v3, v150, v151, v3
  v_max3_f32 v4, v152, v153, v4
  v_max3_f32 v5, v154, v155, v5
L_f1_e1_5:
  v_mfma_f32_32x32x16_bf16 v[140:155], v[48:51], v[12:15], 0
  v_max3_f32 v2, v156, v157, v2
  v_max3_f32 v3, v158, v159, v3
  v_max3_f32 v4, v160, v161, v4
  v_max3_f32 v5, v162, v163, v5
  v_max3_f32 v2, v164, v165, v2
  v_max3_f32 v3, v166, v167, v3
  v_max3_f32 v4, v168, v169, v4
  v_max3_f32 v5, v170, v171, v5
L_f1_e1_6:
  s_waitcnt vmcnt(3)
  v_mfma_f32_32x32x16_bf16 v[156:171], v[16:19], v[12:15], v[204:219]
  v_max3_f32 v2, v124, v125, v2
  v_max3_f32 v3, v126, v127, v3
  v_max3_f32 v4, v128, v129, v4
  v_max3_f32 v5, v130, v131, v5
  v_max3_f32 v2, v132, v133, v2
  v_max3_f32 v3, v134, v135, v3
  v_max3_f32 v4, v136, v137, v4
  v_max3_f32 v5, v138, v139, v5
L_f1_e1_7:
  v_max3_f32 v2, v140, v141, v2
  v_max3_f32 v3, v142, v143, v3
  v_max3_f32 v4, v144, v145, v4
  v_max3_f32 v5, v146, v147, v5
  v_max3_f32 v2, v148, v149, v2
  v_max3_f32 v3, v150, v151, v3
  v_max3_f32 v4, v152, v153, v4
  v_max3_f32 v5, v154, v155, v5
L_f1_e1_8:
  v_max3_f32 v2, v156, v157, v2
  v_max3_f32 v3, v158, v159, v3
  v_max3_f32 v4, v160, v161, v4
  v_max3_f32 v5, v162, v163, v5
  v_max3_f32 v2, v164, v165, v2
  v_max3_f32 v3, v166, v167, v3
  v_max3_f32 v4, v168, v169, v4
  v_max3_f32 v5, v170, v171, v5
  s_waitcnt vmcnt(1)
  v_max_f32 v2, v2, v3
  v_max_f32 v4, v4, v5
  v_max_f32 v2, v2, v4
  v_mov_b32 v3, v2
  s_nop 1
  v_permlane32_swap_b32 v2, v3
  v_max_f32 v2, v2, v3
  v_sub_f32 v2, 0, v2
  v_mov_b32 v188, v2
  v_mov_b32 v189, v2
  v_mov_b32 v190, v2
  v_mov_b32 v191, v2
  v_mov_b32 v192, v2
  v_mov_b32 v193, v2
  v_mov_b32 v194, v2
  v_mov_b32 v195, v2
  v_mov_b32 v196, v2
  v_mov_b32 v197, v2
  v_mov_b32 v198, v2
  v_mov_b32 v199, v2
  v_mov_b32 v200, v2
  v_mov_b32 v201, v2
  v_mov_b32 v202, v2
  v_mov_b32 v203, v2
  v_mov_b32 v172, 0
  v_mov_b32 v173, 0
  v_mov_b32 v174, 0
  v_mov_b32 v175, 0
  v_mov_b32 v176, 0
  v_mov_b32 v177, 0
  v_mov_b32 v178, 0
  v_mov_b32 v179, 0
  v_mov_b32 v180, 0
  v_mov_b32 v181, 0
  v_mov_b32 v182, 0
  v_mov_b32 v183, 0
  v_mov_b32 v184, 0
  v_mov_b32 v185, 0
  v_mov_b32 v186, 0
  v_mov_b32 v187, 0
  v_mov_b32 v236, 0
  v_mov_b32 v237, 0
  v_mov_b32 v238, 0
  v_mov_b32 v239, 0
  v_mov_b32 v240, 0
  v_mov_b32 v241, 0
  v_mov_b32 v242, 0
  v_mov_b32 v243, 0
  v_mov_b32 v244, 0
  v_mov_b32 v245, 0
  v_mov_b32 v246, 0
  v_mov_b32 v247, 0
  v_mov_b32 v248, 0
  v_mov_b32 v249, 0
  v_mov_b32 v250, 0
  v_mov_b32 v251, 0
  s_cmp_eq_u32 s95, 0
  s_cbranch_scc0 L_f1_d2
  v_add_f32 v124, v220, v2
  v_add_f32 v125, v221, v2
  v_add_f32 v126, v222, v2
  v_add_f32 v127, v223, v2
  v_add_f32 v128, v224, v2
  v_add_f32 v129, v225, v2
  v_add_f32 v130, v226, v2
  v_add_f32 v131, v227, v2
  v_add_f32 v132, v228, v2
  v_add_f32 v133, v229, v2
  v_add_f32 v134, v230, v2
  v_add_f32 v135, v231, v2
  v_add_f32 v136, v232, v2
  v_add_f32 v137, v233, v2
  v_add_f32 v138, v234, v2
  v_add_f32 v139, v235, v2
  s_nop 1
  v_mfma_f32_32x32x16_bf16 v[124:139], v[20:23], v[12:15], v[124:139]
  v_mfma_f32_32x32x16_bf16 v[140:155], v[24:27], v[12:15], v[188:203]
L_f1_e2_0:
  s_nop 10
  v_exp_f32 v124, v124
  v_exp_f32 v125, v125
  v_exp_f32 v126, v126
  v_exp_f32 v127, v127
  v_exp_f32 v128, v128
  v_exp_f32 v129, v129
  v_exp_f32 v130, v130
  v_exp_f32 v131, v131
  v_exp_f32 v132, v132
  v_exp_f32 v133, v133
  v_exp_f32 v134, v134
  v_exp_f32 v135, v135
  v_exp_f32 v136, v136
  v_exp_f32 v137, v137
  v_mfma_f32_32x32x16_bf16 v[156:171], v[28:31], v[12:15], v[188:203]
  v_exp_f32 v138, v138
  v_exp_f32 v139, v139
  v_cvt_pk_bf16_f32 v236, v124, v125
  v_cvt_pk_bf16_f32 v237, v126, v127
  v_cvt_pk_bf16_f32 v238, v128, v129
  v_cvt_pk_bf16_f32 v239, v130, v131
  v_cvt_pk_bf16_f32 v240, v132, v133
  v_cvt_pk_bf16_f32 v241, v134, v135
  v_cvt_pk_bf16_f32 v242, v136, v137
  v_cvt_pk_bf16_f32 v243, v138, v139
L_f1_e2_1:
  v_exp_f32 v140, v140
  v_exp_f32 v141, v141
  v_exp_f32 v142, v142
  v_exp_f32 v143, v143
  v_mfma_f32_32x32x16_bf16 v[172:187], v[60:63], v[236:239], v[172:187]
  v_exp_f32 v144, v144
  v_exp_f32 v145, v145
  v_exp_f32 v146, v146
  v_exp_f32 v147, v147
  v_exp_f32 v148, v148
  v_mfma_f32_32x32x16_bf16 v[172:187], v[64:67], v[240:243], v[172:187]
  v_exp_f32 v149, v149
  v_exp_f32 v150, v150
  v_exp_f32 v151, v151
  v_exp_f32 v152, v152
  v_exp_f32 v153, v153
  v_mfma_f32_32x32x16_bf16 v[124:139], v[32:35], v[12:15], v[188:203]
  v_exp_f32 v154, v154
  v_exp_f32 v155, v155
  v_cvt_pk_bf16_f32 v244, v140, v141
  v_cvt_pk_bf16_f32 v245, v142, v143
  v_cvt_pk_bf16_f32 v246, v144, v145
  v_cvt_pk_bf16_f32 v247, v146, v147
  v_cvt_pk_bf16_f32 v248, v148, v149
  v_cvt_pk_bf16_f32 v249, v150, v151
  v_cvt_pk_bf16_f32 v250, v152, v153
  v_cvt_pk_bf16_f32 v251, v154, v155
L_f1_e2_2:
  v_exp_f32 v156, v156
  v_exp_f32 v157, v157
  v_exp_f32 v158, v158
  v_exp_f32 v159, v159
  v_mfma_f32_32x32x16_bf16 v[172:187], v[68:71], v[244:247], v[172:187]
  v_exp_f32 v160, v160
  v_exp_f32 v161, v161
  v_exp_f32 v162, v162
  v_exp_f32 v163, v163
  v_exp_f32 v164, v164
  v_mfma_f32_32x32x16_bf16 v[172:187], v[72:75], v[248:251], v[172:187]
  v_exp_f32 v165, v165
  v_exp_f32 v166, v166
  v_exp_f32 v167, v167
  v_exp_f32 v168, v168
  v_exp_f32 v169, v169
  v_mfma_f32_32x32x16_bf16 v[140:155], v[36:39], v[12:15], v[188:203]
  v_exp_f32 v170, v170
  v_exp_f32 v171, v171
  v_cvt_pk_bf16_f32 v236, v156, v157
  v_cvt_pk_bf16_f32 v237, v158, v159
  v_cvt_pk_bf16_f32 v238, v160, v161
  v_cvt_pk_bf16_f32 v239, v162, v163
  v_cvt_pk_bf16_f32 v240, v164, v165
  v_cvt_pk_bf16_f32 v241, v166, v167
  v_cvt_pk_bf16_f32 v242, v168, v169
  v_cvt_pk_bf16_f32 v243, v170, v171
L_f1_e2_3:
  v_exp_f32 v124, v124
  v_exp_f32 v125, v125
  v_exp_f32 v126, v126
  v_exp_f32 v127, v127
  v_mfma_f32_32x32x16_bf16 v[172:187], v[76:79], v[236:239], v[172:187]
  v_exp_f32 v128, v128
  v_exp_f32 v129, v129
  v_exp_f32 v130, v130
  v_exp_f32 v131, v131
  v_exp_f32 v132, v132
  v_mfma_f32_32x32x16_bf16 v[172:187], v[80:83], v[240:243], v[172:187]
  v_exp_f32 v133, v133
  v_exp_f32 v134, v134
  v_exp_f32 v135, v135
  v_exp_f32 v136, v136
  v_exp_f32 v137, v137
  v_mfma_f32_32x32x16_bf16 v[156:171], v[40:43], v[12:15], v[188:203]
  v_exp_f32 v138, v138
  v_exp_f32 v139, v139
  v_cvt_pk_bf16_f32 v244, v124, v125
  v_cvt_pk_bf16_f32 v245, v126, v127
  v_cvt_pk_bf16_f32 v246, v128, v129
  v_cvt_pk_bf16_f32 v247, v130, v131
  v_cvt_pk_bf16_f32 v248, v132, v133
  v_cvt_pk_bf16_f32 v249, v134, v135
  v_cvt_pk_bf16_f32 v250, v136, v137
  v_cvt_pk_bf16_f32 v251, v138, v139
L_f1_e2_4:
  v_exp_f32 v140, v140
  v_exp_f32 v141, v141
  v_exp_f32 v142, v142
  v_exp_f32 v143, v143
  v_mfma_f32_32x32x16_bf16 v[172:187], v[84:87], v[244:247], v[172:187]
  v_exp_f32 v144, v144
  v_exp_f32 v145, v145
  v_exp_f32 v146, v146
  v_exp_f32 v147, v147
  v_exp_f32 v148, v148
  v_mfma_f32_32x32x16_bf16 v[172:187], v[88:91], v[248:251], v[172:187]
  v_exp_f32 v149, v149
  v_exp_f32 v150, v150
  v_exp_f32 v151, v151
  v_exp_f32 v152, v152
  v_exp_f32 v153, v153
  v_mfma_f32_32x32x16_bf16 v[124:139], v[44:47], v[12:15], v[188:203]
  v_exp_f32 v154, v154
  v_exp_f32 v155, v155
  v_cvt_pk_bf16_f32 v236, v140, v141
  v_cvt_pk_bf16_f32 v237, v142, v143
  v_cvt_pk_bf16_f32 v238, v144, v145
  v_cvt_pk_bf16_f32 v239, v146, v147
  v_cvt_pk_bf16_f32 v240, v148, v149
  v_cvt_pk_bf16_f32 v241, v150, v151
  v_cvt_pk_bf16_f32 v242, v152, v153
  v_cvt_pk_bf16_f32 v243, v154, v155
L_f1_e2_5:
  v_exp_f32 v156, v156
  v_exp_f32 v157, v157
  v_exp_f32 v158, v158
  v_exp_f32 v159, v159
  v_mfma_f32_32x32x16_bf16 v[172:187], v[92:95], v[236:239], v[172:187]
  v_exp_f32 v160, v160
  v_exp_f32 v161, v161
  v_exp_f32 v162, v162
  v_exp_f32 v163, v163
  v_exp_f32 v164, v164
  v_mfma_f32_32x32x16_bf16 v[172:187], v[96:99], v[240:243], v[172:187]
  v_exp_f32 v165, v165
  v_exp_f32 v166, v166
  v_exp_f32 v167, v167
  v_exp_f32 v168, v168
  v_exp_f32 v169, v169
  v_mfma_f32_32x32x16_bf16 v[140:155], v[48:51], v[12:15], v[188:203]
  v_exp_f32 v170, v170
  v_exp_f32 v171, v171
  v_cvt_pk_bf16_f32 v244, v156, v157
  v_cvt_pk_bf16_f32 v245, v158, v159
  v_cvt_pk_bf16_f32 v246, v160, v161
  v_cvt_pk_bf16_f32 v247, v162, v163
  v_cvt_pk_bf16_f32 v248, v164, v165
  v_cvt_pk_bf16_f32 v249, v166, v167
  v_cvt_pk_bf16_f32 v250, v168, v169
  v_cvt_pk_bf16_f32 v251, v170, v171
L_f1_e2_6:
  v_exp_f32 v124, v124
  v_exp_f32 v125, v125
  v_exp_f32 v126, v126
  v_exp_f32 v127, v127
  v_mfma_f32_32x32x16_bf16 v[172:187], v[100:103], v[244:247], v[172:187]
  v_exp_f32 v128, v128
  v_exp_f32 v129, v129
  v_exp_f32 v130, v130
  v_exp_f32 v131, v131
  v_exp_f32 v132, v132
  v_mfma_f32_32x32x16_bf16 v[172:187], v[104:107], v[248:251], v[172:187]
  v_exp_f32 v133, v133
  v_exp_f32 v134, v134
  v_exp_f32 v135, v135
  v_exp_f32 v136, v136
  v_exp_f32 v137, v137
  v_exp_f32 v138, v138
  v_exp_f32 v139, v139
  v_cvt_pk_bf16_f32 v236, v124, v125
  v_cvt_pk_bf16_f32 v237, v126, v127
  v_cvt_pk_bf16_f32 v238, v128, v129
  v_cvt_pk_bf16_f32 v239, v130, v131
  v_cvt_pk_bf16_f32 v240, v132, v133
  v_cvt_pk_bf16_f32 v241, v134, v135
  v_cvt_pk_bf16_f32 v242, v136, v137
  v_cvt_pk_bf16_f32 v243, v138, v139
  v_add_f32 v156, v204, v2
  v_add_f32 v157, v205, v2
  v_add_f32 v158, v206, v2
  v_add_f32 v159, v207, v2
  v_add_f32 v160, v208, v2
  v_add_f32 v161, v209, v2
  v_add_f32 v162, v210, v2
  v_add_f32 v163, v211, v2
  v_add_f32 v164, v212, v2
  v_add_f32 v165, v213, v2
  v_add_f32 v166, v214, v2
  v_add_f32 v167, v215, v2
  v_add_f32 v168, v216, v2
  v_add_f32 v169, v217, v2
  v_add_f32 v170, v218, v2
  v_add_f32 v171, v219, v2
  s_nop 1
  v_mfma_f32_32x32x16_bf16 v[156:171], v[16:19], v[12:15], v[156:171]
L_f1_e2_7:
  v_exp_f32 v140, v140
  v_exp_f32 v141, v141
  v_exp_f32 v142, v142
  v_exp_f32 v143, v143
  v_mfma_f32_32x32x16_bf16 v[172:187], v[108:111], v[236:239], v[172:187]
  v_exp_f32 v144, v144
  v_exp_f32 v145, v145
  v_exp_f32 v146, v146
  v_exp_f32 v147, v147
  v_exp_f32 v148, v148
  v_mfma_f32_32x32x16_bf16 v[172:187], v[112:115], v[240:243], v[172:187]
  v_exp_f32 v149, v149
  v_exp_f32 v150, v150
  v_exp_f32 v151, v151
  v_exp_f32 v152, v152
  v_exp_f32 v153, v153
  v_exp_f32 v154, v154
  v_exp_f32 v155, v155
  v_cvt_pk_bf16_f32 v244, v140, v141
  v_cvt_pk_bf16_f32 v245, v142, v143
  v_cvt_pk_bf16_f32 v246, v144, v145
  v_cvt_pk_bf16_f32 v247, v146, v147
  v_cvt_pk_bf16_f32 v248, v148, v149
  v_cvt_pk_bf16_f32 v249, v150, v151
  v_cvt_pk_bf16_f32 v250, v152, v153
  v_cvt_pk_bf16_f32 v251, v154, v155
L_f1_e2_8:
  v_exp_f32 v156, v156
  v_exp_f32 v157, v157
  v_exp_f32 v158, v158
  v_exp_f32 v159, v159
  v_mfma_f32_32x32x16_bf16 v[172:187], v[116:119], v[244:247], v[172:187]
  v_exp_f32 v160, v160
  v_exp_f32 v161, v161
  v_exp_f32 v162, v162
  v_exp_f32 v163, v163
  v_exp_f32 v164, v164
  v_mfma_f32_32x32x16_bf16 v[172:187], v[120:123], v[248:251], v[172:187]
  v_exp_f32 v165, v165
  v_exp_f32 v166, v166
  v_exp_f32 v167, v167
  v_exp_f32 v168, v168
  v_exp_f32 v169, v169
  v_exp_f32 v170, v170
  v_exp_f32 v171, v171
  v_cvt_pk_bf16_f32 v236, v156, v157
  v_cvt_pk_bf16_f32 v237, v158, v159
  v_cvt_pk_bf16_f32 v238, v160, v161
  v_cvt_pk_bf16_f32 v239, v162, v163
  v_cvt_pk_bf16_f32 v240, v164, v165
  v_cvt_pk_bf16_f32 v241, v166, v167
  v_cvt_pk_bf16_f32 v242, v168, v169
  v_cvt_pk_bf16_f32 v243, v170, v171
  v_mfma_f32_32x32x16_bf16 v[172:187], v[52:55], v[236:239], v[172:187]
  s_nop 0
  v_mfma_f32_32x32x16_bf16 v[172:187], v[56:59], v[240:243], v[172:187]
  s_nop 11
  v_rcp_f32 v2, v180
  s_nop 0
  v_mul_f32 v172, v172, v2
  v_mul_f32 v173, v173, v2
  v_mul_f32 v174, v174, v2
  v_mul_f32 v175, v175, v2
  v_mul_f32 v176, v176, v2
  v_mul_f32 v177, v177, v2
  v_mul_f32 v178, v178, v2
  v_mul_f32 v179, v179, v2
  v_cvt_pk_bf16_f32 v236, v172, v173
  v_cvt_pk_bf16_f32 v237, v174, v175
  v_cvt_pk_bf16_f32 v238, v176, v177
  v_cvt_pk_bf16_f32 v239, v178, v179
  s_branch L_f1_end
L_f1_d1:
  s_waitcnt vmcnt(3)
  s_cmp_eq_u32 s95, 1
  s_cbranch_scc1 L_f1_s1_1
  s_cmp_eq_u32 s95, 2
  s_cbranch_scc1 L_f1_s1_2
  s_cmp_eq_u32 s95, 3
  s_cbranch_scc1 L_f1_s1_3
  s_cmp_eq_u32 s95, 4
  s_cbranch_scc1 L_f1_s1_4
  s_cmp_eq_u32 s95, 5
  s_cbranch_scc1 L_f1_s1_5
  s_cmp_eq_u32 s95, 6
  s_cbranch_scc1 L_f1_s1_6
  s_cmp_eq_u32 s95, 7
  s_cbranch_scc1 L_f1_s1_7
  s_cmp_eq_u32 s95, 8
  s_cbranch_scc1 L_f1_s1_8
L_f1_s1_1:
  v_mfma_f32_32x32x16_bf16 v[140:155], v[24:27], v[12:15], 0
  v_mfma_f32_32x32x16_bf16 v[156:171], v[28:31], v[12:15], 0
  s_nop 15
  s_branch L_f1_e1_1
L_f1_s1_2:
  v_mfma_f32_32x32x16_bf16 v[156:171], v[28:31], v[12:15], 0
  v_mfma_f32_32x32x16_bf16 v[124:139], v[32:35], v[12:15], 0
  s_nop 15
  s_branch L_f1_e1_2
L_f1_s1_3:
  v_mfma_f32_32x32x16_bf16 v[124:139], v[32:35], v[12:15], 0
  v_mfma_f32_32x32x16_bf16 v[140:155], v[36:39], v[12:15], 0
  s_nop 15
  s_branch L_f1_e1_3
L_f1_s1_4:
  v_mfma_f32_32x32x16_bf16 v[140:155], v[36:39], v[12:15], 0
  v_mfma_f32_32x32x16_bf16 v[156:171], v[40:43], v[12:15], 0
  s_nop 15
  s_branch L_f1_e1_4
L_f1_s1_5:
  v_mfma_f32_32x32x16_bf16 v[156:171], v[40:43], v[12:15], 0
  v_mfma_f32_32x32x16_bf16 v[124:139], v[44:47], v[12:15], 0
  s_nop 15
  s_branch L_f1_e1_5
L_f1_s1_6:
  v_mfma_f32_32x32x16_bf16 v[124:139], v[44:47], v[12:15], 0
  v_mfma_f32_32x32x16_bf16 v[140:155], v[48:51], v[12:15], 0
  s_nop 15
  s_branch L_f1_e1_6
L_f1_s1_7:
  v_mfma_f32_32x32x16_bf16 v[140:155], v[48:51], v[12:15], 0
  v_mfma_f32_32x32x16_bf16 v[156:171], v[16:19], v[12:15], v[204:219]
  s_nop 15
  s_branch L_f1_e1_7
L_f1_s1_8:
  v_mfma_f32_32x32x16_bf16 v[156:171], v[16:19], v[12:15], v[204:219]
  s_nop 15
  s_branch L_f1_e1_8
L_f1_d2:
  s_cmp_eq_u32 s95, 1
  s_cbranch_scc1 L_f1_s2_1
  s_cmp_eq_u32 s95, 2
  s_cbranch_scc1 L_f1_s2_2
  s_cmp_eq_u32 s95, 3
  s_cbranch_scc1 L_f1_s2_3
  s_cmp_eq_u32 s95, 4
  s_cbranch_scc1 L_f1_s2_4
  s_cmp_eq_u32 s95, 5
  s_cbranch_scc1 L_f1_s2_5
  s_cmp_eq_u32 s95, 6
  s_cbranch_scc1 L_f1_s2_6
  s_cmp_eq_u32 s95, 7
  s_cbranch_scc1 L_f1_s2_7
  s_cmp_eq_u32 s95, 8
  s_cbranch_scc1 L_f1_s2_8
L_f1_s2_1:
  s_nop 7
  v_mfma_f32_32x32x16_bf16 v[140:155], v[24:27], v[12:15], v[188:203]
  v_mfma_f32_32x32x16_bf16 v[156:171], v[28:31], v[12:15], v[188:203]
  s_nop 15
  s_branch L_f1_e2_1
L_f1_s2_2:
  s_nop 7
  v_mfma_f32_32x32x16_bf16 v[156:171], v[28:31], v[12:15], v[188:203]
  v_mfma_f32_32x32x16_bf16 v[124:139], v[32:35], v[12:15], v[188:203]
  s_nop 15
  s_branch L_f1_e2_2
L_f1_s2_3:
  s_nop 7
  v_mfma_f32_32x32x16_bf16 v[124:139], v[32:35], v[12:15], v[188:203]
  v_mfma_f32_32x32x16_bf16 v[140:155], v[36:39], v[12:15], v[188:203]
  s_nop 15
  s_branch L_f1_e2_3
L_f1_s2_4:
  s_nop 7
  v_mfma_f32_32x32x16_bf16 v[140:155], v[36:39], v[12:15], v[188:203]
  v_mfma_f32_32x32x16_bf16 v[156:171], v[40:43], v[12:15], v[188:203]
  s_nop 15
  s_branch L_f1_e2_4
L_f1_s2_5:
  s_nop 7
  v_mfma_f32_32x32x16_bf16 v[156:171], v[40:43], v[12:15], v[188:203]
  v_mfma_f32_32x32x16_bf16 v[124:139], v[44:47], v[12:15], v[188:203]
  s_nop 15
  s_branch L_f1_e2_5
L_f1_s2_6:
  s_nop 7
  v_mfma_f32_32x32x16_bf16 v[124:139], v[44:47], v[12:15], v[188:203]
  v_mfma_f32_32x32x16_bf16 v[140:155], v[48:51], v[12:15], v[188:203]
  s_nop 15
  s_branch L_f1_e2_6
L_f1_s2_7:
  s_nop 7
  v_mfma_f32_32x32x16_bf16 v[140:155], v[48:51], v[12:15], v[188:203]
  v_add_f32 v156, v204, v2
  v_add_f32 v157, v205, v2
  v_add_f32 v158, v206, v2
  v_add_f32 v159, v207, v2
  v_add_f32 v160, v208, v2
  v_add_f32 v161, v209, v2
  v_add_f32 v162, v210, v2
  v_add_f32 v163, v211, v2
  v_add_f32 v164, v212, v2
  v_add_f32 v165, v213, v2
  v_add_f32 v166, v214, v2
  v_add_f32 v167, v215, v2
  v_add_f32 v168, v216, v2
  v_add_f32 v169, v217, v2
  v_add_f32 v170, v218, v2
  v_add_f32 v171, v219, v2
  s_nop 1
  v_mfma_f32_32x32x16_bf16 v[156:171], v[16:19], v[12:15], v[156:171]
  s_nop 15
  s_branch L_f1_e2_7
L_f1_s2_8:
  s_nop 7
  v_add_f32 v156, v204, v2
  v_add_f32 v157, v205, v2
  v_add_f32 v158, v206, v2
  v_add_f32 v159, v207, v2
  v_add_f32 v160, v208, v2
  v_add_f32 v161, v209, v2
  v_add_f32 v162, v210, v2
  v_add_f32 v163, v211, v2
  v_add_f32 v164, v212, v2
  v_add_f32 v165, v213, v2
  v_add_f32 v166, v214, v2
  v_add_f32 v167, v215, v2
  v_add_f32 v168, v216, v2
  v_add_f32 v169, v217, v2
  v_add_f32 v170, v218, v2
  v_add_f32 v171, v219, v2
  s_nop 1
  v_mfma_f32_32x32x16_bf16 v[156:171], v[16:19], v[12:15], v[156:171]
  s_nop 15
  s_branch L_f1_e2_8
L_f1_end:
  s_nop 3
  s_add_u32 s10, s93, 1
  s_mul_i32 s10, s10, 147456
  s_add_u32 s11, s94, 112
  s_lshl_b32 s11, s11, 10
  s_add_u32 s10, s10, s11
  s_add_u32 s10, s10, 6291456
  v_lshlrev_b32 v3, 4, v0
  buffer_store_dwordx4 v[236:239], v3, s[68:71], s10 offen sc1
L_at_done:
  s_waitcnt vmcnt(0)
  v_mov_b32 v6, 12804
  v_mov_b32 v7, 1
  s_mov_b64 exec, 1
  ds_add_rtn_u32 v7, v6, v7
  s_waitcnt lgkmcnt(0)
  s_mov_b64 exec, -1
  v_readfirstlane_b32 s10, v7
  s_nop 3
  s_cmp_eq_u32 s10, 3
  s_cbranch_scc0 L_at_fl_skip
  s_lshr_b32 s10, s6, 1
  s_lshl_b32 s10, s10, 7
  s_and_b32 s12, s6, 1
  s_lshl_b32 s12, s12, 4
  s_add_u32 s12, s12, s7
  s_lshl_b32 s12, s12, 2
  s_add_u32 s10, s10, s12
  s_add_u32 s10, s10, 8192
  s_add_u32 s11, s33, 4
  v_mov_b32 v6, s11
  v_mov_b32 v7, s10
  s_mov_b32 s11, 16777216
  s_mov_b64 exec, 1
  buffer_store_dword v6, v7, s[68:71], s11 offen sc1
  s_mov_b64 exec, -1
L_at_fl_skip:
  s_waitcnt vmcnt(0)
  s_waitcnt vmcnt(0)
L_exit:
  s_endpgm
.section .rodata,"a"
.p2align 6
.amdhsa_kernel parallel_sum__sliding_block__glu_gated_glu__prompt_kernel
  .amdhsa_next_free_vgpr 256
  .amdhsa_next_free_sgpr 102
  .amdhsa_accum_offset 256
  .amdhsa_group_segment_fixed_size 0
  .amdhsa_kernarg_size 80
  .amdhsa_user_sgpr_count 2
  .amdhsa_user_sgpr_kernarg_segment_ptr 1
  .amdhsa_system_sgpr_workgroup_id_x 1
.end_amdhsa_kernel
```
